```python
import torch

def _softmax(x, axis=-1):
    return torch.softmax(x, dim=axis)
def _gelu(x):
    return torch.nn.functional.gelu(x, approximate="tanh")
def _silu(x):
    return torch.nn.functional.silu(x)
def _sigmoid(x):
    return torch.sigmoid(x)
def _layernorm(x, axis=-1, eps=1e-5):
    m = x.mean(dim=axis, keepdim=True)
    v = x.var(dim=axis, keepdim=True, unbiased=False)
    return (x - m) / torch.sqrt(v + eps)
def _scatter_add(tgt, idx, src, axis=0):
    return tgt.clone().index_add_(axis, idx, src)
def _segment_sum(src, seg, n):
    out = torch.zeros((n,) + src.shape[1:], dtype=src.dtype)
    return out.index_add_(0, seg, src)
def _pad(x, pw):
    flat = tuple(v for pair in reversed(pw) for v in pair)
    return torch.nn.functional.pad(x, flat)

kernel_name = 'standalone__mha_softmax__near_ridge'

def setup_inputs():

    _w = (lambda a: (lambda t: t.to(torch.bfloat16) if t.is_floating_point() else t)(torch.as_tensor(a)))
    B, H, Sq, Sk, D = 8, 32, 1024, 512, 128
    return {
        "q": _w((lambda *s: torch.randn(*s, dtype=torch.bfloat16) * 0.8)(B, H, Sq, D)),
        "k": _w((lambda *s: torch.randn(*s, dtype=torch.bfloat16) * 0.8)(B, H, Sk, D)),
        "v": _w((lambda *s: torch.randn(*s, dtype=torch.bfloat16) * 0.05)(B, H, Sk, D)),
    }

def reference(q, k, v):
    scale = q.shape[-1] ** -0.5
    scores = torch.einsum("bhqd,bhkd->bhqk", q, k) * scale
    p = _softmax(scores, axis=-1)
    return torch.einsum("bhqk,bhkd->bhqd", p, v)
```

```asm
; @launch grid=(256,1,1) block=(256,1,1) lds=152064
.amdgcn_target "amdgcn-amd-amdhsa--gfx950"
.text
.globl standalone__mha_softmax__near_ridge_kernel
.p2align 8
.type standalone__mha_softmax__near_ridge_kernel,@function
standalone__mha_softmax__near_ridge_kernel:
    s_cmp_ge_u32 s2, 256
    s_cbranch_scc1 L_end
    s_load_dwordx2 s[8:9], s[0:1], 8
    s_load_dwordx2 s[4:5], s[0:1], 0
    s_load_dwordx2 s[12:13], s[0:1], 16
    s_load_dwordx2 s[16:17], s[0:1], 24
    v_mov_b32_e32 v7, v0
    s_getpc_b64 s[40:41]
L_pc:
    s_bfe_u32 s42, s2, 0x30003
    s_mul_i32 s42, s42, ((L_slow-L_pc)/1024+1)*128
    v_lshrrev_b32_e32 v8, 2, v7
    v_min_u32_e32 v8, (L_slow-L_pc)/1024, v8
    v_lshl_add_u32 v8, v8, 7, s42
    v_min_u32_e32 v8, L_slow-L_pc, v8
    v_mov_b32_e32 v9, s41
    v_add_co_u32_e32 v8, vcc, s40, v8
    s_nop 1
    v_addc_co_u32_e32 v9, vcc, 0, v9, vcc
    global_load_dword v241, v[8:9], off
    v_lshrrev_b32_e32 v1, 6, v0
    v_and_b32_e32 v0, 63, v0
    v_readfirstlane_b32 s34, v1
    v_bfe_u32 v2, v0, 2, 2
    v_lshrrev_b32_e32 v3, 4, v0
    v_and_b32_e32 v4, 3, v0
    v_lshlrev_b32_e32 v254, 12, v1
    v_lshl_add_u32 v254, v2, 8, v254
    v_lshl_add_u32 v254, v3, 6, v254
    v_lshl_add_u32 v254, v4, 4, v254
    s_and_b32 s35, s2, 7
    s_lshr_b32 s36, s2, 5
    s_lshl3_add_u32 s36, s35, s36
    s_lshl_b32 s20, s36, 17
    s_mul_i32 s23, s34, 4224
    s_addk_i32 s23, 1024
    s_mov_b32 s11, 0x20000
    s_lshl_b32 s10, s11, 8
    s_add_u32 m0, s23, 0
    s_mov_b32 s7, s11
    s_lshl_b32 s6, s11, 9
    s_bfe_u32 s37, s2, 0x20003
    s_lshl2_add_u32 s37, s36, s37
    s_lshl_b32 s21, s37, 16
    s_waitcnt lgkmcnt(0)
    buffer_load_dwordx4 v254, s[8:11], s20 offen nt lds
    s_add_u32 m0, s23, 32
    s_mul_i32 s27, s34, 4352
    buffer_load_dwordx4 v254, s[8:11], s20 offen offset:1024 nt lds
    s_add_u32 m0, s23, 64
    s_add_u32 s27, s27, 134656
    buffer_load_dwordx4 v254, s[8:11], s20 offen offset:2048 nt lds
    s_add_u32 m0, s23, 96
    s_lshl_b32 s37, s34, 12
    buffer_load_dwordx4 v254, s[8:11], s20 offen offset:3072 nt lds
    s_add_u32 m0, s27, 0
    s_add_u32 s38, s21, s37
    buffer_load_dwordx4 v254, s[4:7], s21 offen nt lds
    s_add_u32 m0, s27, 32
    s_mov_b32 s39, s20
    buffer_load_dwordx4 v254, s[4:7], s21 offen offset:1024 nt lds
    s_add_u32 m0, s27, 64
    s_mul_i32 s24, s34, 4128
    buffer_load_dwordx4 v254, s[4:7], s21 offen offset:2048 nt lds
    s_add_u32 m0, s27, 96
    s_add_u32 s24, s24, 68608
    buffer_load_dwordx4 v254, s[4:7], s21 offen offset:3072 nt lds
    s_xor_b32 s21, s21, 16384
    s_add_u32 m0, s23, 33792
    s_mov_b32 s14, s10
    s_bitcmp0_b32 s2, 0
    s_cbranch_scc0 L_y8
    s_waitcnt vmcnt(0)
L_y8:
    buffer_load_dwordx4 v254, s[4:7], s21 offen nt lds
    s_add_u32 m0, s23, 33824
    s_mov_b32 s15, s11
    buffer_load_dwordx4 v254, s[4:7], s21 offen offset:1024 nt lds
    s_add_u32 m0, s23, 33856
    s_mov_b32 s19, s11
    buffer_load_dwordx4 v254, s[4:7], s21 offen offset:2048 nt lds
    s_add_u32 m0, s23, 33888
    v_and_b32_e32 v5, 15, v0
    buffer_load_dwordx4 v254, s[4:7], s21 offen offset:3072 nt lds
    s_xor_b32 s21, s21, 49152
    s_xor_b32 s22, s38, 49152
    s_mov_b32 s18, 0
    s_mov_b32 s48, 0
    v_mul_u32_u24_e32 v252, 1056, v2
    v_lshl_add_u32 v252, v4, 6, v252
    v_lshl_add_u32 v252, v3, 4, v252
    v_mul_u32_u24_e32 v253, 1032, v3
    v_lshl_add_u32 v253, v5, 4, v253
    v_add_u32_e32 v253, 68608, v253
    v_add_u32_e32 v246, s27, v252
    v_add_u32_e32 v255, s23, v252
    v_add_u32_e32 v252, 1024, v252
    s_lshl_b32 s45, s34, 8
    s_mov_b32 s44, 0
    v_mov_b32_e32 v6, 0
    s_mov_b32 m0, s45
    v_mul_u32_u24_e32 v242, 272, v5
    ds_write_addtid_b32 v6
    v_lshl_add_u32 v242, v3, 4, v242
    v_add_u32_e32 v242, s27, v242
    v_mul_u32_u24_e32 v247, 272, v3
    v_lshl_add_u32 v247, v5, 4, v247
    v_add_u32_e32 v247, s27, v247
    s_mov_b32 s25, -3
    s_mov_b32 s47, 2
    s_mov_b32 s46, 0x40400000
    s_mov_b32 s26, 0x5f800000
    s_mov_b64 s[28:29], 0
    v_mov_b32_e32 v6, 0x3f803f80
    v_accvgpr_write_b32 a208, v6
    v_accvgpr_write_b32 a209, v6
    v_accvgpr_write_b32 a210, v6
    v_accvgpr_write_b32 a211, v6
    v_and_b32_e32 v6, 1, v0
    v_mul_u32_u24_e32 v245, 0xaaaa, v6
    v_add_u32_e32 v245, 0x4444, v245
    v_lshl_or_b32 v245, v245, 16, v245
    v_lshlrev_b32_e32 v6, 4, v6
    v_mov_b32_e32 v7, 0x3e03
    v_mov_b32_e32 v8, 0xb9d8
    v_lshlrev_b32_e32 v7, v6, v7
    v_lshlrev_b32_e32 v8, v6, v8
    v_cmp_gt_u32_e32 vcc, 2, v4
    s_nop 1
    v_cndmask_b32_e32 v9, 0, v7, vcc
    v_cndmask_b32_e32 v10, 0, v8, vcc
    v_sub_u32_e32 v7, v7, v9
    v_sub_u32_e32 v8, v8, v10
    v_accvgpr_write_b32 a212, v9
    v_accvgpr_write_b32 a213, v7
    v_accvgpr_write_b32 a214, v10
    v_accvgpr_write_b32 a215, v8
    s_waitcnt lgkmcnt(0)
    v_accvgpr_write_b32 a194, 0
    v_accvgpr_write_b32 a195, 0
    v_accvgpr_write_b32 a198, 0
    v_accvgpr_write_b32 a199, 0
    v_accvgpr_write_b32 a202, 0
    v_accvgpr_write_b32 a203, 0
    v_accvgpr_write_b32 a206, 0
    v_accvgpr_write_b32 a207, 0
    s_add_u32 s64, s24, 8
    s_add_u32 s65, s24, 16
    s_add_u32 s66, s24, 24
    s_add_u32 s67, s23, 50688
    s_add_u32 s68, s23, 50720
    s_add_u32 s69, s23, 50752
    s_add_u32 s70, s23, 50784
    s_add_u32 s71, s27, 32
    s_add_u32 s72, s27, 64
    s_add_u32 s73, s27, 96
    s_add_u32 s74, s23, 16896
    s_add_u32 s75, s23, 16928
    s_add_u32 s76, s23, 16960
    s_add_u32 s77, s23, 16992
    s_add_u32 s78, s24, 16512
    s_add_u32 s79, s24, 16520
    s_add_u32 s80, s24, 16528
    s_add_u32 s81, s24, 16536
    s_add_u32 s82, s23, 33792
    s_add_u32 s83, s23, 33824
    s_add_u32 s84, s23, 33856
    s_add_u32 s85, s23, 33888
    s_add_u32 s86, s24, 33024
    s_add_u32 s87, s24, 33032
    s_add_u32 s88, s24, 33040
    s_add_u32 s89, s24, 33048
    s_add_u32 s90, s24, 49536
    s_add_u32 s91, s24, 49544
    s_add_u32 s92, s24, 49552
    s_add_u32 s93, s24, 49560
    s_add_u32 s94, s23, 32
    s_add_u32 s95, s23, 64
    s_add_u32 s96, s23, 96
    s_waitcnt vmcnt(8)
    s_barrier
    s_mov_b32 m0, s24
    s_nop 0
    buffer_load_dwordx4 v254, s[12:15], s20 offen nt lds
    s_mov_b32 m0, s64
    s_nop 0
    buffer_load_dwordx4 v254, s[12:15], s20 offen offset:1024 nt lds
    s_mov_b32 m0, s65
    s_nop 0
    buffer_load_dwordx4 v254, s[12:15], s20 offen offset:2048 nt lds
    s_mov_b32 m0, s66
    s_nop 0
    buffer_load_dwordx4 v254, s[12:15], s20 offen offset:3072 nt lds
    ds_read_b128 a[0:3], v252 offset:0
    ds_read_b128 a[4:7], v252 offset:256
    ds_read_b128 a[8:11], v252 offset:512
    ds_read_b128 a[12:15], v252 offset:768
    ds_read_b128 a[16:19], v252 offset:4224
    ds_read_b128 a[20:23], v252 offset:4480
    ds_read_b128 a[24:27], v252 offset:4736
    ds_read_b128 a[28:31], v252 offset:4992
    ds_read_b128 a[32:35], v252 offset:8448
    ds_read_b128 a[36:39], v252 offset:8704
    ds_read_b128 a[40:43], v252 offset:8960
    ds_read_b128 a[44:47], v252 offset:9216
    ds_read_b128 a[48:51], v252 offset:12672
    ds_read_b128 a[52:55], v252 offset:12928
    ds_read_b128 a[56:59], v252 offset:13184
    ds_read_b128 a[60:63], v252 offset:13440
    s_waitcnt vmcnt(8)
    ds_read_b128 a[128:131], v246 offset:0
    ds_read_b128 a[132:135], v246 offset:256
    ds_read_b128 a[136:139], v246 offset:512
    ds_read_b128 a[140:143], v246 offset:768
    s_mov_b32 m0, s67
    s_nop 0
    s_bitcmp0_b32 s2, 0
    s_cbranch_scc0 L_y16
    s_waitcnt vmcnt(4)
L_y16:
    buffer_load_dwordx4 v254, s[4:7], s21 offen nt lds
    s_mov_b32 m0, s68
    s_nop 0
    buffer_load_dwordx4 v254, s[4:7], s21 offen offset:1024 nt lds
    s_mov_b32 m0, s69
    s_nop 0
    buffer_load_dwordx4 v254, s[4:7], s21 offen offset:2048 nt lds
    s_mov_b32 m0, s70
    s_nop 0
    buffer_load_dwordx4 v254, s[4:7], s21 offen offset:3072 nt lds
    s_waitcnt lgkmcnt(3)
    v_mfma_f32_4x4x4_16b_bf16 v[136:139], a[212:213], a[128:129], 0
    s_xor_b32 s21, s21, 16384
    v_accvgpr_write_b32 a192, 0
    v_mfma_f32_4x4x4_16b_bf16 v[192:195], a[212:213], a[130:131], 0
    s_xor_b32 s20, s20, 16384
    v_accvgpr_write_b32 a193, 0
    v_mfma_f32_4x4x4_16b_bf16 v[136:139], a[214:215], a[128:129], v[136:139]
    s_waitcnt lgkmcnt(2)
    v_accvgpr_write_b32 a196, 0
    v_mfma_f32_4x4x4_16b_bf16 v[140:143], a[212:213], a[132:133], 0
    v_accvgpr_write_b32 a197, 0
    v_mfma_f32_4x4x4_16b_bf16 v[192:195], a[214:215], a[130:131], v[192:195]
    v_accvgpr_write_b32 a200, 0
    v_mfma_f32_4x4x4_16b_bf16 v[124:127], a[212:213], a[134:135], 0
    v_cvt_pk_bf16_f32 v128, v136, v137
    v_mfma_f32_4x4x4_16b_bf16 v[140:143], a[214:215], a[132:133], v[140:143]
    s_waitcnt lgkmcnt(1)
    v_cvt_pk_bf16_f32 v129, v138, v139
    v_mfma_f32_4x4x4_16b_bf16 v[136:139], a[212:213], a[136:137], 0
    v_cvt_pk_bf16_f32 v130, v192, v193
    v_mfma_f32_4x4x4_16b_bf16 v[124:127], a[214:215], a[134:135], v[124:127]
    v_cvt_pk_bf16_f32 v131, v194, v195
    v_mfma_f32_4x4x4_16b_bf16 v[192:195], a[212:213], a[138:139], 0
    v_cvt_pk_bf16_f32 v132, v140, v141
    v_mfma_f32_4x4x4_16b_bf16 v[136:139], a[214:215], a[136:137], v[136:139]
    s_waitcnt lgkmcnt(0)
    v_cvt_pk_bf16_f32 v133, v142, v143
    v_mfma_f32_4x4x4_16b_bf16 v[140:143], a[212:213], a[140:141], 0
    v_cvt_pk_bf16_f32 v134, v124, v125
    v_mfma_f32_4x4x4_16b_bf16 v[192:195], a[214:215], a[138:139], v[192:195]
    v_cvt_pk_bf16_f32 v135, v126, v127
    v_mfma_f32_4x4x4_16b_bf16 v[124:127], a[212:213], a[142:143], 0
    v_cvt_pk_bf16_f32 v136, v136, v137
    v_mfma_f32_4x4x4_16b_bf16 v[140:143], a[214:215], a[140:141], v[140:143]
    v_cvt_pk_bf16_f32 v137, v138, v139
    v_mfma_f32_4x4x4_16b_bf16 v[124:127], a[214:215], a[142:143], v[124:127]
    v_cvt_pk_bf16_f32 v138, v192, v193
    v_mfma_f32_16x16x32_bf16 v[208:211], a[0:3], v[128:131], 0
    v_cvt_pk_bf16_f32 v139, v194, v195
    v_accvgpr_write_b32 a201, 0
    v_accvgpr_write_b32 a204, 0
    v_cvt_pk_bf16_f32 v140, v140, v141
    v_cvt_pk_bf16_f32 v141, v142, v143
    v_mfma_f32_16x16x32_bf16 v[208:211], a[4:7], v[132:135], v[208:211]
    v_cvt_pk_bf16_f32 v142, v124, v125
    v_cvt_pk_bf16_f32 v143, v126, v127
    v_mfma_f32_16x16x32_bf16 v[208:211], a[8:11], v[136:139], v[208:211]
    v_accvgpr_write_b32 a205, 0
    v_mfma_f32_16x16x32_bf16 v[208:211], a[12:15], v[140:143], v[208:211]
    v_mfma_f32_16x16x32_bf16 v[212:215], a[28:31], v[140:143], 0
    v_mfma_f32_16x16x32_bf16 v[212:215], a[24:27], v[136:139], v[212:215]
    v_max3_f32 v192, v208, v209, v210
    v_max_f32_e32 v193, v192, v211
    v_max_f32_e32 v192, v192, v211
    v_mfma_f32_16x16x32_bf16 v[212:215], a[20:23], v[132:135], v[212:215]
    v_mfma_f32_16x16x32_bf16 v[212:215], a[16:19], v[128:131], v[212:215]
    s_mov_b32 m0, s27
    v_permlane32_swap_b32_e32 v192, v193
    v_max_f32_e64 v194, v192, v193
    v_max_f32_e32 v195, v192, v193
    s_nop 3
    v_permlane16_swap_b32_e32 v194, v195
    v_max_f32_e32 v195, v194, v195
    v_sub_f32_e32 v192, -4.0, v195
    v_sub_f32_e32 v193, -4.0, v195
    v_pk_mov_b32 v[194:195], v[192:193], v[192:193] op_sel:[0,1]
    v_pk_add_f32 v[208:209], v[208:209], v[192:193]
    v_pk_add_f32 v[210:211], v[210:211], v[192:193]
    v_pk_add_f32 v[212:213], v[212:213], v[192:193]
    v_pk_add_f32 v[214:215], v[214:215], v[192:193]
    v_mfma_f32_16x16x32_bf16 v[216:219], a[32:35], v[128:131], v[192:195]
    s_waitcnt vmcnt(8)
    ds_read_b128 a[144:147], v255 offset:33792
    ds_read_b128 a[148:151], v255 offset:34048
    ds_read_b128 a[152:155], v255 offset:34304
    ds_read_b128 a[156:159], v255 offset:34560
    v_mfma_f32_16x16x32_bf16 v[216:219], a[36:39], v[132:135], v[216:219]
    s_bitcmp0_b32 s2, 0
    s_cbranch_scc0 L_y20
    s_waitcnt vmcnt(0)
L_y20:
    buffer_load_dwordx4 v254, s[4:7], s21 offen nt lds
    v_exp_f32_e32 v208, v208
    v_exp_f32_e32 v209, v209
    v_mfma_f32_16x16x32_bf16 v[216:219], a[40:43], v[136:139], v[216:219]
    s_mov_b32 m0, s71
    v_exp_f32_e32 v210, v210
    v_exp_f32_e32 v211, v211
    v_exp_f32_e32 v212, v212
    v_mfma_f32_16x16x32_bf16 v[216:219], a[44:47], v[140:143], v[216:219]
    buffer_load_dwordx4 v254, s[4:7], s21 offen offset:1024 nt lds
    v_exp_f32_e32 v213, v213
    v_exp_f32_e32 v214, v214
    v_mfma_f32_16x16x32_bf16 v[220:223], a[60:63], v[140:143], v[192:195]
    s_mov_b32 m0, s72
    v_exp_f32_e32 v215, v215
    v_cvt_pk_bf16_f32 v224, v208, v209
    v_cvt_pk_bf16_f32 v225, v210, v211
    v_cvt_pk_bf16_f32 v226, v212, v213
    v_cvt_pk_bf16_f32 v227, v214, v215
    v_mfma_f32_16x16x32_bf16 v[220:223], a[56:59], v[136:139], v[220:223]
    buffer_load_dwordx4 v254, s[4:7], s21 offen offset:2048 nt lds
    v_exp_f32_e64 v216, v216
    v_mfma_f32_16x16x32_bf16 v[220:223], a[52:55], v[132:135], v[220:223]
    s_mov_b32 m0, s73
    v_exp_f32_e32 v217, v217
    v_exp_f32_e64 v218, v218
    v_mfma_f32_16x16x32_bf16 v[220:223], a[48:51], v[128:131], v[220:223]
    s_waitcnt lgkmcnt(1)
    buffer_load_dwordx4 v254, s[4:7], s21 offen offset:3072 nt lds
    v_exp_f32_e32 v219, v219
    v_mfma_f32_4x4x4_16b_bf16 v[152:155], a[212:213], a[144:145], 0
    v_cvt_pk_bf16_f32 v228, v216, v217
    v_mfma_f32_4x4x4_16b_bf16 v[196:199], a[212:213], a[146:147], 0
    v_cvt_pk_bf16_f32 v229, v218, v219
    v_mfma_f32_4x4x4_16b_bf16 v[152:155], a[214:215], a[144:145], v[152:155]
    v_exp_f32_e32 v220, v220
    v_exp_f32_e32 v221, v221
    v_exp_f32_e64 v222, v222
    v_mfma_f32_4x4x4_16b_bf16 v[156:159], a[212:213], a[148:149], 0
    v_exp_f32_e64 v223, v223
    v_cvt_pk_bf16_f32 v230, v220, v221
    v_mfma_f32_4x4x4_16b_bf16 v[196:199], a[214:215], a[146:147], v[196:199]
    v_cvt_pk_bf16_f32 v231, v222, v223
    v_mfma_f32_4x4x4_16b_bf16 v[124:127], a[212:213], a[150:151], 0
    v_cvt_pk_bf16_f32 v144, v152, v153
    v_mfma_f32_4x4x4_16b_bf16 v[156:159], a[214:215], a[148:149], v[156:159]
    v_cvt_pk_bf16_f32 v145, v154, v155
    v_mfma_f32_4x4x4_16b_bf16 v[152:155], a[212:213], a[152:153], 0
    v_cvt_pk_bf16_f32 v146, v196, v197
    v_cvt_pk_bf16_f32 v147, v198, v199
    v_mfma_f32_4x4x4_16b_bf16 v[124:127], a[214:215], a[150:151], v[124:127]
    s_waitcnt vmcnt(8)
    v_mfma_f32_4x4x4_16b_bf16 v[196:199], a[212:213], a[154:155], 0
    s_barrier
    ds_read_b64_tr_b16 a[72:73], v253 offset:8
    ds_read_b64_tr_b16 a[82:83], v253 offset:4384
    ds_read_b64_tr_b16 a[92:93], v253 offset:8520
    v_cvt_pk_bf16_f32 v148, v156, v157
    v_cvt_pk_bf16_f32 v149, v158, v159
    v_mfma_f32_4x4x4_16b_bf16 v[152:155], a[214:215], a[152:153], v[152:155]
    s_waitcnt lgkmcnt(3)
    ds_read_b64_tr_b16 a[64:65], v253 offset:0
    ds_read_b64_tr_b16 a[66:67], v253 offset:4128
    v_mfma_f32_4x4x4_16b_bf16 v[156:159], a[212:213], a[156:157], 0
    s_mov_b32 m0, s74
    ds_read_b64_tr_b16 a[68:69], v253 offset:8256
    ds_read_b64_tr_b16 a[70:71], v253 offset:12384
    v_cvt_pk_bf16_f32 v150, v124, v125
    v_cvt_pk_bf16_f32 v151, v126, v127
    v_mfma_f32_4x4x4_16b_bf16 v[196:199], a[214:215], a[154:155], v[196:199]
    ds_read_b64_tr_b16 a[76:77], v253 offset:8264
    ds_read_b64_tr_b16 a[78:79], v253 offset:12392
    buffer_load_dwordx4 v254, s[8:11], s20 offen nt lds
    v_mfma_f32_4x4x4_16b_bf16 v[124:127], a[212:213], a[158:159], 0
    s_mov_b32 m0, s75
    ds_read_b64_tr_b16 a[74:75], v253 offset:4136
    v_cvt_pk_bf16_f32 v152, v152, v153
    v_cvt_pk_bf16_f32 v153, v154, v155
    v_mfma_f32_4x4x4_16b_bf16 v[156:159], a[214:215], a[156:157], v[156:159]
    buffer_load_dwordx4 v254, s[8:11], s20 offen offset:1024 nt lds
    ds_read_b64_tr_b16 a[80:81], v253 offset:256
    s_waitcnt lgkmcnt(10)
    v_accvgpr_read_b32 v248, a72
    v_accvgpr_read_b32 v249, a73
    v_max_f32_e64 v248, |v248|, |v249|
    v_mfma_f32_4x4x4_16b_bf16 v[124:127], a[214:215], a[158:159], v[124:127]
    s_mov_b32 m0, s76
    ds_read_b64_tr_b16 a[84:85], v253 offset:8512
    s_waitcnt lgkmcnt(10)
    v_accvgpr_read_b32 v249, a82
    v_accvgpr_read_b32 v250, a83
    v_cvt_pk_bf16_f32 v154, v196, v197
    v_cvt_pk_bf16_f32 v155, v198, v199
    s_waitcnt lgkmcnt(9)
    v_accvgpr_read_b32 v251, a93
    v_mfma_f32_16x16x32_bf16 v[208:211], a[0:3], v[144:147], 0
    buffer_load_dwordx4 v254, s[8:11], s20 offen offset:2048 nt lds
    ds_read_b64_tr_b16 a[86:87], v253 offset:12640
    v_max_f32_e64 v249, |v249|, |v250|
    v_cvt_pk_bf16_f32 v156, v156, v157
    v_accvgpr_read_b32 v250, a92
    v_cvt_pk_bf16_f32 v157, v158, v159
    v_mfma_f32_16x16x32_bf16 v[208:211], a[4:7], v[148:151], v[208:211]
    s_mov_b32 m0, s77
    ds_read_b64_tr_b16 a[94:95], v253 offset:12648
    v_max_f32_e64 v250, |v250|, |v251|
    v_cvt_pk_bf16_f32 v158, v124, v125
    v_cvt_pk_bf16_f32 v159, v126, v127
    v_med3_f32 v248, |v248|, |v249|, |v250|
    v_mfma_f32_16x16x32_bf16 v[208:211], a[8:11], v[152:155], v[208:211]
    buffer_load_dwordx4 v254, s[8:11], s20 offen offset:3072 nt lds
    ds_read_b64_tr_b16 a[88:89], v253 offset:264
    v_and_b32_e32 v248, 0x7f800000, v248
    v_mul_f32_e32 v251, s46, v248
    v_mul_f32_e32 v250, s46, v248
    v_mul_f32_e32 v249, s46, v248
    v_mfma_f32_16x16x32_bf16 v[208:211], a[12:15], v[156:159], v[208:211]
    ds_read_b64_tr_b16 a[90:91], v253 offset:4392
    v_mul_f32_e32 v248, s46, v248
    v_smfmac_f32_16x16x64_bf16 a[192:195], a[208:211], v[224:231], v245
    s_waitcnt lgkmcnt(6)
    ds_read_b64_tr_b16 a[96:97], v253 offset:512
    v_mfma_f32_16x16x32_bf16 v[0:3], a[64:67], v[224:227], v[248:251]
    ds_read_b64_tr_b16 a[98:99], v253 offset:4640
    v_max3_f32 v196, v208, v209, v210
    v_mfma_f32_16x16x32_bf16 v[0:3], a[68:71], v[228:231], v[0:3]
    ds_read_b64_tr_b16 a[100:101], v253 offset:8768
    v_max_f32_e32 v197, v196, v211
    v_mfma_f32_16x16x32_bf16 v[4:7], a[76:79], v[228:231], v[248:251]
    ds_read_b64_tr_b16 a[102:103], v253 offset:12896
    v_max_f32_e64 v196, v196, v211
    v_mfma_f32_16x16x32_bf16 v[4:7], a[72:75], v[224:227], v[4:7]
    ds_read_b64_tr_b16 a[108:109], v253 offset:8776
    v_mfma_f32_16x16x32_bf16 v[212:215], a[28:31], v[156:159], 0
    v_permlane32_swap_b32_e32 v196, v197
    v_mfma_f32_16x16x32_bf16 v[212:215], a[24:27], v[152:155], v[212:215]
    ds_read_b64_tr_b16 a[110:111], v253 offset:12904
    ds_read_b64_tr_b16 a[104:105], v253 offset:520
    v_mfma_f32_16x16x32_bf16 v[212:215], a[20:23], v[148:151], v[212:215]
    ds_read_b64_tr_b16 a[106:107], v253 offset:4648
    v_max_f32_e32 v198, v196, v197
    v_mfma_f32_16x16x32_bf16 v[212:215], a[16:19], v[144:147], v[212:215]
    s_waitcnt lgkmcnt(10)
    ds_read_b64_tr_b16 a[112:113], v253 offset:768
    v_max_f32_e32 v199, v196, v197
    v_mfma_f32_16x16x32_bf16 v[8:11], a[80:83], v[224:227], v[248:251]
    ds_read_b64_tr_b16 a[114:115], v253 offset:4896
    v_mfma_f32_16x16x32_bf16 v[8:11], a[84:87], v[228:231], v[8:11]
    v_permlane16_swap_b32_e32 v198, v199
    v_max_f32_e32 v199, v198, v199
    v_sub_f32_e32 v196, -4.0, v199
    v_sub_f32_e32 v197, -4.0, v199
    v_pk_mov_b32 v[198:199], v[196:197], v[196:197] op_sel:[0,1]
    v_pk_add_f32 v[208:209], v[208:209], v[196:197]
    v_pk_add_f32 v[210:211], v[210:211], v[196:197]
    v_pk_add_f32 v[212:213], v[212:213], v[196:197]
    v_pk_add_f32 v[214:215], v[214:215], v[196:197]
    v_mfma_f32_16x16x32_bf16 v[12:15], a[92:95], v[228:231], v[248:251]
    s_waitcnt lgkmcnt(9)
    v_exp_f32_e32 v208, v208
    v_mfma_f32_16x16x32_bf16 v[12:15], a[88:91], v[224:227], v[12:15]
    ds_read_b64_tr_b16 a[116:117], v253 offset:9024
    ds_read_b64_tr_b16 a[118:119], v253 offset:13152
    v_mfma_f32_16x16x32_bf16 v[216:219], a[32:35], v[144:147], v[196:199]
    ds_read_b64_tr_b16 a[124:125], v253 offset:9032
    ds_read_b64_tr_b16 a[126:127], v253 offset:13160
    v_mfma_f32_16x16x32_bf16 v[216:219], a[36:39], v[148:151], v[216:219]
    ds_read_b64_tr_b16 a[120:121], v253 offset:776
    ds_read_b64_tr_b16 a[122:123], v253 offset:4904
    v_mfma_f32_16x16x32_bf16 v[216:219], a[40:43], v[152:155], v[216:219]
    v_exp_f32_e32 v209, v209
    v_mfma_f32_16x16x32_bf16 v[216:219], a[44:47], v[156:159], v[216:219]
    s_waitcnt lgkmcnt(9)
    v_exp_f32_e32 v210, v210
    v_mfma_f32_16x16x32_bf16 v[16:19], a[96:99], v[224:227], v[248:251]
    v_exp_f32_e32 v211, v211
    v_mfma_f32_16x16x32_bf16 v[16:19], a[100:103], v[228:231], v[16:19]
    v_exp_f32_e32 v212, v212
    v_mfma_f32_16x16x32_bf16 v[20:23], a[108:111], v[228:231], v[248:251]
    s_waitcnt lgkmcnt(6)
    v_exp_f32_e64 v213, v213
    v_mfma_f32_16x16x32_bf16 v[20:23], a[104:107], v[224:227], v[20:23]
    s_mov_b32 m0, s78
    v_exp_f32_e32 v214, v214
    v_mfma_f32_16x16x32_bf16 v[220:223], a[60:63], v[156:159], v[196:199]
    s_waitcnt vmcnt(8)
    ds_read_b128 a[160:163], v255 offset:50688
    ds_read_b128 a[164:167], v255 offset:50944
    ds_read_b128 a[168:171], v255 offset:51200
    ds_read_b128 a[172:175], v255 offset:51456
    v_mfma_f32_16x16x32_bf16 v[220:223], a[56:59], v[152:155], v[220:223]
    buffer_load_dwordx4 v254, s[12:15], s20 offen nt lds
    v_mfma_f32_16x16x32_bf16 v[220:223], a[52:55], v[148:151], v[220:223]
    s_mov_b32 m0, s79
    v_exp_f32_e64 v215, v215
    v_mfma_f32_16x16x32_bf16 v[220:223], a[48:51], v[144:147], v[220:223]
    buffer_load_dwordx4 v254, s[12:15], s20 offen offset:1024 nt lds
    v_mfma_f32_16x16x32_bf16 v[24:27], a[112:115], v[224:227], v[248:251]
    s_waitcnt lgkmcnt(6)
    v_exp_f32_e32 v216, v216
    v_mfma_f32_16x16x32_bf16 v[24:27], a[116:119], v[228:231], v[24:27]
    s_mov_b32 m0, s80
    v_exp_f32_e32 v217, v217
    v_mfma_f32_16x16x32_bf16 v[28:31], a[124:127], v[228:231], v[248:251]
    s_waitcnt lgkmcnt(4)
    buffer_load_dwordx4 v254, s[12:15], s20 offen offset:2048 nt lds
    v_mfma_f32_16x16x32_bf16 v[28:31], a[120:123], v[224:227], v[28:31]
    s_waitcnt lgkmcnt(3)
    v_exp_f32_e64 v218, v218
    v_mfma_f32_4x4x4_16b_bf16 v[168:171], a[212:213], a[160:161], 0
    s_mov_b32 m0, s81
    v_cvt_pk_bf16_f32 v232, v208, v209
    v_mfma_f32_4x4x4_16b_bf16 v[200:203], a[212:213], a[162:163], 0
    v_cvt_pk_bf16_f32 v233, v210, v211
    v_mfma_f32_4x4x4_16b_bf16 v[168:171], a[214:215], a[160:161], v[168:171]
    s_waitcnt lgkmcnt(2)
    buffer_load_dwordx4 v254, s[12:15], s20 offen offset:3072 nt lds
    v_mfma_f32_4x4x4_16b_bf16 v[172:175], a[212:213], a[164:165], 0
    s_xor_b32 s20, s20, 49152
    v_cvt_pk_bf16_f32 v234, v212, v213
    v_mfma_f32_4x4x4_16b_bf16 v[200:203], a[214:215], a[162:163], v[200:203]
    v_cvt_pk_bf16_f32 v235, v214, v215
    v_mfma_f32_4x4x4_16b_bf16 v[124:127], a[212:213], a[166:167], 0
    v_cvt_pk_bf16_f32 v160, v168, v169
    v_mfma_f32_4x4x4_16b_bf16 v[172:175], a[214:215], a[164:165], v[172:175]
    s_waitcnt lgkmcnt(1)
    v_cvt_pk_bf16_f32 v161, v170, v171
    v_mfma_f32_4x4x4_16b_bf16 v[168:171], a[212:213], a[168:169], 0
    v_cvt_pk_bf16_f32 v162, v200, v201
    v_mfma_f32_4x4x4_16b_bf16 v[124:127], a[214:215], a[166:167], v[124:127]
    v_cvt_pk_bf16_f32 v163, v202, v203
    v_mfma_f32_4x4x4_16b_bf16 v[200:203], a[212:213], a[170:171], 0
    v_cvt_pk_bf16_f32 v164, v172, v173
    v_mfma_f32_4x4x4_16b_bf16 v[168:171], a[214:215], a[168:169], v[168:171]
    s_waitcnt lgkmcnt(0)
    v_cvt_pk_bf16_f32 v165, v174, v175
    v_mfma_f32_4x4x4_16b_bf16 v[172:175], a[212:213], a[172:173], 0
    v_cvt_pk_bf16_f32 v166, v124, v125
    v_mfma_f32_4x4x4_16b_bf16 v[200:203], a[214:215], a[170:171], v[200:203]
    v_exp_f32_e64 v219, v219
    v_cvt_pk_bf16_f32 v167, v126, v127
    v_mfma_f32_4x4x4_16b_bf16 v[124:127], a[212:213], a[174:175], 0
    v_exp_f32_e64 v220, v220
    v_mfma_f32_4x4x4_16b_bf16 v[172:175], a[214:215], a[172:173], v[172:175]
    v_exp_f32_e64 v221, v221
    v_cvt_pk_bf16_f32 v168, v168, v169
    v_mfma_f32_4x4x4_16b_bf16 v[124:127], a[214:215], a[174:175], v[124:127]
    v_exp_f32_e32 v222, v222
    v_cvt_pk_bf16_f32 v169, v170, v171
    v_mfma_f32_16x16x32_bf16 v[208:211], a[0:3], v[160:163], 0
    s_xor_b32 s21, s21, 49152
    v_exp_f32_e32 v223, v223
    v_cvt_pk_bf16_f32 v170, v200, v201
    v_cvt_pk_bf16_f32 v171, v202, v203
    v_cvt_pk_bf16_f32 v172, v172, v173
    v_cvt_pk_bf16_f32 v173, v174, v175
    v_mfma_f32_16x16x32_bf16 v[208:211], a[4:7], v[164:167], v[208:211]
    s_ashr_i32 s49, s25, 31
    v_cvt_pk_bf16_f32 v174, v124, v125
    v_cvt_pk_bf16_f32 v175, v126, v127
    v_mfma_f32_16x16x32_bf16 v[208:211], a[8:11], v[168:171], v[208:211]
    s_add_u32 s21, s21, 16777216
    v_cvt_pk_bf16_f32 v236, v216, v217
    v_cvt_pk_bf16_f32 v237, v218, v219
    v_cvt_pk_bf16_f32 v238, v220, v221
    v_cvt_pk_bf16_f32 v239, v222, v223
    v_mfma_f32_16x16x32_bf16 v[208:211], a[12:15], v[172:175], v[208:211]
    s_and_b32 s21, s21, s49
    v_mbcnt_lo_u32_b32 v255, -1, 0
    v_mbcnt_hi_u32_b32 v255, -1, v255
    v_smfmac_f32_16x16x64_bf16 a[196:199], a[208:211], v[232:239], v245
    s_and_b32 s6, s6, s49
    v_lshlrev_b32_e32 v255, 4, v255
    v_mfma_f32_16x16x32_bf16 v[32:35], a[64:67], v[232:235], v[248:251]
    v_max3_f32 v200, v208, v209, v210
    v_max_f32_e64 v201, v200, v211
    v_mfma_f32_16x16x32_bf16 v[32:35], a[68:71], v[236:239], v[32:35]
    v_max_f32_e64 v200, v200, v211
    v_mfma_f32_16x16x32_bf16 v[36:39], a[76:79], v[236:239], v[248:251]
    v_mfma_f32_16x16x32_bf16 v[36:39], a[72:75], v[232:235], v[36:39]
    v_permlane32_swap_b32_e32 v200, v201
    v_mfma_f32_16x16x32_bf16 v[212:215], a[28:31], v[172:175], 0
    v_max_f32_e64 v202, v200, v201
    v_max_f32_e32 v203, v200, v201
    v_mfma_f32_16x16x32_bf16 v[212:215], a[24:27], v[168:171], v[212:215]
    v_mfma_f32_16x16x32_bf16 v[212:215], a[20:23], v[164:167], v[212:215]
    v_mfma_f32_16x16x32_bf16 v[212:215], a[16:19], v[160:163], v[212:215]
    v_mfma_f32_16x16x32_bf16 v[40:43], a[80:83], v[232:235], v[248:251]
    v_mfma_f32_16x16x32_bf16 v[40:43], a[84:87], v[236:239], v[40:43]
    v_permlane16_swap_b32_e32 v202, v203
    v_max_f32_e32 v203, v202, v203
    v_sub_f32_e32 v200, -4.0, v203
    v_sub_f32_e32 v201, -4.0, v203
    v_pk_mov_b32 v[202:203], v[200:201], v[200:201] op_sel:[0,1]
    v_pk_add_f32 v[208:209], v[208:209], v[200:201]
    v_pk_add_f32 v[210:211], v[210:211], v[200:201]
    v_pk_add_f32 v[212:213], v[212:213], v[200:201]
    v_pk_add_f32 v[214:215], v[214:215], v[200:201]
    v_mfma_f32_16x16x32_bf16 v[44:47], a[92:95], v[236:239], v[248:251]
    v_exp_f32_e32 v208, v208
    v_mfma_f32_16x16x32_bf16 v[44:47], a[88:91], v[232:235], v[44:47]
    v_exp_f32_e32 v209, v209
    v_mfma_f32_16x16x32_bf16 v[216:219], a[32:35], v[160:163], v[200:203]
    v_exp_f32_e32 v210, v210
    v_mfma_f32_16x16x32_bf16 v[216:219], a[36:39], v[164:167], v[216:219]
    v_exp_f32_e32 v211, v211
    v_mfma_f32_16x16x32_bf16 v[216:219], a[40:43], v[168:171], v[216:219]
    v_exp_f32_e32 v212, v212
    v_mfma_f32_16x16x32_bf16 v[216:219], a[44:47], v[172:175], v[216:219]
    v_exp_f32_e32 v213, v213
    v_mfma_f32_16x16x32_bf16 v[48:51], a[96:99], v[232:235], v[248:251]
    v_exp_f32_e32 v214, v214
    v_mfma_f32_16x16x32_bf16 v[48:51], a[100:103], v[236:239], v[48:51]
    v_exp_f32_e32 v215, v215
    v_mfma_f32_16x16x32_bf16 v[52:55], a[108:111], v[236:239], v[248:251]
    v_exp_f32_e64 v216, v216
    v_mfma_f32_16x16x32_bf16 v[52:55], a[104:107], v[232:235], v[52:55]
    s_mov_b32 m0, s82
    v_exp_f32_e32 v217, v217
    v_mfma_f32_16x16x32_bf16 v[220:223], a[60:63], v[172:175], v[200:203]
    s_waitcnt vmcnt(8)
    ds_read_b128 a[176:179], v246 offset:0
    ds_read_b128 a[180:183], v246 offset:256
    ds_read_b128 a[184:187], v246 offset:512
    ds_read_b128 a[188:191], v246 offset:768
    v_mfma_f32_16x16x32_bf16 v[220:223], a[56:59], v[168:171], v[220:223]
    buffer_load_dwordx4 v254, s[8:11], s20 offen nt lds
    v_mfma_f32_16x16x32_bf16 v[220:223], a[52:55], v[164:167], v[220:223]
    s_mov_b32 m0, s83
    v_exp_f32_e64 v218, v218
    v_mfma_f32_16x16x32_bf16 v[220:223], a[48:51], v[160:163], v[220:223]
    buffer_load_dwordx4 v254, s[8:11], s20 offen offset:1024 nt lds
    v_mfma_f32_16x16x32_bf16 v[56:59], a[112:115], v[232:235], v[248:251]
    s_mov_b32 m0, s84
    v_exp_f32_e32 v219, v219
    v_mfma_f32_16x16x32_bf16 v[56:59], a[116:119], v[236:239], v[56:59]
    buffer_load_dwordx4 v254, s[8:11], s20 offen offset:2048 nt lds
    v_mfma_f32_16x16x32_bf16 v[60:63], a[124:127], v[236:239], v[248:251]
    s_mov_b32 m0, s85
    v_exp_f32_e32 v220, v220
    v_mfma_f32_16x16x32_bf16 v[60:63], a[120:123], v[232:235], v[60:63]
    s_waitcnt lgkmcnt(3)
    buffer_load_dwordx4 v254, s[8:11], s20 offen offset:3072 nt lds
    v_mfma_f32_4x4x4_16b_bf16 v[184:187], a[212:213], a[176:177], 0
    v_cvt_pk_bf16_f32 v224, v208, v209
    v_mfma_f32_4x4x4_16b_bf16 v[204:207], a[212:213], a[178:179], 0
    v_cvt_pk_bf16_f32 v225, v210, v211
    v_mfma_f32_4x4x4_16b_bf16 v[184:187], a[214:215], a[176:177], v[184:187]
    s_waitcnt lgkmcnt(2)
    v_cvt_pk_bf16_f32 v226, v212, v213
    v_mfma_f32_4x4x4_16b_bf16 v[188:191], a[212:213], a[180:181], 0
    v_cvt_pk_bf16_f32 v227, v214, v215
    v_mfma_f32_4x4x4_16b_bf16 v[204:207], a[214:215], a[178:179], v[204:207]
    v_cvt_pk_bf16_f32 v228, v216, v217
    v_mfma_f32_4x4x4_16b_bf16 v[124:127], a[212:213], a[182:183], 0
    v_cvt_pk_bf16_f32 v176, v184, v185
    v_mfma_f32_4x4x4_16b_bf16 v[188:191], a[214:215], a[180:181], v[188:191]
    s_waitcnt lgkmcnt(1)
    v_cvt_pk_bf16_f32 v177, v186, v187
    v_mfma_f32_4x4x4_16b_bf16 v[184:187], a[212:213], a[184:185], 0
    v_cvt_pk_bf16_f32 v178, v204, v205
    v_mfma_f32_4x4x4_16b_bf16 v[124:127], a[214:215], a[182:183], v[124:127]
    v_cvt_pk_bf16_f32 v179, v206, v207
    v_mfma_f32_4x4x4_16b_bf16 v[204:207], a[212:213], a[186:187], 0
    v_cvt_pk_bf16_f32 v180, v188, v189
    v_mfma_f32_4x4x4_16b_bf16 v[184:187], a[214:215], a[184:185], v[184:187]
    s_waitcnt lgkmcnt(0)
    v_cvt_pk_bf16_f32 v181, v190, v191
    v_mfma_f32_4x4x4_16b_bf16 v[188:191], a[212:213], a[188:189], 0
    v_cvt_pk_bf16_f32 v182, v124, v125
    v_mfma_f32_4x4x4_16b_bf16 v[204:207], a[214:215], a[186:187], v[204:207]
    v_cvt_pk_bf16_f32 v183, v126, v127
    v_mfma_f32_4x4x4_16b_bf16 v[124:127], a[212:213], a[190:191], 0
    v_cvt_pk_bf16_f32 v184, v184, v185
    v_mfma_f32_4x4x4_16b_bf16 v[188:191], a[214:215], a[188:189], v[188:191]
    v_exp_f32_e64 v221, v221
    v_mfma_f32_4x4x4_16b_bf16 v[124:127], a[214:215], a[190:191], v[124:127]
    v_exp_f32_e32 v222, v222
    v_cvt_pk_bf16_f32 v185, v186, v187
    v_mfma_f32_16x16x32_bf16 v[208:211], a[0:3], v[176:179], 0
    s_mov_b32 m0, s86
    v_exp_f32_e32 v223, v223
    v_cvt_pk_bf16_f32 v186, v204, v205
    v_cvt_pk_bf16_f32 v187, v206, v207
    v_cvt_pk_bf16_f32 v188, v188, v189
    v_cvt_pk_bf16_f32 v189, v190, v191
    v_mfma_f32_16x16x32_bf16 v[208:211], a[4:7], v[180:183], v[208:211]
    v_cvt_pk_bf16_f32 v190, v124, v125
    v_cvt_pk_bf16_f32 v191, v126, v127
    v_mfma_f32_16x16x32_bf16 v[208:211], a[8:11], v[184:187], v[208:211]
    s_waitcnt vmcnt(8)
    v_cvt_pk_bf16_f32 v229, v218, v219
    v_cvt_pk_bf16_f32 v230, v220, v221
    v_cvt_pk_bf16_f32 v231, v222, v223
    v_mfma_f32_16x16x32_bf16 v[208:211], a[12:15], v[188:191], v[208:211]
    s_barrier
    buffer_load_dwordx4 v254, s[12:15], s20 offen nt lds
    v_smfmac_f32_16x16x64_bf16 a[200:203], a[208:211], v[224:231], v245
    s_mov_b32 m0, s87
    ds_read_b128 a[0:3], v252 offset:16896
    v_mfma_f32_16x16x32_bf16 v[64:67], a[64:67], v[224:227], v[248:251]
    ds_read_b128 a[4:7], v252 offset:17152
    v_max3_f32 v204, v208, v209, v210
    v_mfma_f32_16x16x32_bf16 v[64:67], a[68:71], v[228:231], v[64:67]
    ds_read_b128 a[8:11], v252 offset:17408
    v_max_f32_e64 v205, v204, v211
    v_mfma_f32_16x16x32_bf16 v[68:71], a[76:79], v[228:231], v[248:251]
    ds_read_b128 a[12:15], v252 offset:17664
    v_max_f32_e64 v204, v204, v211
    v_mfma_f32_16x16x32_bf16 v[68:71], a[72:75], v[224:227], v[68:71]
    buffer_load_dwordx4 v254, s[12:15], s20 offen offset:1024 nt lds
    v_mfma_f32_16x16x32_bf16 v[212:215], a[28:31], v[188:191], 0
    s_mov_b32 m0, s88
    v_permlane32_swap_b32_e32 v204, v205
    v_mfma_f32_16x16x32_bf16 v[212:215], a[24:27], v[184:187], v[212:215]
    ds_read_b128 a[28:31], v252 offset:21888
    v_max_f32_e64 v206, v204, v205
    v_mfma_f32_16x16x32_bf16 v[212:215], a[20:23], v[180:183], v[212:215]
    ds_read_b128 a[24:27], v252 offset:21632
    v_max_f32_e64 v207, v204, v205
    v_mfma_f32_16x16x32_bf16 v[212:215], a[16:19], v[176:179], v[212:215]
    buffer_load_dwordx4 v254, s[12:15], s20 offen offset:2048 nt lds
    v_mfma_f32_16x16x32_bf16 v[72:75], a[80:83], v[224:227], v[248:251]
    s_mov_b32 m0, s89
    ds_read_b128 a[20:23], v252 offset:21376
    v_mfma_f32_16x16x32_bf16 v[72:75], a[84:87], v[228:231], v[72:75]
    v_permlane16_swap_b32_e32 v206, v207
    v_max_f32_e64 v207, v206, v207
    v_sub_f32_e32 v204, -4.0, v207
    v_sub_f32_e32 v205, -4.0, v207
    v_pk_mov_b32 v[206:207], v[204:205], v[204:205] op_sel:[0,1]
    v_pk_add_f32 v[208:209], v[208:209], v[204:205]
    v_pk_add_f32 v[210:211], v[210:211], v[204:205]
    v_pk_add_f32 v[212:213], v[212:213], v[204:205]
    v_pk_add_f32 v[214:215], v[214:215], v[204:205]
    v_mfma_f32_16x16x32_bf16 v[76:79], a[92:95], v[228:231], v[248:251]
    buffer_load_dwordx4 v254, s[12:15], s20 offen offset:3072 nt lds
    v_mfma_f32_16x16x32_bf16 v[76:79], a[88:91], v[224:227], v[76:79]
    s_xor_b32 s20, s20, 16384
    v_exp_f32_e32 v208, v208
    v_mfma_f32_16x16x32_bf16 v[216:219], a[32:35], v[176:179], v[204:207]
    v_exp_f32_e32 v209, v209
    v_mfma_f32_16x16x32_bf16 v[216:219], a[36:39], v[180:183], v[216:219]
    v_exp_f32_e32 v210, v210
    v_mfma_f32_16x16x32_bf16 v[216:219], a[40:43], v[184:187], v[216:219]
    v_exp_f32_e32 v211, v211
    v_mfma_f32_16x16x32_bf16 v[216:219], a[44:47], v[188:191], v[216:219]
    v_exp_f32_e32 v212, v212
    v_mfma_f32_16x16x32_bf16 v[80:83], a[96:99], v[224:227], v[248:251]
    v_exp_f32_e32 v213, v213
    v_mfma_f32_16x16x32_bf16 v[80:83], a[100:103], v[228:231], v[80:83]
    v_exp_f32_e32 v214, v214
    v_mfma_f32_16x16x32_bf16 v[84:87], a[108:111], v[228:231], v[248:251]
    v_exp_f32_e32 v215, v215
    v_mfma_f32_16x16x32_bf16 v[84:87], a[104:107], v[224:227], v[84:87]
    ds_read_b128 a[16:19], v252 offset:21120
    v_cvt_pk_bf16_f32 v232, v208, v209
    v_mfma_f32_16x16x32_bf16 v[220:223], a[60:63], v[188:191], v[204:207]
    ds_read_b128 a[32:35], v252 offset:25344
    v_cvt_pk_bf16_f32 v233, v210, v211
    v_mfma_f32_16x16x32_bf16 v[220:223], a[56:59], v[184:187], v[220:223]
    ds_read_b128 a[36:39], v252 offset:25600
    v_cvt_pk_bf16_f32 v234, v212, v213
    v_mfma_f32_16x16x32_bf16 v[220:223], a[52:55], v[180:183], v[220:223]
    ds_read_b128 a[40:43], v252 offset:25856
    v_cvt_pk_bf16_f32 v235, v214, v215
    v_mfma_f32_16x16x32_bf16 v[220:223], a[48:51], v[176:179], v[220:223]
    v_exp_f32_e32 v216, v216
    v_mfma_f32_16x16x32_bf16 v[88:91], a[112:115], v[224:227], v[248:251]
    v_exp_f32_e32 v217, v217
    v_mfma_f32_16x16x32_bf16 v[88:91], a[116:119], v[228:231], v[88:91]
    v_exp_f32_e32 v218, v218
    v_mfma_f32_16x16x32_bf16 v[92:95], a[124:127], v[228:231], v[248:251]
    v_exp_f32_e32 v219, v219
    v_mfma_f32_16x16x32_bf16 v[92:95], a[120:123], v[224:227], v[92:95]
    s_waitcnt lgkmcnt(4)
    ds_read_b128 a[44:47], v252 offset:26112
    v_cvt_pk_bf16_f32 v236, v216, v217
    v_mfma_f32_16x16x32_bf16 v[208:211], a[0:3], v[128:131], v[192:195]
    ds_read_b128 a[60:63], v252 offset:30336
    v_cvt_pk_bf16_f32 v237, v218, v219
    v_mfma_f32_16x16x32_bf16 v[208:211], a[4:7], v[132:135], v[208:211]
    ds_read_b128 a[56:59], v252 offset:30080
    v_mfma_f32_16x16x32_bf16 v[208:211], a[8:11], v[136:139], v[208:211]
    s_waitcnt vmcnt(8)
    ds_read_b128 a[52:55], v252 offset:29824
    v_mfma_f32_16x16x32_bf16 v[208:211], a[12:15], v[140:143], v[208:211]
    s_barrier
    v_exp_f32_e32 v220, v220
    v_mfma_f32_16x16x32_bf16 v[212:215], a[28:31], v[140:143], v[192:195]
    ds_read_b128 a[48:51], v252 offset:29568
    v_exp_f32_e32 v221, v221
    v_mfma_f32_16x16x32_bf16 v[212:215], a[24:27], v[136:139], v[212:215]
    v_exp_f32_e32 v222, v222
    v_mfma_f32_16x16x32_bf16 v[212:215], a[20:23], v[132:135], v[212:215]
    s_waitcnt lgkmcnt(5)
    v_exp_f32_e32 v223, v223
    v_mfma_f32_16x16x32_bf16 v[212:215], a[16:19], v[128:131], v[212:215]
    ds_read_b64_tr_b16 a[224:225], v253 offset:16512
    v_cvt_pk_bf16_f32 v238, v220, v221
    v_mfma_f32_16x16x32_bf16 v[216:219], a[32:35], v[128:131], v[192:195]
    ds_read_b64_tr_b16 a[226:227], v253 offset:20640
    v_cvt_pk_bf16_f32 v239, v222, v223
    v_mfma_f32_16x16x32_bf16 v[216:219], a[36:39], v[132:135], v[216:219]
    v_exp_f32_e32 v208, v208
    v_mfma_f32_16x16x32_bf16 v[216:219], a[40:43], v[136:139], v[216:219]
    s_waitcnt lgkmcnt(6)
    v_exp_f32_e32 v209, v209
    v_mfma_f32_16x16x32_bf16 v[216:219], a[44:47], v[140:143], v[216:219]
    s_waitcnt lgkmcnt(5)
    v_exp_f32_e32 v210, v210
    v_mfma_f32_16x16x32_bf16 v[220:223], a[60:63], v[140:143], v[192:195]
    s_waitcnt lgkmcnt(4)
    v_exp_f32_e32 v211, v211
    v_mfma_f32_16x16x32_bf16 v[220:223], a[56:59], v[136:139], v[220:223]
    s_waitcnt lgkmcnt(3)
    v_exp_f32_e32 v212, v212
    v_mfma_f32_16x16x32_bf16 v[220:223], a[52:55], v[132:135], v[220:223]
    s_waitcnt lgkmcnt(2)
    v_exp_f32_e32 v213, v213
    v_mfma_f32_16x16x32_bf16 v[220:223], a[48:51], v[128:131], v[220:223]
    v_exp_f32_e32 v214, v214
    v_smfmac_f32_16x16x64_bf16 a[204:207], a[208:211], v[232:239], v245
    v_cvt_pk_bf16_f32 v224, v208, v209
    v_mfma_f32_16x16x32_bf16 v[96:99], a[64:67], v[232:235], v[248:251]
    v_exp_f32_e32 v215, v215
    v_mfma_f32_16x16x32_bf16 v[96:99], a[68:71], v[236:239], v[96:99]
    ds_read_b64_tr_b16 a[228:229], v253 offset:24768
    v_cvt_pk_bf16_f32 v225, v210, v211
    v_mfma_f32_16x16x32_bf16 v[100:103], a[76:79], v[236:239], v[248:251]
    v_exp_f32_e32 v216, v216
    v_mfma_f32_16x16x32_bf16 v[100:103], a[72:75], v[232:235], v[100:103]
    v_exp_f32_e32 v217, v217
    v_mfma_f32_16x16x32_bf16 v[104:107], a[80:83], v[232:235], v[248:251]
    v_exp_f32_e32 v218, v218
    v_mfma_f32_16x16x32_bf16 v[104:107], a[84:87], v[236:239], v[104:107]
    v_exp_f32_e32 v219, v219
    v_mfma_f32_16x16x32_bf16 v[108:111], a[92:95], v[236:239], v[248:251]
    ds_read_b64_tr_b16 a[230:231], v253 offset:28896
    v_cvt_pk_bf16_f32 v226, v212, v213
    v_mfma_f32_16x16x32_bf16 v[108:111], a[88:91], v[232:235], v[108:111]
    ds_read_b64_tr_b16 a[236:237], v253 offset:24776
    v_cvt_pk_bf16_f32 v227, v214, v215
    v_mfma_f32_16x16x32_bf16 v[112:115], a[96:99], v[232:235], v[248:251]
    v_exp_f32_e32 v220, v220
    v_mfma_f32_16x16x32_bf16 v[112:115], a[100:103], v[236:239], v[112:115]
    v_exp_f32_e32 v221, v221
    v_mfma_f32_16x16x32_bf16 v[116:119], a[108:111], v[236:239], v[248:251]
    v_exp_f32_e32 v222, v222
    v_mfma_f32_16x16x32_bf16 v[116:119], a[104:107], v[232:235], v[116:119]
    v_exp_f32_e32 v223, v223
    v_mfma_f32_16x16x32_bf16 v[120:123], a[112:115], v[232:235], v[248:251]
    ds_read_b64_tr_b16 a[238:239], v253 offset:28904
    v_cvt_pk_bf16_f32 v228, v216, v217
    v_mfma_f32_16x16x32_bf16 v[120:123], a[116:119], v[236:239], v[120:123]
    ds_read_b64_tr_b16 a[232:233], v253 offset:16520
    v_cvt_pk_bf16_f32 v229, v218, v219
    v_mfma_f32_16x16x32_bf16 v[124:127], a[124:127], v[236:239], v[248:251]
    s_mov_b32 m0, s67
    ds_read_b64_tr_b16 a[234:235], v253 offset:20648
    v_cvt_pk_bf16_f32 v230, v220, v221
    v_mfma_f32_16x16x32_bf16 v[124:127], a[120:123], v[232:235], v[124:127]
    ds_read_b64_tr_b16 a[240:241], v253 offset:16768
    v_cvt_pk_bf16_f32 v231, v222, v223
    v_mfma_f32_16x16x32_bf16 v[208:211], a[0:3], v[144:147], v[196:199]
    s_add_u32 s44, s44, 1
    buffer_load_dwordx4 v254, s[8:11], s20 offen nt lds
    v_mfma_f32_16x16x32_bf16 v[208:211], a[4:7], v[148:151], v[208:211]
    ds_read_b64_tr_b16 a[242:243], v253 offset:20896
    v_mfma_f32_16x16x32_bf16 v[208:211], a[8:11], v[152:155], v[208:211]
    ds_read_b64_tr_b16 a[244:245], v253 offset:25024
    v_mfma_f32_16x16x32_bf16 v[208:211], a[12:15], v[156:159], v[208:211]
    ds_read_b64_tr_b16 a[246:247], v253 offset:29152
    v_mfma_f32_16x16x32_bf16 v[212:215], a[28:31], v[156:159], v[196:199]
    ds_read_b64_tr_b16 a[252:253], v253 offset:25032
    v_mfma_f32_16x16x32_bf16 v[212:215], a[24:27], v[152:155], v[212:215]
    v_exp_f32_e32 v208, v208
    v_mfma_f32_16x16x32_bf16 v[212:215], a[20:23], v[148:151], v[212:215]
    s_mov_b32 m0, s68
    v_exp_f32_e32 v209, v209
    v_mfma_f32_16x16x32_bf16 v[212:215], a[16:19], v[144:147], v[212:215]
    ds_read_b64_tr_b16 a[254:255], v253 offset:29160
    v_cvt_pk_bf16_f32 v232, v208, v209
    v_mfma_f32_16x16x32_bf16 v[216:219], a[32:35], v[144:147], v[196:199]
    ds_read_b64_tr_b16 a[248:249], v253 offset:16776
    v_mov_b32_e32 v244, s44
    v_mfma_f32_16x16x32_bf16 v[216:219], a[36:39], v[148:151], v[216:219]
    buffer_load_dwordx4 v254, s[8:11], s20 offen offset:1024 nt lds
    v_mfma_f32_16x16x32_bf16 v[216:219], a[40:43], v[152:155], v[216:219]
    v_exp_f32_e32 v210, v210
    v_mfma_f32_16x16x32_bf16 v[216:219], a[44:47], v[156:159], v[216:219]
    ds_read_b64_tr_b16 a[250:251], v253 offset:20904
    ds_read_b64_tr_b16 a[96:97], v253 offset:17024
    v_mfma_f32_16x16x32_bf16 v[220:223], a[60:63], v[156:159], v[196:199]
    ds_read_b64_tr_b16 a[98:99], v253 offset:21152
    ds_read_b64_tr_b16 a[100:101], v253 offset:25280
    v_mfma_f32_16x16x32_bf16 v[220:223], a[56:59], v[152:155], v[220:223]
    s_waitcnt vmcnt(2)
    ds_read_b64_tr_b16 a[102:103], v253 offset:29408
    ds_read_b64_tr_b16 a[108:109], v253 offset:25288
    v_mfma_f32_16x16x32_bf16 v[220:223], a[52:55], v[148:151], v[220:223]
    s_mov_b32 m0, s45
    ds_read_b64_tr_b16 a[110:111], v253 offset:29416
    ds_read_b64_tr_b16 a[104:105], v253 offset:17032
    v_mfma_f32_16x16x32_bf16 v[220:223], a[48:51], v[144:147], v[220:223]
    ds_read_b64_tr_b16 a[106:107], v253 offset:21160
    ds_read_b64_tr_b16 a[112:113], v253 offset:17280
    v_smfmac_f32_16x16x64_bf16 a[192:195], a[208:211], v[224:231], v245
    s_waitcnt lgkmcnt(12)
    ds_read_b64_tr_b16 a[114:115], v253 offset:21408
    v_mfma_f32_16x16x32_bf16 v[0:3], a[224:227], v[224:227], v[0:3]
    ds_read_b64_tr_b16 a[116:117], v253 offset:25536
    ds_read_b64_tr_b16 a[118:119], v253 offset:29664
    v_mfma_f32_16x16x32_bf16 v[0:3], a[228:231], v[228:231], v[0:3]
    ds_read_b64_tr_b16 a[124:125], v253 offset:25544
    ds_read_b64_tr_b16 a[126:127], v253 offset:29672
    v_mfma_f32_16x16x32_bf16 v[4:7], a[236:239], v[228:231], v[4:7]
    ds_write_addtid_b32 v244
    ds_read_b64_tr_b16 a[120:121], v253 offset:17288
    v_mfma_f32_16x16x32_bf16 v[4:7], a[232:235], v[224:227], v[4:7]
    ds_read_b64_tr_b16 a[122:123], v253 offset:21416
    v_mfma_f32_16x16x32_bf16 v[8:11], a[240:243], v[224:227], v[8:11]
    v_exp_f32_e32 v211, v211
    v_mfma_f32_16x16x32_bf16 v[8:11], a[244:247], v[228:231], v[8:11]
    s_waitcnt lgkmcnt(15)
    v_exp_f32_e32 v212, v212
    v_mfma_f32_16x16x32_bf16 v[12:15], a[252:255], v[228:231], v[12:15]
    v_exp_f32_e32 v213, v213
    v_mfma_f32_16x16x32_bf16 v[12:15], a[248:251], v[224:227], v[12:15]
    v_exp_f32_e32 v214, v214
    v_mfma_f32_16x16x32_bf16 v[16:19], a[96:99], v[224:227], v[16:19]
    s_waitcnt lgkmcnt(12)
    v_exp_f32_e32 v215, v215
    v_mfma_f32_16x16x32_bf16 v[16:19], a[100:103], v[228:231], v[16:19]
    s_waitcnt lgkmcnt(10)
    v_cvt_pk_bf16_f32 v233, v210, v211
    v_cvt_pk_bf16_f32 v234, v212, v213
    v_mfma_f32_16x16x32_bf16 v[20:23], a[108:111], v[228:231], v[20:23]
    s_waitcnt lgkmcnt(8)
    v_exp_f32_e32 v216, v216
    v_mfma_f32_16x16x32_bf16 v[20:23], a[104:107], v[224:227], v[20:23]
    s_waitcnt lgkmcnt(7)
    v_exp_f32_e32 v217, v217
    v_mfma_f32_16x16x32_bf16 v[24:27], a[112:115], v[224:227], v[24:27]
    s_waitcnt lgkmcnt(5)
    v_exp_f32_e32 v218, v218
    v_mfma_f32_16x16x32_bf16 v[24:27], a[116:119], v[228:231], v[24:27]
    s_waitcnt lgkmcnt(3)
    v_exp_f32_e32 v219, v219
    v_mfma_f32_16x16x32_bf16 v[28:31], a[124:127], v[228:231], v[28:31]
    s_waitcnt lgkmcnt(0)
    v_cvt_pk_bf16_f32 v235, v214, v215
    v_cvt_pk_bf16_f32 v236, v216, v217
    v_mfma_f32_16x16x32_bf16 v[28:31], a[120:123], v[224:227], v[28:31]
    s_mov_b32 m0, s69
    v_exp_f32_e32 v220, v220
    v_mfma_f32_16x16x32_bf16 v[208:211], a[0:3], v[160:163], v[200:203]
    buffer_load_dwordx4 v254, s[8:11], s20 offen offset:2048 nt lds
    v_mfma_f32_16x16x32_bf16 v[208:211], a[4:7], v[164:167], v[208:211]
    s_mov_b32 m0, s70
    v_exp_f32_e32 v221, v221
    v_mfma_f32_16x16x32_bf16 v[208:211], a[8:11], v[168:171], v[208:211]
    v_exp_f32_e32 v222, v222
    v_mfma_f32_16x16x32_bf16 v[208:211], a[12:15], v[172:175], v[208:211]
    v_exp_f32_e32 v223, v223
    v_mfma_f32_16x16x32_bf16 v[212:215], a[28:31], v[172:175], v[200:203]
    v_cvt_pk_bf16_f32 v237, v218, v219
    v_cvt_pk_bf16_f32 v238, v220, v221
    v_mfma_f32_16x16x32_bf16 v[212:215], a[24:27], v[168:171], v[212:215]
    buffer_load_dwordx4 v254, s[8:11], s20 offen offset:3072 nt lds
    v_mfma_f32_16x16x32_bf16 v[212:215], a[20:23], v[164:167], v[212:215]
    s_mov_b32 m0, s90
    v_exp_f32_e32 v208, v208
    v_mfma_f32_16x16x32_bf16 v[212:215], a[16:19], v[160:163], v[212:215]
    v_exp_f32_e32 v209, v209
    v_mfma_f32_16x16x32_bf16 v[216:219], a[32:35], v[160:163], v[200:203]
    v_cvt_pk_bf16_f32 v239, v222, v223
    v_cvt_pk_bf16_f32 v224, v208, v209
    v_mfma_f32_16x16x32_bf16 v[216:219], a[36:39], v[164:167], v[216:219]
    v_exp_f32_e32 v210, v210
    v_mfma_f32_16x16x32_bf16 v[216:219], a[40:43], v[168:171], v[216:219]
    v_exp_f32_e32 v211, v211
    v_mfma_f32_16x16x32_bf16 v[216:219], a[44:47], v[172:175], v[216:219]
    buffer_load_dwordx4 v254, s[12:15], s20 offen nt lds
    v_mfma_f32_16x16x32_bf16 v[220:223], a[60:63], v[172:175], v[200:203]
    v_exp_f32_e32 v212, v212
    v_mfma_f32_16x16x32_bf16 v[220:223], a[56:59], v[168:171], v[220:223]
    v_exp_f32_e32 v213, v213
    v_mfma_f32_16x16x32_bf16 v[220:223], a[52:55], v[164:167], v[220:223]
    s_mov_b32 m0, s91
    v_exp_f32_e32 v214, v214
    v_mfma_f32_16x16x32_bf16 v[220:223], a[48:51], v[160:163], v[220:223]
    v_exp_f32_e32 v215, v215
    v_smfmac_f32_16x16x64_bf16 a[196:199], a[208:211], v[232:239], v245
    v_cvt_pk_bf16_f32 v225, v210, v211
    v_mfma_f32_16x16x32_bf16 v[32:35], a[224:227], v[232:235], v[32:35]
    v_exp_f32_e32 v216, v216
    v_mfma_f32_16x16x32_bf16 v[32:35], a[228:231], v[236:239], v[32:35]
    ds_read_b32 v244, v255
    v_cvt_pk_bf16_f32 v226, v212, v213
    v_mfma_f32_16x16x32_bf16 v[36:39], a[236:239], v[236:239], v[36:39]
    v_exp_f32_e32 v217, v217
    v_mfma_f32_16x16x32_bf16 v[36:39], a[232:235], v[232:235], v[36:39]
    v_exp_f32_e32 v218, v218
    v_mfma_f32_16x16x32_bf16 v[40:43], a[240:243], v[232:235], v[40:43]
    v_exp_f32_e32 v219, v219
    v_mfma_f32_16x16x32_bf16 v[40:43], a[244:247], v[236:239], v[40:43]
    v_cvt_pk_bf16_f32 v227, v214, v215
    v_cvt_pk_bf16_f32 v228, v216, v217
    v_mfma_f32_16x16x32_bf16 v[44:47], a[252:255], v[236:239], v[44:47]
    buffer_load_dwordx4 v254, s[12:15], s20 offen offset:1024 nt lds
    v_mfma_f32_16x16x32_bf16 v[44:47], a[248:251], v[232:235], v[44:47]
    s_mov_b32 m0, s92
    v_exp_f32_e32 v220, v220
    v_mfma_f32_16x16x32_bf16 v[48:51], a[96:99], v[232:235], v[48:51]
    v_exp_f32_e32 v221, v221
    v_mfma_f32_16x16x32_bf16 v[48:51], a[100:103], v[236:239], v[48:51]
    s_waitcnt lgkmcnt(0)
    v_cmp_gt_u32_e32 vcc, s44, v244
    v_cvt_pk_bf16_f32 v229, v218, v219
    v_mfma_f32_16x16x32_bf16 v[52:55], a[108:111], v[236:239], v[52:55]
    v_exp_f32_e32 v222, v222
    v_mfma_f32_16x16x32_bf16 v[52:55], a[104:107], v[232:235], v[52:55]
    s_cbranch_vccnz L_rt0
L_bk0:
    v_exp_f32_e32 v223, v223
    v_mfma_f32_16x16x32_bf16 v[56:59], a[112:115], v[232:235], v[56:59]
    ds_read_b64_tr_b16 a[64:65], v253 offset:33024
    v_cvt_pk_bf16_f32 v230, v220, v221
    v_mfma_f32_16x16x32_bf16 v[56:59], a[116:119], v[236:239], v[56:59]
    ds_read_b64_tr_b16 a[66:67], v253 offset:37152
    v_cvt_pk_bf16_f32 v231, v222, v223
    v_mfma_f32_16x16x32_bf16 v[60:63], a[124:127], v[236:239], v[60:63]
    buffer_load_dwordx4 v254, s[12:15], s20 offen offset:2048 nt lds
    v_mfma_f32_16x16x32_bf16 v[60:63], a[120:123], v[232:235], v[60:63]
    s_mov_b32 m0, s93
    ds_read_b64_tr_b16 a[68:69], v253 offset:41280
    v_mfma_f32_16x16x32_bf16 v[208:211], a[0:3], v[176:179], v[204:207]
    buffer_load_dwordx4 v254, s[12:15], s20 offen offset:3072 nt lds
    v_mfma_f32_16x16x32_bf16 v[208:211], a[4:7], v[180:183], v[208:211]
    s_xor_b32 s20, s20, 114688
    ds_read_b128 a[0:3], v252 offset:33792
    v_mfma_f32_16x16x32_bf16 v[208:211], a[8:11], v[184:187], v[208:211]
    ds_read_b128 a[4:7], v252 offset:34048
    v_mfma_f32_16x16x32_bf16 v[208:211], a[12:15], v[188:191], v[208:211]
    ds_read_b128 a[8:11], v252 offset:34304
    v_mfma_f32_16x16x32_bf16 v[212:215], a[28:31], v[188:191], v[204:207]
    ds_read_b128 a[12:15], v252 offset:34560
    v_mfma_f32_16x16x32_bf16 v[212:215], a[24:27], v[184:187], v[212:215]
    v_exp_f32_e32 v208, v208
    v_mfma_f32_16x16x32_bf16 v[212:215], a[20:23], v[180:183], v[212:215]
    s_mov_b32 m0, s23
    v_exp_f32_e32 v209, v209
    v_mfma_f32_16x16x32_bf16 v[212:215], a[16:19], v[176:179], v[212:215]
    v_exp_f32_e32 v210, v210
    v_mfma_f32_16x16x32_bf16 v[216:219], a[32:35], v[176:179], v[204:207]
    v_exp_f32_e32 v211, v211
    v_mfma_f32_16x16x32_bf16 v[216:219], a[36:39], v[180:183], v[216:219]
    ds_read_b128 a[28:31], v252 offset:38784
    v_cvt_pk_bf16_f32 v232, v208, v209
    v_mfma_f32_16x16x32_bf16 v[216:219], a[40:43], v[184:187], v[216:219]
    ds_read_b128 a[24:27], v252 offset:38528
    v_cvt_pk_bf16_f32 v233, v210, v211
    v_mfma_f32_16x16x32_bf16 v[216:219], a[44:47], v[188:191], v[216:219]
    buffer_load_dwordx4 v254, s[8:11], s20 offen nt lds
    v_mfma_f32_16x16x32_bf16 v[220:223], a[60:63], v[188:191], v[204:207]
    v_exp_f32_e32 v212, v212
    v_mfma_f32_16x16x32_bf16 v[220:223], a[56:59], v[184:187], v[220:223]
    v_exp_f32_e32 v213, v213
    v_mfma_f32_16x16x32_bf16 v[220:223], a[52:55], v[180:183], v[220:223]
    s_mov_b32 m0, s94
    ds_read_b128 a[20:23], v252 offset:38272
    v_cvt_pk_bf16_f32 v234, v212, v213
    v_mfma_f32_16x16x32_bf16 v[220:223], a[48:51], v[176:179], v[220:223]
    v_exp_f32_e32 v214, v214
    v_smfmac_f32_16x16x64_bf16 a[200:203], a[208:211], v[224:231], v245
    ds_read_b128 a[16:19], v252 offset:38016
    v_mfma_f32_16x16x32_bf16 v[64:67], a[224:227], v[224:227], v[64:67]
    v_exp_f32_e32 v215, v215
    v_mfma_f32_16x16x32_bf16 v[64:67], a[228:231], v[228:231], v[64:67]
    ds_read_b128 a[32:35], v252 offset:42240
    v_cvt_pk_bf16_f32 v235, v214, v215
    v_mfma_f32_16x16x32_bf16 v[68:71], a[236:239], v[228:231], v[68:71]
    v_exp_f32_e32 v216, v216
    v_mfma_f32_16x16x32_bf16 v[68:71], a[232:235], v[224:227], v[68:71]
    v_exp_f32_e32 v217, v217
    v_mfma_f32_16x16x32_bf16 v[72:75], a[240:243], v[224:227], v[72:75]
    ds_read_b128 a[36:39], v252 offset:42496
    v_cvt_pk_bf16_f32 v236, v216, v217
    v_mfma_f32_16x16x32_bf16 v[72:75], a[244:247], v[228:231], v[72:75]
    v_exp_f32_e32 v218, v218
    v_mfma_f32_16x16x32_bf16 v[76:79], a[252:255], v[228:231], v[76:79]
    v_exp_f32_e32 v219, v219
    v_mfma_f32_16x16x32_bf16 v[76:79], a[248:251], v[224:227], v[76:79]
    ds_read_b128 a[40:43], v252 offset:42752
    v_cvt_pk_bf16_f32 v237, v218, v219
    v_mfma_f32_16x16x32_bf16 v[80:83], a[96:99], v[224:227], v[80:83]
    buffer_load_dwordx4 v254, s[8:11], s20 offen offset:1024 nt lds
    v_mfma_f32_16x16x32_bf16 v[80:83], a[100:103], v[228:231], v[80:83]
    v_exp_f32_e32 v220, v220
    v_mfma_f32_16x16x32_bf16 v[84:87], a[108:111], v[228:231], v[84:87]
    v_exp_f32_e32 v221, v221
    v_mfma_f32_16x16x32_bf16 v[84:87], a[104:107], v[224:227], v[84:87]
    ds_read_b128 a[44:47], v252 offset:43008
    v_cvt_pk_bf16_f32 v238, v220, v221
    v_mfma_f32_16x16x32_bf16 v[88:91], a[112:115], v[224:227], v[88:91]
    v_exp_f32_e32 v222, v222
    v_mfma_f32_16x16x32_bf16 v[88:91], a[116:119], v[228:231], v[88:91]
    v_exp_f32_e32 v223, v223
    v_mfma_f32_16x16x32_bf16 v[92:95], a[124:127], v[228:231], v[92:95]
    s_mov_b32 m0, s27
    ds_read_b128 a[60:63], v252 offset:47232
    v_cvt_pk_bf16_f32 v239, v222, v223
    v_mfma_f32_16x16x32_bf16 v[92:95], a[120:123], v[224:227], v[92:95]
    s_waitcnt lgkmcnt(4)
    ds_read_b128 a[56:59], v252 offset:46976
    v_mfma_f32_16x16x32_bf16 v[208:211], a[0:3], v[128:131], v[192:195]
    buffer_load_dwordx4 v254, s[4:7], s21 offen nt lds
    v_mfma_f32_16x16x32_bf16 v[208:211], a[4:7], v[132:135], v[208:211]
    s_mov_b32 m0, s95
    ds_read_b128 a[52:55], v252 offset:46720
    v_mfma_f32_16x16x32_bf16 v[208:211], a[8:11], v[136:139], v[208:211]
    buffer_load_dwordx4 v254, s[8:11], s20 offen offset:2048 nt lds
    v_mfma_f32_16x16x32_bf16 v[208:211], a[12:15], v[140:143], v[208:211]
    ds_read_b128 a[48:51], v252 offset:46464
    v_mfma_f32_16x16x32_bf16 v[212:215], a[28:31], v[140:143], v[192:195]
    ds_read_b64_tr_b16 a[70:71], v253 offset:45408
    v_mfma_f32_16x16x32_bf16 v[212:215], a[24:27], v[136:139], v[212:215]
    v_exp_f32_e32 v208, v208
    v_mfma_f32_16x16x32_bf16 v[212:215], a[20:23], v[132:135], v[212:215]
    s_mov_b32 m0, s71
    v_exp_f32_e32 v209, v209
    v_mfma_f32_16x16x32_bf16 v[212:215], a[16:19], v[128:131], v[212:215]
    v_exp_f32_e32 v210, v210
    v_mfma_f32_16x16x32_bf16 v[216:219], a[32:35], v[128:131], v[192:195]
    s_waitcnt lgkmcnt(5)
    v_exp_f32_e32 v211, v211
    v_mfma_f32_16x16x32_bf16 v[216:219], a[36:39], v[132:135], v[216:219]
    buffer_load_dwordx4 v254, s[4:7], s21 offen offset:1024 nt lds
    v_mfma_f32_16x16x32_bf16 v[216:219], a[40:43], v[136:139], v[216:219]
    s_mov_b32 m0, s96
    v_exp_f32_e32 v212, v212
    v_mfma_f32_16x16x32_bf16 v[216:219], a[44:47], v[140:143], v[216:219]
    s_waitcnt lgkmcnt(4)
    buffer_load_dwordx4 v254, s[8:11], s20 offen offset:3072 nt lds
    v_mfma_f32_16x16x32_bf16 v[220:223], a[60:63], v[140:143], v[192:195]
    s_waitcnt lgkmcnt(3)
    v_exp_f32_e32 v213, v213
    v_mfma_f32_16x16x32_bf16 v[220:223], a[56:59], v[136:139], v[220:223]
    s_waitcnt lgkmcnt(2)
    v_exp_f32_e32 v214, v214
    v_mfma_f32_16x16x32_bf16 v[220:223], a[52:55], v[132:135], v[220:223]
    s_waitcnt lgkmcnt(1)
    v_exp_f32_e32 v215, v215
    v_mfma_f32_16x16x32_bf16 v[220:223], a[48:51], v[128:131], v[220:223]
    s_mov_b32 m0, s72
    ds_read_b64_tr_b16 a[76:77], v253 offset:41288
    v_cvt_pk_bf16_f32 v224, v208, v209
    v_smfmac_f32_16x16x64_bf16 a[204:207], a[208:211], v[232:239], v245
    v_cvt_pk_bf16_f32 v225, v210, v211
    v_mfma_f32_16x16x32_bf16 v[96:99], a[224:227], v[232:235], v[96:99]
    v_exp_f32_e32 v216, v216
    v_mfma_f32_16x16x32_bf16 v[96:99], a[228:231], v[236:239], v[96:99]
    v_exp_f32_e32 v217, v217
    v_mfma_f32_16x16x32_bf16 v[100:103], a[236:239], v[236:239], v[100:103]
    v_exp_f32_e32 v218, v218
    v_mfma_f32_16x16x32_bf16 v[100:103], a[232:235], v[232:235], v[100:103]
    v_exp_f32_e32 v219, v219
    v_mfma_f32_16x16x32_bf16 v[104:107], a[240:243], v[232:235], v[104:107]
    buffer_load_dwordx4 v254, s[4:7], s21 offen offset:2048 nt lds
    v_mfma_f32_16x16x32_bf16 v[104:107], a[244:247], v[236:239], v[104:107]
    s_mov_b32 m0, s24
    ds_read_b64_tr_b16 a[78:79], v253 offset:45416
    v_cvt_pk_bf16_f32 v226, v212, v213
    v_mfma_f32_16x16x32_bf16 v[108:111], a[252:255], v[236:239], v[108:111]
    ds_read_b64_tr_b16 a[72:73], v253 offset:33032
    v_cvt_pk_bf16_f32 v227, v214, v215
    v_mfma_f32_16x16x32_bf16 v[108:111], a[248:251], v[232:235], v[108:111]
    buffer_load_dwordx4 v254, s[12:15], s20 offen nt lds
    v_mfma_f32_16x16x32_bf16 v[112:115], a[96:99], v[232:235], v[112:115]
    s_mov_b32 m0, s73
    v_exp_f32_e32 v220, v220
    v_mfma_f32_16x16x32_bf16 v[112:115], a[100:103], v[236:239], v[112:115]
    v_exp_f32_e32 v221, v221
    v_mfma_f32_16x16x32_bf16 v[116:119], a[108:111], v[236:239], v[116:119]
    v_exp_f32_e32 v222, v222
    v_mfma_f32_16x16x32_bf16 v[116:119], a[104:107], v[232:235], v[116:119]
    v_exp_f32_e32 v223, v223
    v_mfma_f32_16x16x32_bf16 v[120:123], a[112:115], v[232:235], v[120:123]
    ds_read_b64_tr_b16 a[74:75], v253 offset:37160
    v_cvt_pk_bf16_f32 v228, v216, v217
    v_mfma_f32_16x16x32_bf16 v[120:123], a[116:119], v[236:239], v[120:123]
    ds_read_b64_tr_b16 a[80:81], v253 offset:33280
    v_cvt_pk_bf16_f32 v229, v218, v219
    v_mfma_f32_16x16x32_bf16 v[124:127], a[124:127], v[236:239], v[124:127]
    ds_read_b64_tr_b16 a[82:83], v253 offset:37408
    v_cvt_pk_bf16_f32 v230, v220, v221
    v_mfma_f32_16x16x32_bf16 v[124:127], a[120:123], v[232:235], v[124:127]
    ds_read_b64_tr_b16 a[84:85], v253 offset:41536
    v_cvt_pk_bf16_f32 v231, v222, v223
    v_mfma_f32_16x16x32_bf16 v[208:211], a[0:3], v[144:147], v[196:199]
    s_add_u32 s44, s44, 1
    buffer_load_dwordx4 v254, s[4:7], s21 offen offset:3072 nt lds
    v_mfma_f32_16x16x32_bf16 v[208:211], a[4:7], v[148:151], v[208:211]
    s_mov_b32 m0, s64
    ds_read_b64_tr_b16 a[86:87], v253 offset:45664
    v_mfma_f32_16x16x32_bf16 v[208:211], a[8:11], v[152:155], v[208:211]
    s_xor_b32 s21, s21, 16384
    buffer_load_dwordx4 v254, s[12:15], s20 offen offset:1024 nt lds
    v_mfma_f32_16x16x32_bf16 v[208:211], a[12:15], v[156:159], v[208:211]
    ds_read_b64_tr_b16 a[92:93], v253 offset:41544
    v_mfma_f32_16x16x32_bf16 v[212:215], a[28:31], v[156:159], v[196:199]
    ds_read_b64_tr_b16 a[94:95], v253 offset:45672
    v_mfma_f32_16x16x32_bf16 v[212:215], a[24:27], v[152:155], v[212:215]
    v_exp_f32_e32 v208, v208
    v_mfma_f32_16x16x32_bf16 v[212:215], a[20:23], v[148:151], v[212:215]
    s_mov_b32 m0, s65
    v_exp_f32_e32 v209, v209
    v_mfma_f32_16x16x32_bf16 v[212:215], a[16:19], v[144:147], v[212:215]
    ds_read_b64_tr_b16 a[88:89], v253 offset:33288
    v_cvt_pk_bf16_f32 v232, v208, v209
    v_mfma_f32_16x16x32_bf16 v[216:219], a[32:35], v[144:147], v[196:199]
    ds_read_b64_tr_b16 a[90:91], v253 offset:37416
    v_mov_b32_e32 v244, s44
    v_mfma_f32_16x16x32_bf16 v[216:219], a[36:39], v[148:151], v[216:219]
    buffer_load_dwordx4 v254, s[12:15], s20 offen offset:2048 nt lds
    v_mfma_f32_16x16x32_bf16 v[216:219], a[40:43], v[152:155], v[216:219]
    v_exp_f32_e32 v210, v210
    v_mfma_f32_16x16x32_bf16 v[216:219], a[44:47], v[156:159], v[216:219]
    ds_read_b64_tr_b16 a[96:97], v253 offset:33536
    ds_read_b64_tr_b16 a[98:99], v253 offset:37664
    v_mfma_f32_16x16x32_bf16 v[220:223], a[60:63], v[156:159], v[196:199]
    ds_read_b64_tr_b16 a[100:101], v253 offset:41792
    ds_read_b64_tr_b16 a[102:103], v253 offset:45920
    v_mfma_f32_16x16x32_bf16 v[220:223], a[56:59], v[152:155], v[220:223]
    s_waitcnt vmcnt(11)
    ds_read_b64_tr_b16 a[108:109], v253 offset:41800
    ds_read_b64_tr_b16 a[110:111], v253 offset:45928
    v_mfma_f32_16x16x32_bf16 v[220:223], a[52:55], v[148:151], v[220:223]
    s_mov_b32 m0, s45
    ds_read_b64_tr_b16 a[104:105], v253 offset:33544
    ds_read_b64_tr_b16 a[106:107], v253 offset:37672
    v_mfma_f32_16x16x32_bf16 v[220:223], a[48:51], v[144:147], v[220:223]
    ds_read_b64_tr_b16 a[112:113], v253 offset:33792
    ds_read_b64_tr_b16 a[114:115], v253 offset:37920
    v_smfmac_f32_16x16x64_bf16 a[192:195], a[208:211], v[224:231], v245
    ds_read_b64_tr_b16 a[116:117], v253 offset:42048
    v_mfma_f32_16x16x32_bf16 v[0:3], a[64:67], v[224:227], v[0:3]
    s_waitcnt lgkmcnt(13)
    ds_read_b64_tr_b16 a[118:119], v253 offset:46176
    ds_read_b64_tr_b16 a[124:125], v253 offset:42056
    v_mfma_f32_16x16x32_bf16 v[0:3], a[68:71], v[228:231], v[0:3]
    ds_read_b64_tr_b16 a[126:127], v253 offset:46184
    ds_write_addtid_b32 v244
    v_mfma_f32_16x16x32_bf16 v[4:7], a[76:79], v[228:231], v[4:7]
    ds_read_b64_tr_b16 a[120:121], v253 offset:33800
    ds_read_b64_tr_b16 a[122:123], v253 offset:37928
    v_mfma_f32_16x16x32_bf16 v[4:7], a[72:75], v[224:227], v[4:7]
    v_exp_f32_e32 v211, v211
    v_mfma_f32_16x16x32_bf16 v[8:11], a[80:83], v[224:227], v[8:11]
    v_exp_f32_e32 v212, v212
    v_mfma_f32_16x16x32_bf16 v[8:11], a[84:87], v[228:231], v[8:11]
    v_exp_f32_e32 v213, v213
    v_mfma_f32_16x16x32_bf16 v[12:15], a[92:95], v[228:231], v[12:15]
    s_waitcnt lgkmcnt(15)
    v_exp_f32_e32 v214, v214
    v_mfma_f32_16x16x32_bf16 v[12:15], a[88:91], v[224:227], v[12:15]
    v_exp_f32_e32 v215, v215
    v_mfma_f32_16x16x32_bf16 v[16:19], a[96:99], v[224:227], v[16:19]
    s_waitcnt lgkmcnt(11)
    v_cvt_pk_bf16_f32 v233, v210, v211
    v_cvt_pk_bf16_f32 v234, v212, v213
    v_mfma_f32_16x16x32_bf16 v[16:19], a[100:103], v[228:231], v[16:19]
    s_waitcnt lgkmcnt(2)
    v_exp_f32_e32 v216, v216
    v_mfma_f32_16x16x32_bf16 v[20:23], a[108:111], v[228:231], v[20:23]
    s_mov_b32 m0, s66
    v_exp_f32_e32 v217, v217
    v_mfma_f32_16x16x32_bf16 v[20:23], a[104:107], v[224:227], v[20:23]
    v_exp_f32_e32 v218, v218
    v_mfma_f32_16x16x32_bf16 v[24:27], a[112:115], v[224:227], v[24:27]
    v_exp_f32_e32 v219, v219
    v_mfma_f32_16x16x32_bf16 v[24:27], a[116:119], v[228:231], v[24:27]
    v_cvt_pk_bf16_f32 v235, v214, v215
    v_cvt_pk_bf16_f32 v236, v216, v217
    v_mfma_f32_16x16x32_bf16 v[28:31], a[124:127], v[228:231], v[28:31]
    s_waitcnt lgkmcnt(0)
    v_exp_f32_e32 v220, v220
    v_mfma_f32_16x16x32_bf16 v[28:31], a[120:123], v[224:227], v[28:31]
    v_exp_f32_e32 v221, v221
    v_mfma_f32_16x16x32_bf16 v[208:211], a[0:3], v[160:163], v[200:203]
    v_exp_f32_e32 v222, v222
    v_mfma_f32_16x16x32_bf16 v[208:211], a[4:7], v[164:167], v[208:211]
    v_exp_f32_e32 v223, v223
    v_mfma_f32_16x16x32_bf16 v[208:211], a[8:11], v[168:171], v[208:211]
    v_cvt_pk_bf16_f32 v237, v218, v219
    v_cvt_pk_bf16_f32 v238, v220, v221
    v_mfma_f32_16x16x32_bf16 v[208:211], a[12:15], v[172:175], v[208:211]
    buffer_load_dwordx4 v254, s[12:15], s20 offen offset:3072 nt lds
    v_mfma_f32_16x16x32_bf16 v[212:215], a[28:31], v[172:175], v[200:203]
    s_xor_b32 s20, s20, 16384
    v_cvt_pk_bf16_f32 v239, v222, v223
    v_mfma_f32_16x16x32_bf16 v[212:215], a[24:27], v[168:171], v[212:215]
    s_mov_b32 m0, s74
    v_exp_f32_e32 v208, v208
    v_mfma_f32_16x16x32_bf16 v[212:215], a[20:23], v[164:167], v[212:215]
    buffer_load_dwordx4 v254, s[8:11], s20 offen nt lds
    v_mfma_f32_16x16x32_bf16 v[212:215], a[16:19], v[160:163], v[212:215]
    s_mov_b32 m0, s75
    v_exp_f32_e32 v209, v209
    v_mfma_f32_16x16x32_bf16 v[216:219], a[32:35], v[160:163], v[200:203]
    v_exp_f32_e32 v210, v210
    v_mfma_f32_16x16x32_bf16 v[216:219], a[36:39], v[164:167], v[216:219]
    v_exp_f32_e32 v211, v211
    v_mfma_f32_16x16x32_bf16 v[216:219], a[40:43], v[168:171], v[216:219]
    buffer_load_dwordx4 v254, s[8:11], s20 offen offset:1024 nt lds
    v_mfma_f32_16x16x32_bf16 v[216:219], a[44:47], v[172:175], v[216:219]
    v_exp_f32_e32 v212, v212
    v_mfma_f32_16x16x32_bf16 v[220:223], a[60:63], v[172:175], v[200:203]
    v_exp_f32_e32 v213, v213
    v_mfma_f32_16x16x32_bf16 v[220:223], a[56:59], v[168:171], v[220:223]
    v_exp_f32_e32 v214, v214
    v_mfma_f32_16x16x32_bf16 v[220:223], a[52:55], v[164:167], v[220:223]
    v_exp_f32_e32 v215, v215
    v_mfma_f32_16x16x32_bf16 v[220:223], a[48:51], v[160:163], v[220:223]
    v_cvt_pk_bf16_f32 v224, v208, v209
    v_cvt_pk_bf16_f32 v225, v210, v211
    v_smfmac_f32_16x16x64_bf16 a[196:199], a[208:211], v[232:239], v245
    v_cvt_pk_bf16_f32 v226, v212, v213
    v_mfma_f32_16x16x32_bf16 v[32:35], a[64:67], v[232:235], v[32:35]
    v_exp_f32_e32 v216, v216
    v_mfma_f32_16x16x32_bf16 v[32:35], a[68:71], v[236:239], v[32:35]
    ds_read_b32 v244, v255
    v_cvt_pk_bf16_f32 v227, v214, v215
    v_mfma_f32_16x16x32_bf16 v[36:39], a[76:79], v[236:239], v[36:39]
    v_exp_f32_e32 v217, v217
    v_mfma_f32_16x16x32_bf16 v[36:39], a[72:75], v[232:235], v[36:39]
    v_exp_f32_e32 v218, v218
    v_mfma_f32_16x16x32_bf16 v[40:43], a[80:83], v[232:235], v[40:43]
    v_exp_f32_e32 v219, v219
    v_mfma_f32_16x16x32_bf16 v[40:43], a[84:87], v[236:239], v[40:43]
    s_mov_b32 m0, s76
    v_exp_f32_e32 v220, v220
    v_mfma_f32_16x16x32_bf16 v[44:47], a[92:95], v[236:239], v[44:47]
    v_exp_f32_e32 v221, v221
    v_mfma_f32_16x16x32_bf16 v[44:47], a[88:91], v[232:235], v[44:47]
    v_exp_f32_e32 v222, v222
    v_mfma_f32_16x16x32_bf16 v[48:51], a[96:99], v[232:235], v[48:51]
    v_exp_f32_e32 v223, v223
    v_mfma_f32_16x16x32_bf16 v[48:51], a[100:103], v[236:239], v[48:51]
    s_waitcnt lgkmcnt(0)
    v_cmp_gt_u32_e32 vcc, s44, v244
    v_cvt_pk_bf16_f32 v228, v216, v217
    v_mfma_f32_16x16x32_bf16 v[52:55], a[108:111], v[236:239], v[52:55]
    v_cvt_pk_bf16_f32 v229, v218, v219
    v_cvt_pk_bf16_f32 v230, v220, v221
    v_mfma_f32_16x16x32_bf16 v[52:55], a[104:107], v[232:235], v[52:55]
    s_cbranch_vccnz L_rt1
L_bk1:
    ds_read_b64_tr_b16 a[224:225], v253 offset:49536
    v_cvt_pk_bf16_f32 v231, v222, v223
    v_mfma_f32_16x16x32_bf16 v[56:59], a[112:115], v[232:235], v[56:59]
    buffer_load_dwordx4 v254, s[8:11], s20 offen offset:2048 nt lds
    v_mfma_f32_16x16x32_bf16 v[56:59], a[116:119], v[236:239], v[56:59]
    ds_read_b64_tr_b16 a[226:227], v253 offset:53664
    v_mfma_f32_16x16x32_bf16 v[60:63], a[124:127], v[236:239], v[60:63]
    s_mov_b32 m0, s77
    ds_read_b64_tr_b16 a[228:229], v253 offset:57792
    v_mfma_f32_16x16x32_bf16 v[60:63], a[120:123], v[232:235], v[60:63]
    ds_read_b64_tr_b16 a[230:231], v253 offset:61920
    v_mfma_f32_16x16x32_bf16 v[208:211], a[0:3], v[176:179], v[204:207]
    buffer_load_dwordx4 v254, s[8:11], s20 offen offset:3072 nt lds
    v_mfma_f32_16x16x32_bf16 v[208:211], a[4:7], v[180:183], v[208:211]
    ds_read_b128 a[0:3], v252 offset:50688
    v_mfma_f32_16x16x32_bf16 v[208:211], a[8:11], v[184:187], v[208:211]
    ds_read_b128 a[4:7], v252 offset:50944
    v_mfma_f32_16x16x32_bf16 v[208:211], a[12:15], v[188:191], v[208:211]
    ds_read_b128 a[8:11], v252 offset:51200
    v_mfma_f32_16x16x32_bf16 v[212:215], a[28:31], v[188:191], v[204:207]
    ds_read_b128 a[12:15], v252 offset:51456
    v_mfma_f32_16x16x32_bf16 v[212:215], a[24:27], v[184:187], v[212:215]
    v_exp_f32_e32 v208, v208
    v_mfma_f32_16x16x32_bf16 v[212:215], a[20:23], v[180:183], v[212:215]
    v_exp_f32_e32 v209, v209
    v_mfma_f32_16x16x32_bf16 v[212:215], a[16:19], v[176:179], v[212:215]
    v_exp_f32_e32 v210, v210
    v_mfma_f32_16x16x32_bf16 v[216:219], a[32:35], v[176:179], v[204:207]
    v_exp_f32_e32 v211, v211
    v_mfma_f32_16x16x32_bf16 v[216:219], a[36:39], v[180:183], v[216:219]
    ds_read_b128 a[28:31], v252 offset:55680
    v_cvt_pk_bf16_f32 v232, v208, v209
    v_mfma_f32_16x16x32_bf16 v[216:219], a[40:43], v[184:187], v[216:219]
    ds_read_b128 a[24:27], v252 offset:55424
    v_cvt_pk_bf16_f32 v233, v210, v211
    v_mfma_f32_16x16x32_bf16 v[216:219], a[44:47], v[188:191], v[216:219]
    v_exp_f32_e32 v212, v212
    v_mfma_f32_16x16x32_bf16 v[220:223], a[60:63], v[188:191], v[204:207]
    v_exp_f32_e32 v213, v213
    v_mfma_f32_16x16x32_bf16 v[220:223], a[56:59], v[184:187], v[220:223]
    ds_read_b128 a[20:23], v252 offset:55168
    v_cvt_pk_bf16_f32 v234, v212, v213
    v_mfma_f32_16x16x32_bf16 v[220:223], a[52:55], v[180:183], v[220:223]
    s_mov_b32 m0, s78
    v_exp_f32_e32 v214, v214
    v_mfma_f32_16x16x32_bf16 v[220:223], a[48:51], v[176:179], v[220:223]
    v_exp_f32_e32 v215, v215
    v_smfmac_f32_16x16x64_bf16 a[200:203], a[208:211], v[224:231], v245
    ds_read_b128 a[16:19], v252 offset:54912
    v_mfma_f32_16x16x32_bf16 v[64:67], a[64:67], v[224:227], v[64:67]
    ds_read_b128 a[32:35], v252 offset:59136
    v_cvt_pk_bf16_f32 v235, v214, v215
    v_mfma_f32_16x16x32_bf16 v[64:67], a[68:71], v[228:231], v[64:67]
    v_exp_f32_e32 v216, v216
    v_mfma_f32_16x16x32_bf16 v[68:71], a[76:79], v[228:231], v[68:71]
    v_exp_f32_e32 v217, v217
    v_mfma_f32_16x16x32_bf16 v[68:71], a[72:75], v[224:227], v[68:71]
    ds_read_b128 a[36:39], v252 offset:59392
    v_cvt_pk_bf16_f32 v236, v216, v217
    v_mfma_f32_16x16x32_bf16 v[72:75], a[80:83], v[224:227], v[72:75]
    v_exp_f32_e32 v218, v218
    v_mfma_f32_16x16x32_bf16 v[72:75], a[84:87], v[228:231], v[72:75]
    v_exp_f32_e32 v219, v219
    v_mfma_f32_16x16x32_bf16 v[76:79], a[92:95], v[228:231], v[76:79]
    ds_read_b128 a[40:43], v252 offset:59648
    v_cvt_pk_bf16_f32 v237, v218, v219
    v_mfma_f32_16x16x32_bf16 v[76:79], a[88:91], v[224:227], v[76:79]
    buffer_load_dwordx4 v254, s[12:15], s20 offen nt lds
    v_mfma_f32_16x16x32_bf16 v[80:83], a[96:99], v[224:227], v[80:83]
    s_mov_b32 m0, s79
    v_exp_f32_e32 v220, v220
    v_mfma_f32_16x16x32_bf16 v[80:83], a[100:103], v[228:231], v[80:83]
    v_exp_f32_e32 v221, v221
    v_mfma_f32_16x16x32_bf16 v[84:87], a[108:111], v[228:231], v[84:87]
    ds_read_b128 a[44:47], v252 offset:59904
    v_cvt_pk_bf16_f32 v238, v220, v221
    v_mfma_f32_16x16x32_bf16 v[84:87], a[104:107], v[224:227], v[84:87]
    v_exp_f32_e32 v222, v222
    v_mfma_f32_16x16x32_bf16 v[88:91], a[112:115], v[224:227], v[88:91]
    v_exp_f32_e32 v223, v223
    v_mfma_f32_16x16x32_bf16 v[88:91], a[116:119], v[228:231], v[88:91]
    ds_read_b128 a[60:63], v252 offset:64128
    v_cvt_pk_bf16_f32 v239, v222, v223
    v_mfma_f32_16x16x32_bf16 v[92:95], a[124:127], v[228:231], v[92:95]
    buffer_load_dwordx4 v254, s[12:15], s20 offen offset:1024 nt lds
    v_mfma_f32_16x16x32_bf16 v[92:95], a[120:123], v[224:227], v[92:95]
    s_waitcnt lgkmcnt(4)
    ds_read_b128 a[56:59], v252 offset:63872
    v_mfma_f32_16x16x32_bf16 v[208:211], a[0:3], v[128:131], v[192:195]
    ds_read_b128 a[52:55], v252 offset:63616
    v_mfma_f32_16x16x32_bf16 v[208:211], a[4:7], v[132:135], v[208:211]
    ds_read_b128 a[48:51], v252 offset:63360
    v_mfma_f32_16x16x32_bf16 v[208:211], a[8:11], v[136:139], v[208:211]
    ds_read_b64_tr_b16 a[236:237], v253 offset:57800
    v_mfma_f32_16x16x32_bf16 v[208:211], a[12:15], v[140:143], v[208:211]
    ds_read_b64_tr_b16 a[238:239], v253 offset:61928
    v_mfma_f32_16x16x32_bf16 v[212:215], a[28:31], v[140:143], v[192:195]
    ds_read_b64_tr_b16 a[232:233], v253 offset:49544
    v_mfma_f32_16x16x32_bf16 v[212:215], a[24:27], v[136:139], v[212:215]
    v_exp_f32_e32 v208, v208
    v_mfma_f32_16x16x32_bf16 v[212:215], a[20:23], v[132:135], v[212:215]
    s_mov_b32 m0, s80
    v_exp_f32_e32 v209, v209
    v_mfma_f32_16x16x32_bf16 v[212:215], a[16:19], v[128:131], v[212:215]
    v_exp_f32_e32 v210, v210
    v_mfma_f32_16x16x32_bf16 v[216:219], a[32:35], v[128:131], v[192:195]
    s_waitcnt lgkmcnt(7)
    v_exp_f32_e32 v211, v211
    v_mfma_f32_16x16x32_bf16 v[216:219], a[36:39], v[132:135], v[216:219]
    buffer_load_dwordx4 v254, s[12:15], s20 offen offset:2048 nt lds
    v_mfma_f32_16x16x32_bf16 v[216:219], a[40:43], v[136:139], v[216:219]
    v_exp_f32_e32 v212, v212
    v_mfma_f32_16x16x32_bf16 v[216:219], a[44:47], v[140:143], v[216:219]
    s_waitcnt lgkmcnt(6)
    v_exp_f32_e32 v213, v213
    v_mfma_f32_16x16x32_bf16 v[220:223], a[60:63], v[140:143], v[192:195]
    s_waitcnt lgkmcnt(5)
    v_exp_f32_e32 v214, v214
    v_mfma_f32_16x16x32_bf16 v[220:223], a[56:59], v[136:139], v[220:223]
    s_waitcnt lgkmcnt(4)
    v_exp_f32_e32 v215, v215
    v_mfma_f32_16x16x32_bf16 v[220:223], a[52:55], v[132:135], v[220:223]
    s_waitcnt lgkmcnt(3)
    ds_read_b64_tr_b16 a[234:235], v253 offset:53672
    v_cvt_pk_bf16_f32 v224, v208, v209
    v_mfma_f32_16x16x32_bf16 v[220:223], a[48:51], v[128:131], v[220:223]
    ds_read_b64_tr_b16 a[240:241], v253 offset:49792
    v_cvt_pk_bf16_f32 v225, v210, v211
    v_smfmac_f32_16x16x64_bf16 a[204:207], a[208:211], v[232:239], v245
    s_waitcnt vmcnt(10)
    ds_read_b128 a[128:131], v246 offset:0
    v_mfma_f32_16x16x32_bf16 v[96:99], a[64:67], v[232:235], v[96:99]
    ds_read_b128 a[132:135], v246 offset:256
    v_cvt_pk_bf16_f32 v226, v212, v213
    v_mfma_f32_16x16x32_bf16 v[96:99], a[68:71], v[236:239], v[96:99]
    ds_read_b128 a[136:139], v246 offset:512
    v_cvt_pk_bf16_f32 v227, v214, v215
    v_mfma_f32_16x16x32_bf16 v[100:103], a[76:79], v[236:239], v[100:103]
    v_exp_f32_e32 v216, v216
    v_mfma_f32_16x16x32_bf16 v[100:103], a[72:75], v[232:235], v[100:103]
    v_exp_f32_e32 v217, v217
    v_mfma_f32_16x16x32_bf16 v[104:107], a[80:83], v[232:235], v[104:107]
    ds_read_b128 a[140:143], v246 offset:768
    v_cvt_pk_bf16_f32 v228, v216, v217
    v_mfma_f32_16x16x32_bf16 v[104:107], a[84:87], v[236:239], v[104:107]
    s_mov_b32 m0, s27
    v_exp_f32_e32 v218, v218
    v_mfma_f32_16x16x32_bf16 v[108:111], a[92:95], v[236:239], v[108:111]
    v_exp_f32_e32 v219, v219
    v_mfma_f32_16x16x32_bf16 v[108:111], a[88:91], v[232:235], v[108:111]
    v_exp_f32_e32 v220, v220
    v_mfma_f32_16x16x32_bf16 v[112:115], a[96:99], v[232:235], v[112:115]
    v_exp_f32_e32 v221, v221
    v_mfma_f32_16x16x32_bf16 v[112:115], a[100:103], v[236:239], v[112:115]
    v_exp_f32_e32 v222, v222
    v_mfma_f32_16x16x32_bf16 v[116:119], a[108:111], v[236:239], v[116:119]
    v_exp_f32_e32 v223, v223
    v_mfma_f32_16x16x32_bf16 v[116:119], a[104:107], v[232:235], v[116:119]
    ds_read_b64_tr_b16 a[242:243], v253 offset:53920
    v_cvt_pk_bf16_f32 v229, v218, v219
    v_mfma_f32_16x16x32_bf16 v[120:123], a[112:115], v[232:235], v[120:123]
    s_waitcnt lgkmcnt(1)
    buffer_load_dwordx4 v254, s[4:7], s21 offen nt lds
    v_mfma_f32_16x16x32_bf16 v[120:123], a[116:119], v[236:239], v[120:123]
    s_mov_b32 m0, s81
    ds_read_b64_tr_b16 a[244:245], v253 offset:58048
    v_cvt_pk_bf16_f32 v230, v220, v221
    v_mfma_f32_16x16x32_bf16 v[124:127], a[124:127], v[236:239], v[124:127]
    ds_read_b64_tr_b16 a[246:247], v253 offset:62176
    v_cvt_pk_bf16_f32 v231, v222, v223
    v_mfma_f32_16x16x32_bf16 v[124:127], a[120:123], v[232:235], v[124:127]
    buffer_load_dwordx4 v254, s[12:15], s20 offen offset:3072 nt lds
    v_mfma_f32_16x16x32_bf16 v[208:211], a[0:3], v[144:147], v[196:199]
    s_mov_b32 m0, s71
    ds_read_b64_tr_b16 a[252:253], v253 offset:58056
    v_mfma_f32_16x16x32_bf16 v[208:211], a[4:7], v[148:151], v[208:211]
    s_xor_b32 s20, s20, 49152
    buffer_load_dwordx4 v254, s[4:7], s21 offen offset:1024 nt lds
    v_mfma_f32_16x16x32_bf16 v[208:211], a[8:11], v[152:155], v[208:211]
    s_add_u32 s44, s44, 1
    ds_read_b64_tr_b16 a[254:255], v253 offset:62184
    v_mfma_f32_16x16x32_bf16 v[208:211], a[12:15], v[156:159], v[208:211]
    ds_read_b64_tr_b16 a[248:249], v253 offset:49800
    v_mfma_f32_16x16x32_bf16 v[212:215], a[28:31], v[156:159], v[196:199]
    ds_read_b64_tr_b16 a[250:251], v253 offset:53928
    v_mfma_f32_16x16x32_bf16 v[212:215], a[24:27], v[152:155], v[212:215]
    v_exp_f32_e32 v208, v208
    v_mfma_f32_16x16x32_bf16 v[212:215], a[20:23], v[148:151], v[212:215]
    s_mov_b32 m0, s72
    v_exp_f32_e32 v209, v209
    v_mfma_f32_16x16x32_bf16 v[212:215], a[16:19], v[144:147], v[212:215]
    ds_read_b64_tr_b16 a[96:97], v253 offset:50048
    v_cvt_pk_bf16_f32 v232, v208, v209
    v_mfma_f32_16x16x32_bf16 v[216:219], a[32:35], v[144:147], v[196:199]
    ds_read_b64_tr_b16 a[98:99], v253 offset:54176
    v_mov_b32_e32 v244, s44
    v_mfma_f32_16x16x32_bf16 v[216:219], a[36:39], v[148:151], v[216:219]
    buffer_load_dwordx4 v254, s[4:7], s21 offen offset:2048 nt lds
    v_mfma_f32_16x16x32_bf16 v[216:219], a[40:43], v[152:155], v[216:219]
    s_mov_b32 m0, s82
    v_exp_f32_e32 v210, v210
    v_mfma_f32_16x16x32_bf16 v[216:219], a[44:47], v[156:159], v[216:219]
    buffer_load_dwordx4 v254, s[8:11], s20 offen nt lds
    v_mfma_f32_16x16x32_bf16 v[220:223], a[60:63], v[156:159], v[196:199]
    ds_read_b64_tr_b16 a[100:101], v253 offset:58304
    ds_read_b64_tr_b16 a[102:103], v253 offset:62432
    v_mfma_f32_16x16x32_bf16 v[220:223], a[56:59], v[152:155], v[220:223]
    s_waitcnt vmcnt(12)
    ds_read_b64_tr_b16 a[108:109], v253 offset:58312
    ds_read_b64_tr_b16 a[110:111], v253 offset:62440
    v_mfma_f32_16x16x32_bf16 v[220:223], a[52:55], v[148:151], v[220:223]
    s_mov_b32 m0, s45
    ds_read_b64_tr_b16 a[104:105], v253 offset:50056
    ds_read_b64_tr_b16 a[106:107], v253 offset:54184
    v_mfma_f32_16x16x32_bf16 v[220:223], a[48:51], v[144:147], v[220:223]
    ds_read_b64_tr_b16 a[112:113], v253 offset:50304
    ds_read_b64_tr_b16 a[114:115], v253 offset:54432
    v_smfmac_f32_16x16x64_bf16 a[192:195], a[208:211], v[224:231], v245
    ds_read_b64_tr_b16 a[116:117], v253 offset:58560
    v_mfma_f32_16x16x32_bf16 v[0:3], a[224:227], v[224:227], v[0:3]
    ds_read_b64_tr_b16 a[118:119], v253 offset:62688
    ds_read_b64_tr_b16 a[124:125], v253 offset:58568
    v_mfma_f32_16x16x32_bf16 v[0:3], a[228:231], v[228:231], v[0:3]
    ds_read_b64_tr_b16 a[126:127], v253 offset:62696
    ds_write_addtid_b32 v244
    v_mfma_f32_16x16x32_bf16 v[4:7], a[236:239], v[228:231], v[4:7]
    ds_read_b64_tr_b16 a[120:121], v253 offset:50312
    ds_read_b64_tr_b16 a[122:123], v253 offset:54440
    v_mfma_f32_16x16x32_bf16 v[4:7], a[232:235], v[224:227], v[4:7]
    s_waitcnt lgkmcnt(15)
    v_exp_f32_e32 v211, v211
    v_mfma_f32_16x16x32_bf16 v[8:11], a[240:243], v[224:227], v[8:11]
    v_exp_f32_e32 v212, v212
    v_mfma_f32_16x16x32_bf16 v[8:11], a[244:247], v[228:231], v[8:11]
    v_exp_f32_e32 v213, v213
    v_mfma_f32_16x16x32_bf16 v[12:15], a[252:255], v[228:231], v[12:15]
    v_exp_f32_e32 v214, v214
    v_mfma_f32_16x16x32_bf16 v[12:15], a[248:251], v[224:227], v[12:15]
    v_exp_f32_e32 v215, v215
    v_mfma_f32_16x16x32_bf16 v[16:19], a[96:99], v[224:227], v[16:19]
    s_waitcnt lgkmcnt(11)
    v_cvt_pk_bf16_f32 v233, v210, v211
    v_cvt_pk_bf16_f32 v234, v212, v213
    v_mfma_f32_16x16x32_bf16 v[16:19], a[100:103], v[228:231], v[16:19]
    s_waitcnt lgkmcnt(2)
    v_exp_f32_e32 v216, v216
    v_mfma_f32_16x16x32_bf16 v[20:23], a[108:111], v[228:231], v[20:23]
    s_mov_b32 m0, s73
    v_exp_f32_e32 v217, v217
    v_mfma_f32_16x16x32_bf16 v[20:23], a[104:107], v[224:227], v[20:23]
    v_exp_f32_e32 v218, v218
    v_mfma_f32_16x16x32_bf16 v[24:27], a[112:115], v[224:227], v[24:27]
    v_exp_f32_e32 v219, v219
    v_mfma_f32_16x16x32_bf16 v[24:27], a[116:119], v[228:231], v[24:27]
    v_cvt_pk_bf16_f32 v235, v214, v215
    v_cvt_pk_bf16_f32 v236, v216, v217
    v_mfma_f32_16x16x32_bf16 v[28:31], a[124:127], v[228:231], v[28:31]
    s_waitcnt lgkmcnt(0)
    v_exp_f32_e32 v220, v220
    v_mfma_f32_16x16x32_bf16 v[28:31], a[120:123], v[224:227], v[28:31]
    v_exp_f32_e32 v221, v221
    v_mfma_f32_16x16x32_bf16 v[208:211], a[0:3], v[160:163], v[200:203]
    v_exp_f32_e32 v222, v222
    v_mfma_f32_16x16x32_bf16 v[208:211], a[4:7], v[164:167], v[208:211]
    v_exp_f32_e32 v223, v223
    v_mfma_f32_16x16x32_bf16 v[208:211], a[8:11], v[168:171], v[208:211]
    v_cvt_pk_bf16_f32 v237, v218, v219
    v_cvt_pk_bf16_f32 v238, v220, v221
    v_mfma_f32_16x16x32_bf16 v[208:211], a[12:15], v[172:175], v[208:211]
    buffer_load_dwordx4 v254, s[4:7], s21 offen offset:3072 nt lds
    v_mfma_f32_16x16x32_bf16 v[212:215], a[28:31], v[172:175], v[200:203]
    s_mov_b32 m0, s83
    v_cvt_pk_bf16_f32 v239, v222, v223
    v_mfma_f32_16x16x32_bf16 v[212:215], a[24:27], v[168:171], v[212:215]
    s_xor_b32 s21, s21, 49152
    buffer_load_dwordx4 v254, s[8:11], s20 offen offset:1024 nt lds
    v_mfma_f32_16x16x32_bf16 v[212:215], a[20:23], v[164:167], v[212:215]
    s_mov_b32 m0, s84
    v_exp_f32_e32 v208, v208
    v_mfma_f32_16x16x32_bf16 v[212:215], a[16:19], v[160:163], v[212:215]
    v_exp_f32_e32 v209, v209
    v_mfma_f32_16x16x32_bf16 v[216:219], a[32:35], v[160:163], v[200:203]
    v_exp_f32_e32 v210, v210
    v_mfma_f32_16x16x32_bf16 v[216:219], a[36:39], v[164:167], v[216:219]
    v_exp_f32_e32 v211, v211
    v_mfma_f32_16x16x32_bf16 v[216:219], a[40:43], v[168:171], v[216:219]
    buffer_load_dwordx4 v254, s[8:11], s20 offen offset:2048 nt lds
    v_mfma_f32_16x16x32_bf16 v[216:219], a[44:47], v[172:175], v[216:219]
    v_exp_f32_e32 v212, v212
    v_mfma_f32_16x16x32_bf16 v[220:223], a[60:63], v[172:175], v[200:203]
    v_exp_f32_e32 v213, v213
    v_mfma_f32_16x16x32_bf16 v[220:223], a[56:59], v[168:171], v[220:223]
    v_exp_f32_e32 v214, v214
    v_mfma_f32_16x16x32_bf16 v[220:223], a[52:55], v[164:167], v[220:223]
    v_exp_f32_e32 v215, v215
    v_mfma_f32_16x16x32_bf16 v[220:223], a[48:51], v[160:163], v[220:223]
    v_cvt_pk_bf16_f32 v224, v208, v209
    v_cvt_pk_bf16_f32 v225, v210, v211
    v_smfmac_f32_16x16x64_bf16 a[196:199], a[208:211], v[232:239], v245
    v_cvt_pk_bf16_f32 v226, v212, v213
    v_mfma_f32_16x16x32_bf16 v[32:35], a[224:227], v[232:235], v[32:35]
    v_exp_f32_e32 v216, v216
    v_mfma_f32_16x16x32_bf16 v[32:35], a[228:231], v[236:239], v[32:35]
    ds_read_b32 v244, v255
    v_cvt_pk_bf16_f32 v227, v214, v215
    v_mfma_f32_16x16x32_bf16 v[36:39], a[236:239], v[236:239], v[36:39]
    v_exp_f32_e32 v217, v217
    v_mfma_f32_16x16x32_bf16 v[36:39], a[232:235], v[232:235], v[36:39]
    v_exp_f32_e32 v218, v218
    v_mfma_f32_16x16x32_bf16 v[40:43], a[240:243], v[232:235], v[40:43]
    v_exp_f32_e32 v219, v219
    v_mfma_f32_16x16x32_bf16 v[40:43], a[244:247], v[236:239], v[40:43]
    s_mov_b32 m0, s85
    v_exp_f32_e32 v220, v220
    v_mfma_f32_16x16x32_bf16 v[44:47], a[252:255], v[236:239], v[44:47]
    v_exp_f32_e32 v221, v221
    v_mfma_f32_16x16x32_bf16 v[44:47], a[248:251], v[232:235], v[44:47]
    v_exp_f32_e32 v222, v222
    v_mfma_f32_16x16x32_bf16 v[48:51], a[96:99], v[232:235], v[48:51]
    v_exp_f32_e32 v223, v223
    v_mfma_f32_16x16x32_bf16 v[48:51], a[100:103], v[236:239], v[48:51]
    s_waitcnt lgkmcnt(0)
    v_cmp_gt_u32_e32 vcc, s44, v244
    v_cvt_pk_bf16_f32 v228, v216, v217
    v_mfma_f32_16x16x32_bf16 v[52:55], a[108:111], v[236:239], v[52:55]
    v_cvt_pk_bf16_f32 v229, v218, v219
    v_cvt_pk_bf16_f32 v230, v220, v221
    v_mfma_f32_16x16x32_bf16 v[52:55], a[104:107], v[232:235], v[52:55]
    s_cbranch_vccnz L_rt2
L_bk2:
    ds_read_b64_tr_b16 a[64:65], v253 offset:0
    v_cvt_pk_bf16_f32 v231, v222, v223
    v_mfma_f32_16x16x32_bf16 v[56:59], a[112:115], v[232:235], v[56:59]
    buffer_load_dwordx4 v254, s[8:11], s20 offen offset:3072 nt lds
    v_mfma_f32_16x16x32_bf16 v[56:59], a[116:119], v[236:239], v[56:59]
    ds_read_b64_tr_b16 a[66:67], v253 offset:4128
    v_mfma_f32_16x16x32_bf16 v[60:63], a[124:127], v[236:239], v[60:63]
    ds_read_b64_tr_b16 a[68:69], v253 offset:8256
    v_mfma_f32_16x16x32_bf16 v[60:63], a[120:123], v[232:235], v[60:63]
    ds_read_b64_tr_b16 a[70:71], v253 offset:12384
    v_mfma_f32_16x16x32_bf16 v[208:211], a[0:3], v[176:179], v[204:207]
    ds_read_b128 a[0:3], v252 offset:0
    v_mfma_f32_16x16x32_bf16 v[208:211], a[4:7], v[180:183], v[208:211]
    ds_read_b128 a[4:7], v252 offset:256
    v_mfma_f32_16x16x32_bf16 v[208:211], a[8:11], v[184:187], v[208:211]
    ds_read_b128 a[8:11], v252 offset:512
    v_mfma_f32_16x16x32_bf16 v[208:211], a[12:15], v[188:191], v[208:211]
    ds_read_b128 a[12:15], v252 offset:768
    v_mfma_f32_16x16x32_bf16 v[212:215], a[28:31], v[188:191], v[204:207]
    ds_read_b128 a[28:31], v252 offset:4992
    v_mfma_f32_16x16x32_bf16 v[212:215], a[24:27], v[184:187], v[212:215]
    v_exp_f32_e32 v208, v208
    v_mfma_f32_16x16x32_bf16 v[212:215], a[20:23], v[180:183], v[212:215]
    s_mov_b32 m0, s86
    v_exp_f32_e32 v209, v209
    v_mfma_f32_16x16x32_bf16 v[212:215], a[16:19], v[176:179], v[212:215]
    v_exp_f32_e32 v210, v210
    v_mfma_f32_16x16x32_bf16 v[216:219], a[32:35], v[176:179], v[204:207]
    v_exp_f32_e32 v211, v211
    v_mfma_f32_16x16x32_bf16 v[216:219], a[36:39], v[180:183], v[216:219]
    ds_read_b128 a[24:27], v252 offset:4736
    v_cvt_pk_bf16_f32 v232, v208, v209
    v_mfma_f32_16x16x32_bf16 v[216:219], a[40:43], v[184:187], v[216:219]
    ds_read_b128 a[20:23], v252 offset:4480
    v_cvt_pk_bf16_f32 v233, v210, v211
    v_mfma_f32_16x16x32_bf16 v[216:219], a[44:47], v[188:191], v[216:219]
    buffer_load_dwordx4 v254, s[12:15], s20 offen nt lds
    v_mfma_f32_16x16x32_bf16 v[220:223], a[60:63], v[188:191], v[204:207]
    v_exp_f32_e32 v212, v212
    v_mfma_f32_16x16x32_bf16 v[220:223], a[56:59], v[184:187], v[220:223]
    v_exp_f32_e32 v213, v213
    v_mfma_f32_16x16x32_bf16 v[220:223], a[52:55], v[180:183], v[220:223]
    v_exp_f32_e32 v214, v214
    v_mfma_f32_16x16x32_bf16 v[220:223], a[48:51], v[176:179], v[220:223]
    v_exp_f32_e32 v215, v215
    v_smfmac_f32_16x16x64_bf16 a[200:203], a[208:211], v[224:231], v245
    ds_read_b128 a[16:19], v252 offset:4224
    v_mfma_f32_16x16x32_bf16 v[64:67], a[224:227], v[224:227], v[64:67]
    ds_read_b128 a[32:35], v252 offset:8448
    v_cvt_pk_bf16_f32 v234, v212, v213
    v_mfma_f32_16x16x32_bf16 v[64:67], a[228:231], v[228:231], v[64:67]
    ds_read_b128 a[36:39], v252 offset:8704
    v_cvt_pk_bf16_f32 v235, v214, v215
    v_mfma_f32_16x16x32_bf16 v[68:71], a[236:239], v[228:231], v[68:71]
    v_exp_f32_e32 v216, v216
    v_mfma_f32_16x16x32_bf16 v[68:71], a[232:235], v[224:227], v[68:71]
    v_exp_f32_e32 v217, v217
    v_mfma_f32_16x16x32_bf16 v[72:75], a[240:243], v[224:227], v[72:75]
    ds_read_b128 a[40:43], v252 offset:8960
    v_cvt_pk_bf16_f32 v236, v216, v217
    v_mfma_f32_16x16x32_bf16 v[72:75], a[244:247], v[228:231], v[72:75]
    s_mov_b32 m0, s87
    v_exp_f32_e32 v218, v218
    v_mfma_f32_16x16x32_bf16 v[76:79], a[252:255], v[228:231], v[76:79]
    v_exp_f32_e32 v219, v219
    v_mfma_f32_16x16x32_bf16 v[76:79], a[248:251], v[224:227], v[76:79]
    ds_read_b128 a[44:47], v252 offset:9216
    v_cvt_pk_bf16_f32 v237, v218, v219
    v_mfma_f32_16x16x32_bf16 v[80:83], a[96:99], v[224:227], v[80:83]
    v_exp_f32_e32 v220, v220
    v_mfma_f32_16x16x32_bf16 v[80:83], a[100:103], v[228:231], v[80:83]
    v_exp_f32_e32 v221, v221
    v_mfma_f32_16x16x32_bf16 v[84:87], a[108:111], v[228:231], v[84:87]
    ds_read_b128 a[60:63], v252 offset:13440
    v_cvt_pk_bf16_f32 v238, v220, v221
    v_mfma_f32_16x16x32_bf16 v[84:87], a[104:107], v[224:227], v[84:87]
    v_exp_f32_e32 v222, v222
    v_mfma_f32_16x16x32_bf16 v[88:91], a[112:115], v[224:227], v[88:91]
    v_exp_f32_e32 v223, v223
    v_mfma_f32_16x16x32_bf16 v[88:91], a[116:119], v[228:231], v[88:91]
    ds_read_b128 a[56:59], v252 offset:13184
    v_cvt_pk_bf16_f32 v239, v222, v223
    v_mfma_f32_16x16x32_bf16 v[92:95], a[124:127], v[228:231], v[92:95]
    buffer_load_dwordx4 v254, s[12:15], s20 offen offset:1024 nt lds
    v_mfma_f32_16x16x32_bf16 v[92:95], a[120:123], v[224:227], v[92:95]
    s_waitcnt lgkmcnt(4)
    ds_read_b128 a[52:55], v252 offset:12928
    v_mfma_f32_16x16x32_bf16 v[208:211], a[0:3], v[128:131], v[192:195]
    ds_read_b128 a[48:51], v252 offset:12672
    v_mfma_f32_16x16x32_bf16 v[208:211], a[4:7], v[132:135], v[208:211]
    ds_read_b64_tr_b16 a[76:77], v253 offset:8264
    v_mfma_f32_16x16x32_bf16 v[208:211], a[8:11], v[136:139], v[208:211]
    ds_read_b64_tr_b16 a[78:79], v253 offset:12392
    v_mfma_f32_16x16x32_bf16 v[208:211], a[12:15], v[140:143], v[208:211]
    ds_read_b64_tr_b16 a[72:73], v253 offset:8
    v_mfma_f32_16x16x32_bf16 v[212:215], a[28:31], v[140:143], v[192:195]
    ds_read_b64_tr_b16 a[74:75], v253 offset:4136
    v_mfma_f32_16x16x32_bf16 v[212:215], a[24:27], v[136:139], v[212:215]
    v_exp_f32_e32 v208, v208
    v_mfma_f32_16x16x32_bf16 v[212:215], a[20:23], v[132:135], v[212:215]
    s_mov_b32 m0, s88
    v_exp_f32_e32 v209, v209
    v_mfma_f32_16x16x32_bf16 v[212:215], a[16:19], v[128:131], v[212:215]
    v_exp_f32_e32 v210, v210
    v_mfma_f32_16x16x32_bf16 v[216:219], a[32:35], v[128:131], v[192:195]
    v_exp_f32_e32 v211, v211
    v_mfma_f32_16x16x32_bf16 v[216:219], a[36:39], v[132:135], v[216:219]
    s_waitcnt lgkmcnt(7)
    buffer_load_dwordx4 v254, s[12:15], s20 offen offset:2048 nt lds
    v_mfma_f32_16x16x32_bf16 v[216:219], a[40:43], v[136:139], v[216:219]
    v_exp_f32_e32 v212, v212
    v_mfma_f32_16x16x32_bf16 v[216:219], a[44:47], v[140:143], v[216:219]
    v_exp_f32_e32 v213, v213
    v_mfma_f32_16x16x32_bf16 v[220:223], a[60:63], v[140:143], v[192:195]
    s_waitcnt lgkmcnt(5)
    v_exp_f32_e32 v214, v214
    v_mfma_f32_16x16x32_bf16 v[220:223], a[56:59], v[136:139], v[220:223]
    v_exp_f32_e32 v215, v215
    v_mfma_f32_16x16x32_bf16 v[220:223], a[52:55], v[132:135], v[220:223]
    s_waitcnt lgkmcnt(3)
    ds_read_b64_tr_b16 a[80:81], v253 offset:256
    v_cvt_pk_bf16_f32 v224, v208, v209
    v_mfma_f32_16x16x32_bf16 v[220:223], a[48:51], v[128:131], v[220:223]
    ds_read_b64_tr_b16 a[82:83], v253 offset:4384
    v_cvt_pk_bf16_f32 v225, v210, v211
    v_smfmac_f32_16x16x64_bf16 a[204:207], a[208:211], v[232:239], v245
    v_cvt_pk_bf16_f32 v226, v212, v213
    v_mfma_f32_16x16x32_bf16 v[96:99], a[224:227], v[232:235], v[96:99]
    v_exp_f32_e32 v216, v216
    v_mfma_f32_16x16x32_bf16 v[96:99], a[228:231], v[236:239], v[96:99]
    v_exp_f32_e32 v217, v217
    v_mfma_f32_16x16x32_bf16 v[100:103], a[236:239], v[236:239], v[100:103]
    v_exp_f32_e32 v218, v218
    v_mfma_f32_16x16x32_bf16 v[100:103], a[232:235], v[232:235], v[100:103]
    v_exp_f32_e32 v219, v219
    v_mfma_f32_16x16x32_bf16 v[104:107], a[240:243], v[232:235], v[104:107]
    ds_read_b64_tr_b16 a[84:85], v253 offset:8512
    v_cvt_pk_bf16_f32 v227, v214, v215
    v_mfma_f32_16x16x32_bf16 v[104:107], a[244:247], v[236:239], v[104:107]
    s_mov_b32 m0, s89
    v_exp_f32_e32 v220, v220
    v_mfma_f32_16x16x32_bf16 v[108:111], a[252:255], v[236:239], v[108:111]
    v_exp_f32_e32 v221, v221
    v_mfma_f32_16x16x32_bf16 v[108:111], a[248:251], v[232:235], v[108:111]
    v_exp_f32_e32 v222, v222
    v_mfma_f32_16x16x32_bf16 v[112:115], a[96:99], v[232:235], v[112:115]
    v_exp_f32_e32 v223, v223
    v_mfma_f32_16x16x32_bf16 v[112:115], a[100:103], v[236:239], v[112:115]
    ds_read_b64_tr_b16 a[86:87], v253 offset:12640
    v_cvt_pk_bf16_f32 v228, v216, v217
    v_mfma_f32_16x16x32_bf16 v[116:119], a[108:111], v[236:239], v[116:119]
    ds_read_b64_tr_b16 a[92:93], v253 offset:8520
    v_cvt_pk_bf16_f32 v229, v218, v219
    v_mfma_f32_16x16x32_bf16 v[116:119], a[104:107], v[232:235], v[116:119]
    ds_read_b64_tr_b16 a[94:95], v253 offset:12648
    v_cvt_pk_bf16_f32 v230, v220, v221
    v_mfma_f32_16x16x32_bf16 v[120:123], a[112:115], v[232:235], v[120:123]
    ds_read_b64_tr_b16 a[88:89], v253 offset:264
    v_cvt_pk_bf16_f32 v231, v222, v223
    v_mfma_f32_16x16x32_bf16 v[120:123], a[116:119], v[236:239], v[120:123]
    buffer_load_dwordx4 v254, s[12:15], s20 offen offset:3072 nt lds
    v_mfma_f32_16x16x32_bf16 v[124:127], a[124:127], v[236:239], v[124:127]
    s_xor_b32 s20, s20, 16384
    ds_read_b64_tr_b16 a[90:91], v253 offset:4392
    v_mfma_f32_16x16x32_bf16 v[124:127], a[120:123], v[232:235], v[124:127]
    ds_read_b64_tr_b16 a[96:97], v253 offset:512
    v_mfma_f32_16x16x32_bf16 v[208:211], a[0:3], v[144:147], v[196:199]
    s_add_u32 s44, s44, 1
    ds_read_b64_tr_b16 a[98:99], v253 offset:4640
    v_mfma_f32_16x16x32_bf16 v[208:211], a[4:7], v[148:151], v[208:211]
    ds_read_b64_tr_b16 a[100:101], v253 offset:8768
    v_mfma_f32_16x16x32_bf16 v[208:211], a[8:11], v[152:155], v[208:211]
    ds_read_b64_tr_b16 a[102:103], v253 offset:12896
    v_mfma_f32_16x16x32_bf16 v[208:211], a[12:15], v[156:159], v[208:211]
    ds_read_b64_tr_b16 a[108:109], v253 offset:8776
    v_mfma_f32_16x16x32_bf16 v[212:215], a[28:31], v[156:159], v[196:199]
    ds_read_b64_tr_b16 a[110:111], v253 offset:12904
    v_mfma_f32_16x16x32_bf16 v[212:215], a[24:27], v[152:155], v[212:215]
    v_exp_f32_e32 v208, v208
    v_mfma_f32_16x16x32_bf16 v[212:215], a[20:23], v[148:151], v[212:215]
    s_mov_b32 m0, s67
    v_exp_f32_e32 v209, v209
    v_mfma_f32_16x16x32_bf16 v[212:215], a[16:19], v[144:147], v[212:215]
    ds_read_b64_tr_b16 a[104:105], v253 offset:520
    v_cvt_pk_bf16_f32 v232, v208, v209
    v_mfma_f32_16x16x32_bf16 v[216:219], a[32:35], v[144:147], v[196:199]
    s_waitcnt vmcnt(7)
    ds_read_b64_tr_b16 a[106:107], v253 offset:4648
    v_mov_b32_e32 v244, s44
    v_mfma_f32_16x16x32_bf16 v[216:219], a[36:39], v[148:151], v[216:219]
    buffer_load_dwordx4 v254, s[8:11], s20 offen nt lds
    v_mfma_f32_16x16x32_bf16 v[216:219], a[40:43], v[152:155], v[216:219]
    v_exp_f32_e32 v210, v210
    v_mfma_f32_16x16x32_bf16 v[216:219], a[44:47], v[156:159], v[216:219]
    v_exp_f32_e32 v211, v211
    v_mfma_f32_16x16x32_bf16 v[220:223], a[60:63], v[156:159], v[196:199]
    ds_read_b64_tr_b16 a[112:113], v253 offset:768
    v_cvt_pk_bf16_f32 v233, v210, v211
    v_mfma_f32_16x16x32_bf16 v[220:223], a[56:59], v[152:155], v[220:223]
    v_exp_f32_e32 v212, v212
    v_mfma_f32_16x16x32_bf16 v[220:223], a[52:55], v[148:151], v[220:223]
    s_mov_b32 m0, s45
    v_exp_f32_e32 v213, v213
    v_mfma_f32_16x16x32_bf16 v[220:223], a[48:51], v[144:147], v[220:223]
    ds_read_b64_tr_b16 a[114:115], v253 offset:4896
    v_cvt_pk_bf16_f32 v234, v212, v213
    v_smfmac_f32_16x16x64_bf16 a[192:195], a[208:211], v[224:231], v245
    ds_read_b64_tr_b16 a[116:117], v253 offset:9024
    v_mfma_f32_16x16x32_bf16 v[0:3], a[64:67], v[224:227], v[0:3]
    ds_read_b64_tr_b16 a[118:119], v253 offset:13152
    ds_read_b64_tr_b16 a[124:125], v253 offset:9032
    v_mfma_f32_16x16x32_bf16 v[0:3], a[68:71], v[228:231], v[0:3]
    s_waitcnt lgkmcnt(7)
    ds_read_b64_tr_b16 a[126:127], v253 offset:13160
    ds_write_addtid_b32 v244
    v_mfma_f32_16x16x32_bf16 v[4:7], a[76:79], v[228:231], v[4:7]
    ds_read_b64_tr_b16 a[120:121], v253 offset:776
    ds_read_b64_tr_b16 a[122:123], v253 offset:4904
    v_mfma_f32_16x16x32_bf16 v[4:7], a[72:75], v[224:227], v[4:7]
    v_exp_f32_e32 v214, v214
    v_mfma_f32_16x16x32_bf16 v[8:11], a[80:83], v[224:227], v[8:11]
    ds_read_b128 a[144:147], v246 offset:0
    v_mfma_f32_16x16x32_bf16 v[8:11], a[84:87], v[228:231], v[8:11]
    ds_read_b128 a[148:151], v246 offset:256
    ds_read_b128 a[152:155], v246 offset:512
    ds_read_b128 a[156:159], v246 offset:768
    v_mfma_f32_16x16x32_bf16 v[12:15], a[92:95], v[228:231], v[12:15]
    v_exp_f32_e32 v215, v215
    v_mfma_f32_16x16x32_bf16 v[12:15], a[88:91], v[224:227], v[12:15]
    v_exp_f32_e32 v216, v216
    v_mfma_f32_16x16x32_bf16 v[16:19], a[96:99], v[224:227], v[16:19]
    s_waitcnt lgkmcnt(6)
    v_exp_f32_e32 v217, v217
    v_mfma_f32_16x16x32_bf16 v[16:19], a[100:103], v[228:231], v[16:19]
    s_mov_b32 m0, s27
    v_exp_f32_e32 v218, v218
    v_mfma_f32_16x16x32_bf16 v[20:23], a[108:111], v[228:231], v[20:23]
    v_exp_f32_e32 v219, v219
    v_mfma_f32_16x16x32_bf16 v[20:23], a[104:107], v[224:227], v[20:23]
    v_cvt_pk_bf16_f32 v235, v214, v215
    v_cvt_pk_bf16_f32 v236, v216, v217
    v_mfma_f32_16x16x32_bf16 v[24:27], a[112:115], v[224:227], v[24:27]
    v_exp_f32_e32 v220, v220
    v_mfma_f32_16x16x32_bf16 v[24:27], a[116:119], v[228:231], v[24:27]
    v_exp_f32_e32 v221, v221
    v_mfma_f32_16x16x32_bf16 v[28:31], a[124:127], v[228:231], v[28:31]
    s_waitcnt lgkmcnt(4)
    v_exp_f32_e32 v222, v222
    v_mfma_f32_16x16x32_bf16 v[28:31], a[120:123], v[224:227], v[28:31]
    v_exp_f32_e32 v223, v223
    v_mfma_f32_16x16x32_bf16 v[208:211], a[0:3], v[160:163], v[200:203]
    v_cvt_pk_bf16_f32 v237, v218, v219
    v_cvt_pk_bf16_f32 v238, v220, v221
    v_mfma_f32_16x16x32_bf16 v[208:211], a[4:7], v[164:167], v[208:211]
    s_waitcnt lgkmcnt(0)
    buffer_load_dwordx4 v254, s[4:7], s21 offen nt lds
    v_mfma_f32_16x16x32_bf16 v[208:211], a[8:11], v[168:171], v[208:211]
    s_mov_b32 m0, s71
    v_cvt_pk_bf16_f32 v239, v222, v223
    v_mfma_f32_16x16x32_bf16 v[208:211], a[12:15], v[172:175], v[208:211]
    buffer_load_dwordx4 v254, s[4:7], s21 offen offset:1024 nt lds
    v_mfma_f32_16x16x32_bf16 v[212:215], a[28:31], v[172:175], v[200:203]
    s_mov_b32 m0, s68
    v_mfma_f32_16x16x32_bf16 v[212:215], a[24:27], v[168:171], v[212:215]
    buffer_load_dwordx4 v254, s[8:11], s20 offen offset:1024 nt lds
    v_mfma_f32_16x16x32_bf16 v[212:215], a[20:23], v[164:167], v[212:215]
    s_mov_b32 m0, s72
    v_exp_f32_e32 v208, v208
    v_mfma_f32_16x16x32_bf16 v[212:215], a[16:19], v[160:163], v[212:215]
    buffer_load_dwordx4 v254, s[4:7], s21 offen offset:2048 nt lds
    v_mfma_f32_16x16x32_bf16 v[216:219], a[32:35], v[160:163], v[200:203]
    s_mov_b32 m0, s73
    v_exp_f32_e32 v209, v209
    v_mfma_f32_16x16x32_bf16 v[216:219], a[36:39], v[164:167], v[216:219]
    v_exp_f32_e32 v210, v210
    v_mfma_f32_16x16x32_bf16 v[216:219], a[40:43], v[168:171], v[216:219]
    v_exp_f32_e32 v211, v211
    v_mfma_f32_16x16x32_bf16 v[216:219], a[44:47], v[172:175], v[216:219]
    buffer_load_dwordx4 v254, s[4:7], s21 offen offset:3072 nt lds
    v_mfma_f32_16x16x32_bf16 v[220:223], a[60:63], v[172:175], v[200:203]
    s_mov_b32 m0, s69
    v_exp_f32_e32 v212, v212
    v_mfma_f32_16x16x32_bf16 v[220:223], a[56:59], v[168:171], v[220:223]
    s_xor_b32 s21, s21, 16384
    buffer_load_dwordx4 v254, s[8:11], s20 offen offset:2048 nt lds
    v_mfma_f32_16x16x32_bf16 v[220:223], a[52:55], v[164:167], v[220:223]
    v_exp_f32_e32 v213, v213
    v_mfma_f32_16x16x32_bf16 v[220:223], a[48:51], v[160:163], v[220:223]
    v_exp_f32_e32 v214, v214
    v_smfmac_f32_16x16x64_bf16 a[196:199], a[208:211], v[232:239], v245
    v_cvt_pk_bf16_f32 v224, v208, v209
    v_mfma_f32_16x16x32_bf16 v[32:35], a[64:67], v[232:235], v[32:35]
    v_exp_f32_e32 v215, v215
    v_mfma_f32_16x16x32_bf16 v[32:35], a[68:71], v[236:239], v[32:35]
    ds_read_b32 v244, v255
    v_cvt_pk_bf16_f32 v225, v210, v211
    v_mfma_f32_16x16x32_bf16 v[36:39], a[76:79], v[236:239], v[36:39]
    v_exp_f32_e32 v216, v216
    v_mfma_f32_16x16x32_bf16 v[36:39], a[72:75], v[232:235], v[36:39]
    v_exp_f32_e32 v217, v217
    v_mfma_f32_16x16x32_bf16 v[40:43], a[80:83], v[232:235], v[40:43]
    v_exp_f32_e32 v218, v218
    v_mfma_f32_16x16x32_bf16 v[40:43], a[84:87], v[236:239], v[40:43]
    s_mov_b32 m0, s70
    v_exp_f32_e32 v219, v219
    v_mfma_f32_16x16x32_bf16 v[44:47], a[92:95], v[236:239], v[44:47]
    v_cvt_pk_bf16_f32 v226, v212, v213
    v_cvt_pk_bf16_f32 v227, v214, v215
    v_mfma_f32_16x16x32_bf16 v[44:47], a[88:91], v[232:235], v[44:47]
    v_exp_f32_e32 v220, v220
    v_mfma_f32_16x16x32_bf16 v[48:51], a[96:99], v[232:235], v[48:51]
    v_exp_f32_e32 v221, v221
    v_mfma_f32_16x16x32_bf16 v[48:51], a[100:103], v[236:239], v[48:51]
    s_waitcnt lgkmcnt(0)
    v_cmp_gt_u32_e32 vcc, s44, v244
    v_cvt_pk_bf16_f32 v228, v216, v217
    v_mfma_f32_16x16x32_bf16 v[52:55], a[108:111], v[236:239], v[52:55]
    v_exp_f32_e32 v222, v222
    v_mfma_f32_16x16x32_bf16 v[52:55], a[104:107], v[232:235], v[52:55]
    s_cbranch_vccnz L_rt3
L_bk3:
    v_exp_f32_e32 v223, v223
    v_mfma_f32_16x16x32_bf16 v[56:59], a[112:115], v[232:235], v[56:59]
    ds_read_b64_tr_b16 a[224:225], v253 offset:16512
    v_cvt_pk_bf16_f32 v229, v218, v219
    v_mfma_f32_16x16x32_bf16 v[56:59], a[116:119], v[236:239], v[56:59]
    ds_read_b64_tr_b16 a[226:227], v253 offset:20640
    v_cvt_pk_bf16_f32 v230, v220, v221
    v_mfma_f32_16x16x32_bf16 v[60:63], a[124:127], v[236:239], v[60:63]
    ds_read_b64_tr_b16 a[228:229], v253 offset:24768
    v_cvt_pk_bf16_f32 v231, v222, v223
    v_mfma_f32_16x16x32_bf16 v[60:63], a[120:123], v[232:235], v[60:63]
    buffer_load_dwordx4 v254, s[8:11], s20 offen offset:3072 nt lds
    v_mfma_f32_16x16x32_bf16 v[208:211], a[0:3], v[176:179], v[204:207]
    ds_read_b128 a[0:3], v252 offset:16896
    v_mfma_f32_16x16x32_bf16 v[208:211], a[4:7], v[180:183], v[208:211]
    ds_read_b128 a[4:7], v252 offset:17152
    v_mfma_f32_16x16x32_bf16 v[208:211], a[8:11], v[184:187], v[208:211]
    ds_read_b128 a[8:11], v252 offset:17408
    v_mfma_f32_16x16x32_bf16 v[208:211], a[12:15], v[188:191], v[208:211]
    ds_read_b128 a[12:15], v252 offset:17664
    v_mfma_f32_16x16x32_bf16 v[212:215], a[28:31], v[188:191], v[204:207]
    ds_read_b128 a[28:31], v252 offset:21888
    v_mfma_f32_16x16x32_bf16 v[212:215], a[24:27], v[184:187], v[212:215]
    v_exp_f32_e32 v208, v208
    v_mfma_f32_16x16x32_bf16 v[212:215], a[20:23], v[180:183], v[212:215]
    s_mov_b32 m0, s90
    v_exp_f32_e32 v209, v209
    v_mfma_f32_16x16x32_bf16 v[212:215], a[16:19], v[176:179], v[212:215]
    v_exp_f32_e32 v210, v210
    v_mfma_f32_16x16x32_bf16 v[216:219], a[32:35], v[176:179], v[204:207]
    v_exp_f32_e32 v211, v211
    v_mfma_f32_16x16x32_bf16 v[216:219], a[36:39], v[180:183], v[216:219]
    ds_read_b128 a[24:27], v252 offset:21632
    v_cvt_pk_bf16_f32 v232, v208, v209
    v_mfma_f32_16x16x32_bf16 v[216:219], a[40:43], v[184:187], v[216:219]
    ds_read_b128 a[20:23], v252 offset:21376
    v_cvt_pk_bf16_f32 v233, v210, v211
    v_mfma_f32_16x16x32_bf16 v[216:219], a[44:47], v[188:191], v[216:219]
    buffer_load_dwordx4 v254, s[12:15], s20 offen nt lds
    v_mfma_f32_16x16x32_bf16 v[220:223], a[60:63], v[188:191], v[204:207]
    v_exp_f32_e32 v212, v212
    v_mfma_f32_16x16x32_bf16 v[220:223], a[56:59], v[184:187], v[220:223]
    v_exp_f32_e32 v213, v213
    v_mfma_f32_16x16x32_bf16 v[220:223], a[52:55], v[180:183], v[220:223]
    v_exp_f32_e32 v214, v214
    v_mfma_f32_16x16x32_bf16 v[220:223], a[48:51], v[176:179], v[220:223]
    v_exp_f32_e32 v215, v215
    v_smfmac_f32_16x16x64_bf16 a[200:203], a[208:211], v[224:231], v245
    ds_read_b128 a[16:19], v252 offset:21120
    v_mfma_f32_16x16x32_bf16 v[64:67], a[64:67], v[224:227], v[64:67]
    ds_read_b128 a[32:35], v252 offset:25344
    v_cvt_pk_bf16_f32 v234, v212, v213
    v_mfma_f32_16x16x32_bf16 v[64:67], a[68:71], v[228:231], v[64:67]
    ds_read_b128 a[36:39], v252 offset:25600
    v_cvt_pk_bf16_f32 v235, v214, v215
    v_mfma_f32_16x16x32_bf16 v[68:71], a[76:79], v[228:231], v[68:71]
    v_exp_f32_e32 v216, v216
    v_mfma_f32_16x16x32_bf16 v[68:71], a[72:75], v[224:227], v[68:71]
    v_exp_f32_e32 v217, v217
    v_mfma_f32_16x16x32_bf16 v[72:75], a[80:83], v[224:227], v[72:75]
    ds_read_b128 a[40:43], v252 offset:25856
    v_cvt_pk_bf16_f32 v236, v216, v217
    v_mfma_f32_16x16x32_bf16 v[72:75], a[84:87], v[228:231], v[72:75]
    s_mov_b32 m0, s91
    v_exp_f32_e32 v218, v218
    v_mfma_f32_16x16x32_bf16 v[76:79], a[92:95], v[228:231], v[76:79]
    v_exp_f32_e32 v219, v219
    v_mfma_f32_16x16x32_bf16 v[76:79], a[88:91], v[224:227], v[76:79]
    ds_read_b128 a[44:47], v252 offset:26112
    v_cvt_pk_bf16_f32 v237, v218, v219
    v_mfma_f32_16x16x32_bf16 v[80:83], a[96:99], v[224:227], v[80:83]
    buffer_store_dwordx4 a[176:179], v255, s[16:19], s22 offen sc0 sc1 nt
    v_mfma_f32_16x16x32_bf16 v[80:83], a[100:103], v[228:231], v[80:83]
    v_exp_f32_e32 v220, v220
    v_mfma_f32_16x16x32_bf16 v[84:87], a[108:111], v[228:231], v[84:87]
    v_exp_f32_e32 v221, v221
    v_mfma_f32_16x16x32_bf16 v[84:87], a[104:107], v[224:227], v[84:87]
    ds_read_b128 a[60:63], v252 offset:30336
    v_cvt_pk_bf16_f32 v238, v220, v221
    v_mfma_f32_16x16x32_bf16 v[88:91], a[112:115], v[224:227], v[88:91]
    v_exp_f32_e32 v222, v222
    v_mfma_f32_16x16x32_bf16 v[88:91], a[116:119], v[228:231], v[88:91]
    v_exp_f32_e32 v223, v223
    v_mfma_f32_16x16x32_bf16 v[92:95], a[124:127], v[228:231], v[92:95]
    ds_read_b128 a[56:59], v252 offset:30080
    v_cvt_pk_bf16_f32 v239, v222, v223
    v_mfma_f32_16x16x32_bf16 v[92:95], a[120:123], v[224:227], v[92:95]
    s_waitcnt lgkmcnt(4)
    buffer_load_dwordx4 v254, s[12:15], s20 offen offset:1024 nt lds
    v_mfma_f32_16x16x32_bf16 v[208:211], a[0:3], v[128:131], v[192:195]
    ds_read_b128 a[52:55], v252 offset:29824
    v_mfma_f32_16x16x32_bf16 v[208:211], a[4:7], v[132:135], v[208:211]
    ds_read_b128 a[48:51], v252 offset:29568
    v_mfma_f32_16x16x32_bf16 v[208:211], a[8:11], v[136:139], v[208:211]
    ds_read_b64_tr_b16 a[230:231], v253 offset:28896
    v_mfma_f32_16x16x32_bf16 v[208:211], a[12:15], v[140:143], v[208:211]
    ds_read_b64_tr_b16 a[236:237], v253 offset:24776
    v_mfma_f32_16x16x32_bf16 v[212:215], a[28:31], v[140:143], v[192:195]
    ds_read_b64_tr_b16 a[238:239], v253 offset:28904
    v_mfma_f32_16x16x32_bf16 v[212:215], a[24:27], v[136:139], v[212:215]
    v_exp_f32_e32 v208, v208
    v_mfma_f32_16x16x32_bf16 v[212:215], a[20:23], v[132:135], v[212:215]
    s_mov_b32 m0, s92
    v_exp_f32_e32 v209, v209
    v_mfma_f32_16x16x32_bf16 v[212:215], a[16:19], v[128:131], v[212:215]
    v_exp_f32_e32 v210, v210
    v_mfma_f32_16x16x32_bf16 v[216:219], a[32:35], v[128:131], v[192:195]
    v_exp_f32_e32 v211, v211
    v_mfma_f32_16x16x32_bf16 v[216:219], a[36:39], v[132:135], v[216:219]
    s_waitcnt lgkmcnt(6)
    buffer_load_dwordx4 v254, s[12:15], s20 offen offset:2048 nt lds
    v_mfma_f32_16x16x32_bf16 v[216:219], a[40:43], v[136:139], v[216:219]
    v_exp_f32_e32 v212, v212
    v_mfma_f32_16x16x32_bf16 v[216:219], a[44:47], v[140:143], v[216:219]
    v_exp_f32_e32 v213, v213
    v_mfma_f32_16x16x32_bf16 v[220:223], a[60:63], v[140:143], v[192:195]
    s_waitcnt lgkmcnt(5)
    v_exp_f32_e32 v214, v214
    v_mfma_f32_16x16x32_bf16 v[220:223], a[56:59], v[136:139], v[220:223]
    s_waitcnt lgkmcnt(4)
    v_exp_f32_e32 v215, v215
    v_mfma_f32_16x16x32_bf16 v[220:223], a[52:55], v[132:135], v[220:223]
    s_waitcnt lgkmcnt(3)
    ds_read_b64_tr_b16 a[232:233], v253 offset:16520
    v_cvt_pk_bf16_f32 v224, v208, v209
    v_mfma_f32_16x16x32_bf16 v[220:223], a[48:51], v[128:131], v[220:223]
    ds_read_b64_tr_b16 a[234:235], v253 offset:20648
    v_cvt_pk_bf16_f32 v225, v210, v211
    v_smfmac_f32_16x16x64_bf16 a[204:207], a[208:211], v[232:239], v245
    v_cvt_pk_bf16_f32 v226, v212, v213
    v_mfma_f32_16x16x32_bf16 v[96:99], a[64:67], v[232:235], v[96:99]
    v_exp_f32_e32 v216, v216
    v_mfma_f32_16x16x32_bf16 v[96:99], a[68:71], v[236:239], v[96:99]
    v_exp_f32_e32 v217, v217
    v_mfma_f32_16x16x32_bf16 v[100:103], a[76:79], v[236:239], v[100:103]
    v_exp_f32_e32 v218, v218
    v_mfma_f32_16x16x32_bf16 v[100:103], a[72:75], v[232:235], v[100:103]
    v_exp_f32_e32 v219, v219
    v_mfma_f32_16x16x32_bf16 v[104:107], a[80:83], v[232:235], v[104:107]
    ds_read_b64_tr_b16 a[240:241], v253 offset:16768
    v_cvt_pk_bf16_f32 v227, v214, v215
    v_mfma_f32_16x16x32_bf16 v[104:107], a[84:87], v[236:239], v[104:107]
    s_mov_b32 m0, s93
    v_exp_f32_e32 v220, v220
    v_mfma_f32_16x16x32_bf16 v[108:111], a[92:95], v[236:239], v[108:111]
    v_exp_f32_e32 v221, v221
    v_mfma_f32_16x16x32_bf16 v[108:111], a[88:91], v[232:235], v[108:111]
    v_exp_f32_e32 v222, v222
    v_mfma_f32_16x16x32_bf16 v[112:115], a[96:99], v[232:235], v[112:115]
    v_exp_f32_e32 v223, v223
    v_mfma_f32_16x16x32_bf16 v[112:115], a[100:103], v[236:239], v[112:115]
    ds_read_b64_tr_b16 a[242:243], v253 offset:20896
    v_cvt_pk_bf16_f32 v228, v216, v217
    v_mfma_f32_16x16x32_bf16 v[116:119], a[108:111], v[236:239], v[116:119]
    ds_read_b64_tr_b16 a[244:245], v253 offset:25024
    v_cvt_pk_bf16_f32 v229, v218, v219
    v_mfma_f32_16x16x32_bf16 v[116:119], a[104:107], v[232:235], v[116:119]
    ds_read_b64_tr_b16 a[246:247], v253 offset:29152
    v_cvt_pk_bf16_f32 v230, v220, v221
    v_mfma_f32_16x16x32_bf16 v[120:123], a[112:115], v[232:235], v[120:123]
    ds_read_b64_tr_b16 a[252:253], v253 offset:25032
    v_cvt_pk_bf16_f32 v231, v222, v223
    v_mfma_f32_16x16x32_bf16 v[120:123], a[116:119], v[236:239], v[120:123]
    buffer_load_dwordx4 v254, s[12:15], s20 offen offset:3072 nt lds
    v_mfma_f32_16x16x32_bf16 v[124:127], a[124:127], v[236:239], v[124:127]
    s_xor_b32 s20, s20, 114688
    ds_read_b64_tr_b16 a[254:255], v253 offset:29160
    v_mfma_f32_16x16x32_bf16 v[124:127], a[120:123], v[232:235], v[124:127]
    s_add_u32 s20, s20, 8388608
    ds_read_b64_tr_b16 a[248:249], v253 offset:16776
    v_mfma_f32_16x16x32_bf16 v[208:211], a[0:3], v[144:147], v[196:199]
    s_and_b32 s10, s10, s49
    ds_read_b64_tr_b16 a[250:251], v253 offset:20904
    v_mfma_f32_16x16x32_bf16 v[208:211], a[4:7], v[148:151], v[208:211]
    s_and_b32 s20, s20, s49
    ds_read_b64_tr_b16 a[96:97], v253 offset:17024
    v_mfma_f32_16x16x32_bf16 v[208:211], a[8:11], v[152:155], v[208:211]
    s_and_b32 s14, s14, s49
    ds_read_b64_tr_b16 a[98:99], v253 offset:21152
    v_mfma_f32_16x16x32_bf16 v[208:211], a[12:15], v[156:159], v[208:211]
    s_add_u32 s44, s44, 1
    ds_read_b64_tr_b16 a[100:101], v253 offset:25280
    v_mfma_f32_16x16x32_bf16 v[212:215], a[28:31], v[156:159], v[196:199]
    ds_read_b64_tr_b16 a[102:103], v253 offset:29408
    v_mfma_f32_16x16x32_bf16 v[212:215], a[24:27], v[152:155], v[212:215]
    v_exp_f32_e32 v208, v208
    v_mfma_f32_16x16x32_bf16 v[212:215], a[20:23], v[148:151], v[212:215]
    s_mov_b32 m0, s23
    v_exp_f32_e32 v209, v209
    v_mfma_f32_16x16x32_bf16 v[212:215], a[16:19], v[144:147], v[212:215]
    ds_read_b64_tr_b16 a[108:109], v253 offset:25288
    v_cvt_pk_bf16_f32 v232, v208, v209
    v_mfma_f32_16x16x32_bf16 v[216:219], a[32:35], v[144:147], v[196:199]
    ds_read_b64_tr_b16 a[110:111], v253 offset:29416
    v_mov_b32_e32 v244, s44
    v_mfma_f32_16x16x32_bf16 v[216:219], a[36:39], v[148:151], v[216:219]
    buffer_store_dwordx4 a[180:183], v255, s[16:19], s22 offen offset:1024 sc0 sc1 nt
    v_mfma_f32_16x16x32_bf16 v[216:219], a[40:43], v[152:155], v[216:219]
    buffer_load_dwordx4 v254, s[8:11], s20 offen nt lds
    v_mfma_f32_16x16x32_bf16 v[216:219], a[44:47], v[156:159], v[216:219]
    v_exp_f32_e32 v210, v210
    v_mfma_f32_16x16x32_bf16 v[220:223], a[60:63], v[156:159], v[196:199]
    v_exp_f32_e32 v211, v211
    v_mfma_f32_16x16x32_bf16 v[220:223], a[56:59], v[152:155], v[220:223]
    s_waitcnt vmcnt(15)
    ds_read_b64_tr_b16 a[104:105], v253 offset:17032
    v_cvt_pk_bf16_f32 v233, v210, v211
    v_mfma_f32_16x16x32_bf16 v[220:223], a[52:55], v[148:151], v[220:223]
    s_mov_b32 m0, s45
    v_exp_f32_e32 v212, v212
    v_mfma_f32_16x16x32_bf16 v[220:223], a[48:51], v[144:147], v[220:223]
    ds_read_b64_tr_b16 a[106:107], v253 offset:21160
    ds_read_b64_tr_b16 a[112:113], v253 offset:17280
    v_smfmac_f32_16x16x64_bf16 a[192:195], a[208:211], v[224:231], v245
    ds_read_b64_tr_b16 a[114:115], v253 offset:21408
    v_mfma_f32_16x16x32_bf16 v[0:3], a[224:227], v[224:227], v[0:3]
    s_waitcnt lgkmcnt(6)
    ds_read_b64_tr_b16 a[116:117], v253 offset:25536
    ds_read_b64_tr_b16 a[118:119], v253 offset:29664
    v_mfma_f32_16x16x32_bf16 v[0:3], a[228:231], v[228:231], v[0:3]
    ds_read_b64_tr_b16 a[124:125], v253 offset:25544
    ds_read_b64_tr_b16 a[126:127], v253 offset:29672
    v_mfma_f32_16x16x32_bf16 v[4:7], a[236:239], v[228:231], v[4:7]
    ds_write_addtid_b32 v244
    ds_read_b64_tr_b16 a[120:121], v253 offset:17288
    v_mfma_f32_16x16x32_bf16 v[4:7], a[232:235], v[224:227], v[4:7]
    ds_read_b64_tr_b16 a[122:123], v253 offset:21416
    v_mfma_f32_16x16x32_bf16 v[8:11], a[240:243], v[224:227], v[8:11]
    v_exp_f32_e32 v213, v213
    v_mfma_f32_16x16x32_bf16 v[8:11], a[244:247], v[228:231], v[8:11]
    v_exp_f32_e32 v214, v214
    v_mfma_f32_16x16x32_bf16 v[12:15], a[252:255], v[228:231], v[12:15]
    v_exp_f32_e32 v215, v215
    v_mfma_f32_16x16x32_bf16 v[12:15], a[248:251], v[224:227], v[12:15]
    v_exp_f32_e32 v216, v216
    v_mfma_f32_16x16x32_bf16 v[16:19], a[96:99], v[224:227], v[16:19]
    v_exp_f32_e32 v217, v217
    v_mfma_f32_16x16x32_bf16 v[16:19], a[100:103], v[228:231], v[16:19]
    s_waitcnt lgkmcnt(10)
    v_exp_f32_e32 v218, v218
    v_mfma_f32_16x16x32_bf16 v[20:23], a[108:111], v[228:231], v[20:23]
    s_waitcnt lgkmcnt(8)
    v_exp_f32_e32 v219, v219
    v_mfma_f32_16x16x32_bf16 v[20:23], a[104:107], v[224:227], v[20:23]
    s_waitcnt lgkmcnt(7)
    v_cvt_pk_bf16_f32 v234, v212, v213
    v_cvt_pk_bf16_f32 v235, v214, v215
    v_mfma_f32_16x16x32_bf16 v[24:27], a[112:115], v[224:227], v[24:27]
    s_waitcnt lgkmcnt(5)
    v_exp_f32_e32 v220, v220
    v_mfma_f32_16x16x32_bf16 v[24:27], a[116:119], v[228:231], v[24:27]
    s_waitcnt lgkmcnt(3)
    v_exp_f32_e32 v221, v221
    v_mfma_f32_16x16x32_bf16 v[28:31], a[124:127], v[228:231], v[28:31]
    s_waitcnt lgkmcnt(0)
    v_exp_f32_e32 v222, v222
    v_mfma_f32_16x16x32_bf16 v[28:31], a[120:123], v[224:227], v[28:31]
    s_mov_b32 m0, s94
    v_exp_f32_e32 v223, v223
    v_mfma_f32_16x16x32_bf16 v[208:211], a[0:3], v[160:163], v[200:203]
    v_cvt_pk_bf16_f32 v236, v216, v217
    v_cvt_pk_bf16_f32 v237, v218, v219
    v_mfma_f32_16x16x32_bf16 v[208:211], a[4:7], v[164:167], v[208:211]
    v_cvt_pk_bf16_f32 v238, v220, v221
    v_cvt_pk_bf16_f32 v239, v222, v223
    v_mfma_f32_16x16x32_bf16 v[208:211], a[8:11], v[168:171], v[208:211]
    buffer_load_dwordx4 v254, s[8:11], s20 offen offset:1024 nt lds
    v_mfma_f32_16x16x32_bf16 v[208:211], a[12:15], v[172:175], v[208:211]
    v_mfma_f32_16x16x32_bf16 v[212:215], a[28:31], v[172:175], v[200:203]
    v_mfma_f32_16x16x32_bf16 v[212:215], a[24:27], v[168:171], v[212:215]
    v_exp_f32_e32 v208, v208
    v_mfma_f32_16x16x32_bf16 v[212:215], a[20:23], v[164:167], v[212:215]
    s_mov_b32 m0, s95
    v_exp_f32_e32 v209, v209
    v_mfma_f32_16x16x32_bf16 v[212:215], a[16:19], v[160:163], v[212:215]
    v_exp_f32_e32 v210, v210
    v_mfma_f32_16x16x32_bf16 v[216:219], a[32:35], v[160:163], v[200:203]
    s_waitcnt vmcnt(10)
    ds_read_b128 a[160:163], v246 offset:0
    v_cvt_pk_bf16_f32 v224, v208, v209
    v_mfma_f32_16x16x32_bf16 v[216:219], a[36:39], v[164:167], v[216:219]
    ds_read_b128 a[164:167], v246 offset:256
    v_accvgpr_write_b32 a218, v251
    v_mfma_f32_16x16x32_bf16 v[216:219], a[40:43], v[168:171], v[216:219]
    ds_read_b128 a[168:171], v246 offset:512
    v_cmp_ngt_f32_e64 s[30:31], s26, v251
    v_mfma_f32_16x16x32_bf16 v[216:219], a[44:47], v[172:175], v[216:219]
    v_exp_f32_e32 v211, v211
    v_mfma_f32_16x16x32_bf16 v[220:223], a[60:63], v[172:175], v[200:203]
    s_or_b64 s[28:29], s[28:29], s[30:31]
    ds_read_b128 a[172:175], v246 offset:768
    v_cvt_pk_bf16_f32 v225, v210, v211
    v_mfma_f32_16x16x32_bf16 v[220:223], a[56:59], v[168:171], v[220:223]
    buffer_load_dwordx4 v254, s[8:11], s20 offen offset:2048 nt lds
    v_mfma_f32_16x16x32_bf16 v[220:223], a[52:55], v[164:167], v[220:223]
    s_mov_b32 m0, s27
    v_exp_f32_e32 v212, v212
    v_mfma_f32_16x16x32_bf16 v[220:223], a[48:51], v[160:163], v[220:223]
    v_exp_f32_e32 v213, v213
    v_smfmac_f32_16x16x64_bf16 a[196:199], a[208:211], v[232:239], v245
    v_cvt_pk_bf16_f32 v226, v212, v213
    v_mfma_f32_16x16x32_bf16 v[32:35], a[224:227], v[232:235], v[32:35]
    v_exp_f32_e32 v214, v214
    v_mfma_f32_16x16x32_bf16 v[32:35], a[228:231], v[236:239], v[32:35]
    ds_read_b32 v244, v255
    v_mfma_f32_16x16x32_bf16 v[36:39], a[236:239], v[236:239], v[36:39]
    v_exp_f32_e32 v215, v215
    v_mfma_f32_16x16x32_bf16 v[36:39], a[232:235], v[232:235], v[36:39]
    v_exp_f32_e32 v216, v216
    v_mfma_f32_16x16x32_bf16 v[40:43], a[240:243], v[232:235], v[40:43]
    v_exp_f32_e32 v217, v217
    v_mfma_f32_16x16x32_bf16 v[40:43], a[244:247], v[236:239], v[40:43]
    v_exp_f32_e32 v218, v218
    v_mfma_f32_16x16x32_bf16 v[44:47], a[252:255], v[236:239], v[44:47]
    v_exp_f32_e32 v219, v219
    v_mfma_f32_16x16x32_bf16 v[44:47], a[248:251], v[232:235], v[44:47]
    v_cvt_pk_bf16_f32 v227, v214, v215
    v_cvt_pk_bf16_f32 v228, v216, v217
    v_mfma_f32_16x16x32_bf16 v[48:51], a[96:99], v[232:235], v[48:51]
    v_exp_f32_e32 v220, v220
    v_mfma_f32_16x16x32_bf16 v[48:51], a[100:103], v[236:239], v[48:51]
    s_waitcnt lgkmcnt(0)
    v_cmp_gt_u32_e32 vcc, s44, v244
    v_cvt_pk_bf16_f32 v229, v218, v219
    v_mfma_f32_16x16x32_bf16 v[52:55], a[108:111], v[236:239], v[52:55]
    v_exp_f32_e32 v221, v221
    v_mfma_f32_16x16x32_bf16 v[52:55], a[104:107], v[232:235], v[52:55]
    s_cbranch_vccnz L_rt4
L_bk4:
    v_exp_f32_e32 v222, v222
    v_mfma_f32_16x16x32_bf16 v[56:59], a[112:115], v[232:235], v[56:59]
    v_exp_f32_e32 v223, v223
    v_mfma_f32_16x16x32_bf16 v[56:59], a[116:119], v[236:239], v[56:59]
    buffer_load_dwordx4 v254, s[4:7], s21 offen nt lds
    v_mfma_f32_16x16x32_bf16 v[60:63], a[124:127], v[236:239], v[60:63]
    s_mov_b32 m0, s96
    ds_read_b64_tr_b16 a[64:65], v253 offset:33024
    v_cvt_pk_bf16_f32 v230, v220, v221
    v_mfma_f32_16x16x32_bf16 v[60:63], a[120:123], v[232:235], v[60:63]
    ds_read_b64_tr_b16 a[66:67], v253 offset:37152
    v_cvt_pk_bf16_f32 v231, v222, v223
L_bnd:
L_mid:
    v_mfma_f32_16x16x32_bf16 v[208:211], a[0:3], v[176:179], v[204:207]
    buffer_load_dwordx4 v254, s[8:11], s20 offen offset:3072 nt lds
    v_mfma_f32_16x16x32_bf16 v[208:211], a[4:7], v[180:183], v[208:211]
    ds_read_b128 a[0:3], v252 offset:33792
    v_mfma_f32_16x16x32_bf16 v[208:211], a[8:11], v[184:187], v[208:211]
    ds_read_b128 a[4:7], v252 offset:34048
    v_mfma_f32_16x16x32_bf16 v[208:211], a[12:15], v[188:191], v[208:211]
    ds_read_b128 a[8:11], v252 offset:34304
    v_mfma_f32_16x16x32_bf16 v[212:215], a[28:31], v[188:191], v[204:207]
    ds_read_b128 a[12:15], v252 offset:34560
    v_mfma_f32_16x16x32_bf16 v[212:215], a[24:27], v[184:187], v[212:215]
    v_exp_f32_e32 v208, v208
    v_mfma_f32_16x16x32_bf16 v[212:215], a[20:23], v[180:183], v[212:215]
    s_mov_b32 m0, s71
    v_exp_f32_e32 v209, v209
    v_mfma_f32_16x16x32_bf16 v[212:215], a[16:19], v[176:179], v[212:215]
    v_exp_f32_e32 v210, v210
    v_mfma_f32_16x16x32_bf16 v[216:219], a[32:35], v[176:179], v[204:207]
    v_exp_f32_e32 v211, v211
    v_mfma_f32_16x16x32_bf16 v[216:219], a[36:39], v[180:183], v[216:219]
    ds_read_b128 a[28:31], v252 offset:38784
    v_cvt_pk_bf16_f32 v232, v208, v209
    v_mfma_f32_16x16x32_bf16 v[216:219], a[40:43], v[184:187], v[216:219]
    buffer_load_dwordx4 v254, s[4:7], s21 offen offset:1024 nt lds
    v_mfma_f32_16x16x32_bf16 v[216:219], a[44:47], v[188:191], v[216:219]
    s_mov_b32 m0, s24
    ds_read_b128 a[24:27], v252 offset:38528
    v_cvt_pk_bf16_f32 v233, v210, v211
    v_mfma_f32_16x16x32_bf16 v[220:223], a[60:63], v[188:191], v[204:207]
    buffer_load_dwordx4 v254, s[12:15], s20 offen nt lds
    v_mfma_f32_16x16x32_bf16 v[220:223], a[56:59], v[184:187], v[220:223]
    v_exp_f32_e32 v212, v212
    v_mfma_f32_16x16x32_bf16 v[220:223], a[52:55], v[180:183], v[220:223]
    v_exp_f32_e32 v213, v213
    v_mfma_f32_16x16x32_bf16 v[220:223], a[48:51], v[176:179], v[220:223]
    ds_read_b128 a[20:23], v252 offset:38272
    v_cvt_pk_bf16_f32 v234, v212, v213
    v_smfmac_f32_16x16x64_bf16 a[200:203], a[208:211], v[224:231], v245
    ds_read_b128 a[16:19], v252 offset:38016
    v_mfma_f32_16x16x32_bf16 v[64:67], a[224:227], v[224:227], v[64:67]
    v_exp_f32_e32 v214, v214
    v_mfma_f32_16x16x32_bf16 v[64:67], a[228:231], v[228:231], v[64:67]
    v_exp_f32_e32 v215, v215
    v_mfma_f32_16x16x32_bf16 v[68:71], a[236:239], v[228:231], v[68:71]
    ds_read_b128 a[32:35], v252 offset:42240
    v_cvt_pk_bf16_f32 v235, v214, v215
    v_mfma_f32_16x16x32_bf16 v[68:71], a[232:235], v[224:227], v[68:71]
    v_exp_f32_e32 v216, v216
    v_mfma_f32_16x16x32_bf16 v[72:75], a[240:243], v[224:227], v[72:75]
    v_exp_f32_e32 v217, v217
    v_mfma_f32_16x16x32_bf16 v[72:75], a[244:247], v[228:231], v[72:75]
    s_mov_b32 m0, s64
    ds_read_b128 a[36:39], v252 offset:42496
    v_cvt_pk_bf16_f32 v236, v216, v217
    v_mfma_f32_16x16x32_bf16 v[76:79], a[252:255], v[228:231], v[76:79]
    v_exp_f32_e32 v218, v218
    v_mfma_f32_16x16x32_bf16 v[76:79], a[248:251], v[224:227], v[76:79]
    v_exp_f32_e32 v219, v219
    v_mfma_f32_16x16x32_bf16 v[80:83], a[96:99], v[224:227], v[80:83]
    ds_read_b128 a[40:43], v252 offset:42752
    v_cvt_pk_bf16_f32 v237, v218, v219
    v_mfma_f32_16x16x32_bf16 v[80:83], a[100:103], v[228:231], v[80:83]
    v_exp_f32_e32 v220, v220
    v_mfma_f32_16x16x32_bf16 v[84:87], a[108:111], v[228:231], v[84:87]
    v_exp_f32_e32 v221, v221
    v_mfma_f32_16x16x32_bf16 v[84:87], a[104:107], v[224:227], v[84:87]
    ds_read_b128 a[44:47], v252 offset:43008
    v_cvt_pk_bf16_f32 v238, v220, v221
    v_mfma_f32_16x16x32_bf16 v[88:91], a[112:115], v[224:227], v[88:91]
    v_exp_f32_e32 v222, v222
    v_mfma_f32_16x16x32_bf16 v[88:91], a[116:119], v[228:231], v[88:91]
    v_exp_f32_e32 v223, v223
    v_mfma_f32_16x16x32_bf16 v[92:95], a[124:127], v[228:231], v[92:95]
    ds_read_b128 a[60:63], v252 offset:47232
    v_cvt_pk_bf16_f32 v239, v222, v223
    v_mfma_f32_16x16x32_bf16 v[92:95], a[120:123], v[224:227], v[92:95]
    s_waitcnt lgkmcnt(4)
    buffer_load_dwordx4 v254, s[12:15], s20 offen offset:1024 nt lds
    v_mfma_f32_16x16x32_bf16 v[208:211], a[0:3], v[128:131], v[192:195]
    s_mov_b32 m0, s72
    ds_read_b128 a[56:59], v252 offset:46976
    v_mfma_f32_16x16x32_bf16 v[208:211], a[4:7], v[132:135], v[208:211]
    buffer_load_dwordx4 v254, s[4:7], s21 offen offset:2048 nt lds
    v_mfma_f32_16x16x32_bf16 v[208:211], a[8:11], v[136:139], v[208:211]
    ds_read_b128 a[52:55], v252 offset:46720
    v_mfma_f32_16x16x32_bf16 v[208:211], a[12:15], v[140:143], v[208:211]
    ds_read_b128 a[48:51], v252 offset:46464
    v_mfma_f32_16x16x32_bf16 v[212:215], a[28:31], v[140:143], v[192:195]
    ds_read_b64_tr_b16 a[68:69], v253 offset:41280
    v_mfma_f32_16x16x32_bf16 v[212:215], a[24:27], v[136:139], v[212:215]
    v_exp_f32_e32 v208, v208
    v_mfma_f32_16x16x32_bf16 v[212:215], a[20:23], v[132:135], v[212:215]
    s_mov_b32 m0, s65
    v_exp_f32_e32 v209, v209
    v_mfma_f32_16x16x32_bf16 v[212:215], a[16:19], v[128:131], v[212:215]
    v_exp_f32_e32 v210, v210
    v_mfma_f32_16x16x32_bf16 v[216:219], a[32:35], v[128:131], v[192:195]
    s_waitcnt lgkmcnt(5)
    v_exp_f32_e32 v211, v211
    v_mfma_f32_16x16x32_bf16 v[216:219], a[36:39], v[132:135], v[216:219]
    buffer_load_dwordx4 v254, s[12:15], s20 offen offset:2048 nt lds
    v_mfma_f32_16x16x32_bf16 v[216:219], a[40:43], v[136:139], v[216:219]
    v_exp_f32_e32 v212, v212
    v_mfma_f32_16x16x32_bf16 v[216:219], a[44:47], v[140:143], v[216:219]
    s_waitcnt lgkmcnt(4)
    v_exp_f32_e32 v213, v213
    v_mfma_f32_16x16x32_bf16 v[220:223], a[60:63], v[140:143], v[192:195]
    s_waitcnt lgkmcnt(3)
    v_exp_f32_e32 v214, v214
    v_mfma_f32_16x16x32_bf16 v[220:223], a[56:59], v[136:139], v[220:223]
    s_waitcnt lgkmcnt(2)
    v_exp_f32_e32 v215, v215
    v_mfma_f32_16x16x32_bf16 v[220:223], a[52:55], v[132:135], v[220:223]
    s_waitcnt lgkmcnt(1)
    ds_read_b64_tr_b16 a[70:71], v253 offset:45408
    v_cvt_pk_bf16_f32 v224, v208, v209
    v_mfma_f32_16x16x32_bf16 v[220:223], a[48:51], v[128:131], v[220:223]
    ds_read_b64_tr_b16 a[76:77], v253 offset:41288
    v_cvt_pk_bf16_f32 v225, v210, v211
    v_smfmac_f32_16x16x64_bf16 a[204:207], a[208:211], v[232:239], v245
    v_cvt_pk_bf16_f32 v226, v212, v213
    v_mfma_f32_16x16x32_bf16 v[96:99], a[224:227], v[232:235], v[96:99]
    v_exp_f32_e32 v216, v216
    v_mfma_f32_16x16x32_bf16 v[96:99], a[228:231], v[236:239], v[96:99]
    v_exp_f32_e32 v217, v217
    v_mfma_f32_16x16x32_bf16 v[100:103], a[236:239], v[236:239], v[100:103]
    v_exp_f32_e32 v218, v218
    v_mfma_f32_16x16x32_bf16 v[100:103], a[232:235], v[232:235], v[100:103]
    v_exp_f32_e32 v219, v219
    v_mfma_f32_16x16x32_bf16 v[104:107], a[240:243], v[232:235], v[104:107]
    ds_read_b64_tr_b16 a[78:79], v253 offset:45416
    v_cvt_pk_bf16_f32 v227, v214, v215
    v_mfma_f32_16x16x32_bf16 v[104:107], a[244:247], v[236:239], v[104:107]
    s_mov_b32 m0, s73
    v_exp_f32_e32 v220, v220
    v_mfma_f32_16x16x32_bf16 v[108:111], a[252:255], v[236:239], v[108:111]
    v_exp_f32_e32 v221, v221
    v_mfma_f32_16x16x32_bf16 v[108:111], a[248:251], v[232:235], v[108:111]
    v_exp_f32_e32 v222, v222
    v_mfma_f32_16x16x32_bf16 v[112:115], a[96:99], v[232:235], v[112:115]
    v_exp_f32_e32 v223, v223
    v_mfma_f32_16x16x32_bf16 v[112:115], a[100:103], v[236:239], v[112:115]
    ds_read_b64_tr_b16 a[72:73], v253 offset:33032
    v_cvt_pk_bf16_f32 v228, v216, v217
    v_mfma_f32_16x16x32_bf16 v[116:119], a[108:111], v[236:239], v[116:119]
    ds_read_b64_tr_b16 a[74:75], v253 offset:37160
    v_cvt_pk_bf16_f32 v229, v218, v219
    v_mfma_f32_16x16x32_bf16 v[116:119], a[104:107], v[232:235], v[116:119]
    buffer_load_dwordx4 v254, s[4:7], s21 offen offset:3072 nt lds
    v_mfma_f32_16x16x32_bf16 v[120:123], a[112:115], v[232:235], v[120:123]
    s_mov_b32 m0, s66
    ds_read_b64_tr_b16 a[80:81], v253 offset:33280
    v_cvt_pk_bf16_f32 v230, v220, v221
    v_mfma_f32_16x16x32_bf16 v[120:123], a[116:119], v[236:239], v[120:123]
    ds_read_b64_tr_b16 a[82:83], v253 offset:37408
    v_cvt_pk_bf16_f32 v231, v222, v223
    v_mfma_f32_16x16x32_bf16 v[124:127], a[124:127], v[236:239], v[124:127]
    buffer_load_dwordx4 v254, s[12:15], s20 offen offset:3072 nt lds
    v_mfma_f32_16x16x32_bf16 v[124:127], a[120:123], v[232:235], v[124:127]
    s_xor_b32 s20, s20, 16384
    ds_read_b64_tr_b16 a[84:85], v253 offset:41536
    v_mfma_f32_16x16x32_bf16 v[208:211], a[0:3], v[144:147], v[196:199]
    s_add_u32 s44, s44, 1
    ds_read_b64_tr_b16 a[86:87], v253 offset:45664
    v_mfma_f32_16x16x32_bf16 v[208:211], a[4:7], v[148:151], v[208:211]
    ds_read_b64_tr_b16 a[92:93], v253 offset:41544
    v_mfma_f32_16x16x32_bf16 v[208:211], a[8:11], v[152:155], v[208:211]
    ds_read_b64_tr_b16 a[94:95], v253 offset:45672
    v_mfma_f32_16x16x32_bf16 v[208:211], a[12:15], v[156:159], v[208:211]
    ds_read_b64_tr_b16 a[88:89], v253 offset:33288
    v_mfma_f32_16x16x32_bf16 v[212:215], a[28:31], v[156:159], v[196:199]
    ds_read_b64_tr_b16 a[90:91], v253 offset:37416
    v_mfma_f32_16x16x32_bf16 v[212:215], a[24:27], v[152:155], v[212:215]
    v_exp_f32_e32 v208, v208
    v_mfma_f32_16x16x32_bf16 v[212:215], a[20:23], v[148:151], v[212:215]
    s_mov_b32 m0, s74
    v_exp_f32_e32 v209, v209
    v_mfma_f32_16x16x32_bf16 v[212:215], a[16:19], v[144:147], v[212:215]
    ds_read_b64_tr_b16 a[96:97], v253 offset:33536
    v_cvt_pk_bf16_f32 v232, v208, v209
    v_mfma_f32_16x16x32_bf16 v[216:219], a[32:35], v[144:147], v[196:199]
    ds_read_b64_tr_b16 a[98:99], v253 offset:37664
    v_mov_b32_e32 v244, s44
    v_mfma_f32_16x16x32_bf16 v[216:219], a[36:39], v[148:151], v[216:219]
    buffer_load_dwordx4 v254, s[8:11], s20 offen nt lds
    v_mfma_f32_16x16x32_bf16 v[216:219], a[40:43], v[152:155], v[216:219]
    v_exp_f32_e32 v210, v210
    v_mfma_f32_16x16x32_bf16 v[216:219], a[44:47], v[156:159], v[216:219]
    v_exp_f32_e32 v211, v211
    v_mfma_f32_16x16x32_bf16 v[220:223], a[60:63], v[156:159], v[196:199]
    ds_read_b64_tr_b16 a[100:101], v253 offset:41792
    ds_read_b64_tr_b16 a[102:103], v253 offset:45920
    v_mfma_f32_16x16x32_bf16 v[220:223], a[56:59], v[152:155], v[220:223]
    s_waitcnt vmcnt(14)
    ds_read_b64_tr_b16 a[108:109], v253 offset:41800
    ds_read_b64_tr_b16 a[110:111], v253 offset:45928
    v_mfma_f32_16x16x32_bf16 v[220:223], a[52:55], v[148:151], v[220:223]
    s_mov_b32 m0, s45
    ds_read_b64_tr_b16 a[104:105], v253 offset:33544
    ds_read_b64_tr_b16 a[106:107], v253 offset:37672
    v_mfma_f32_16x16x32_bf16 v[220:223], a[48:51], v[144:147], v[220:223]
    ds_read_b64_tr_b16 a[112:113], v253 offset:33792
    ds_read_b64_tr_b16 a[114:115], v253 offset:37920
    v_smfmac_f32_16x16x64_bf16 a[192:195], a[208:211], v[224:231], v245
    ds_read_b64_tr_b16 a[116:117], v253 offset:42048
    v_mfma_f32_16x16x32_bf16 v[0:3], a[64:67], v[224:227], v[0:3]
    s_waitcnt lgkmcnt(11)
    ds_read_b64_tr_b16 a[118:119], v253 offset:46176
    ds_read_b64_tr_b16 a[124:125], v253 offset:42056
    v_mfma_f32_16x16x32_bf16 v[0:3], a[68:71], v[228:231], v[0:3]
    ds_read_b64_tr_b16 a[126:127], v253 offset:46184
    ds_write_addtid_b32 v244
    v_mfma_f32_16x16x32_bf16 v[4:7], a[76:79], v[228:231], v[4:7]
    ds_read_b64_tr_b16 a[120:121], v253 offset:33800
    ds_read_b64_tr_b16 a[122:123], v253 offset:37928
    v_mfma_f32_16x16x32_bf16 v[4:7], a[72:75], v[224:227], v[4:7]
    v_exp_f32_e32 v212, v212
    v_mfma_f32_16x16x32_bf16 v[8:11], a[80:83], v[224:227], v[8:11]
    v_exp_f32_e32 v213, v213
    v_mfma_f32_16x16x32_bf16 v[8:11], a[84:87], v[228:231], v[8:11]
    v_exp_f32_e32 v214, v214
    v_mfma_f32_16x16x32_bf16 v[12:15], a[92:95], v[228:231], v[12:15]
    v_exp_f32_e32 v215, v215
    v_mfma_f32_16x16x32_bf16 v[12:15], a[88:91], v[224:227], v[12:15]
    s_waitcnt lgkmcnt(13)
    v_cvt_pk_bf16_f32 v233, v210, v211
    v_cvt_pk_bf16_f32 v234, v212, v213
    v_mfma_f32_16x16x32_bf16 v[16:19], a[96:99], v[224:227], v[16:19]
    v_exp_f32_e32 v216, v216
    v_mfma_f32_16x16x32_bf16 v[16:19], a[100:103], v[228:231], v[16:19]
    s_waitcnt lgkmcnt(9)
    v_exp_f32_e32 v217, v217
    v_mfma_f32_16x16x32_bf16 v[20:23], a[108:111], v[228:231], v[20:23]
    s_waitcnt lgkmcnt(2)
    v_exp_f32_e32 v218, v218
    v_mfma_f32_16x16x32_bf16 v[20:23], a[104:107], v[224:227], v[20:23]
    s_mov_b32 m0, s75
    v_exp_f32_e32 v219, v219
    v_mfma_f32_16x16x32_bf16 v[24:27], a[112:115], v[224:227], v[24:27]
    v_cvt_pk_bf16_f32 v235, v214, v215
    v_cvt_pk_bf16_f32 v236, v216, v217
    v_mfma_f32_16x16x32_bf16 v[24:27], a[116:119], v[228:231], v[24:27]
    v_exp_f32_e32 v220, v220
    v_mfma_f32_16x16x32_bf16 v[28:31], a[124:127], v[228:231], v[28:31]
    s_waitcnt lgkmcnt(0)
    v_exp_f32_e32 v221, v221
    v_mfma_f32_16x16x32_bf16 v[28:31], a[120:123], v[224:227], v[28:31]
    v_exp_f32_e32 v222, v222
    v_mfma_f32_16x16x32_bf16 v[208:211], a[0:3], v[160:163], v[200:203]
    v_exp_f32_e32 v223, v223
    v_mfma_f32_16x16x32_bf16 v[208:211], a[4:7], v[164:167], v[208:211]
    v_cvt_pk_bf16_f32 v237, v218, v219
    v_cvt_pk_bf16_f32 v238, v220, v221
    v_mfma_f32_16x16x32_bf16 v[208:211], a[8:11], v[168:171], v[208:211]
    buffer_store_dwordx4 a[184:187], v255, s[16:19], s22 offen offset:2048 sc0 sc1 nt
    v_mfma_f32_16x16x32_bf16 v[208:211], a[12:15], v[172:175], v[208:211]
    buffer_load_dwordx4 v254, s[8:11], s20 offen offset:1024 nt lds
    v_mfma_f32_16x16x32_bf16 v[212:215], a[28:31], v[172:175], v[200:203]
    v_cvt_pk_bf16_f32 v239, v222, v223
    v_mfma_f32_16x16x32_bf16 v[212:215], a[24:27], v[168:171], v[212:215]
    v_exp_f32_e32 v208, v208
    v_mfma_f32_16x16x32_bf16 v[212:215], a[20:23], v[164:167], v[212:215]
    s_mov_b32 m0, s76
    v_exp_f32_e32 v209, v209
    v_mfma_f32_16x16x32_bf16 v[212:215], a[16:19], v[160:163], v[212:215]
    v_exp_f32_e32 v210, v210
    v_mfma_f32_16x16x32_bf16 v[216:219], a[32:35], v[160:163], v[200:203]
    v_exp_f32_e32 v211, v211
    v_mfma_f32_16x16x32_bf16 v[216:219], a[36:39], v[164:167], v[216:219]
    buffer_load_dwordx4 v254, s[8:11], s20 offen offset:2048 nt lds
    v_mfma_f32_16x16x32_bf16 v[216:219], a[40:43], v[168:171], v[216:219]
    v_exp_f32_e32 v212, v212
    v_mfma_f32_16x16x32_bf16 v[216:219], a[44:47], v[172:175], v[216:219]
    v_exp_f32_e32 v213, v213
    v_mfma_f32_16x16x32_bf16 v[220:223], a[60:63], v[172:175], v[200:203]
    v_exp_f32_e32 v214, v214
    v_mfma_f32_16x16x32_bf16 v[220:223], a[56:59], v[168:171], v[220:223]
    v_exp_f32_e32 v215, v215
    v_mfma_f32_16x16x32_bf16 v[220:223], a[52:55], v[164:167], v[220:223]
    v_cvt_pk_bf16_f32 v224, v208, v209
    v_cvt_pk_bf16_f32 v225, v210, v211
    v_mfma_f32_16x16x32_bf16 v[220:223], a[48:51], v[160:163], v[220:223]
    v_exp_f32_e32 v216, v216
    v_smfmac_f32_16x16x64_bf16 a[196:199], a[208:211], v[232:239], v245
    v_cvt_pk_bf16_f32 v226, v212, v213
    v_mfma_f32_16x16x32_bf16 v[32:35], a[64:67], v[232:235], v[32:35]
    v_exp_f32_e32 v217, v217
    v_mfma_f32_16x16x32_bf16 v[32:35], a[68:71], v[236:239], v[32:35]
    ds_read_b32 v244, v255
    v_cvt_pk_bf16_f32 v227, v214, v215
    v_mfma_f32_16x16x32_bf16 v[36:39], a[76:79], v[236:239], v[36:39]
    v_exp_f32_e32 v218, v218
    v_mfma_f32_16x16x32_bf16 v[36:39], a[72:75], v[232:235], v[36:39]
    v_exp_f32_e32 v219, v219
    v_mfma_f32_16x16x32_bf16 v[40:43], a[80:83], v[232:235], v[40:43]
    v_exp_f32_e32 v220, v220
    v_mfma_f32_16x16x32_bf16 v[40:43], a[84:87], v[236:239], v[40:43]
    s_mov_b32 m0, s77
    v_exp_f32_e32 v221, v221
    v_mfma_f32_16x16x32_bf16 v[44:47], a[92:95], v[236:239], v[44:47]
    v_exp_f32_e32 v222, v222
    v_mfma_f32_16x16x32_bf16 v[44:47], a[88:91], v[232:235], v[44:47]
    v_exp_f32_e32 v223, v223
    v_mfma_f32_16x16x32_bf16 v[48:51], a[96:99], v[232:235], v[48:51]
    v_cvt_pk_bf16_f32 v228, v216, v217
    v_cvt_pk_bf16_f32 v229, v218, v219
    v_mfma_f32_16x16x32_bf16 v[48:51], a[100:103], v[236:239], v[48:51]
    s_waitcnt lgkmcnt(0)
    v_cmp_gt_u32_e32 vcc, s44, v244
    v_cvt_pk_bf16_f32 v230, v220, v221
    v_mfma_f32_16x16x32_bf16 v[52:55], a[108:111], v[236:239], v[52:55]
    buffer_load_dwordx4 v254, s[8:11], s20 offen offset:3072 nt lds
    v_mfma_f32_16x16x32_bf16 v[52:55], a[104:107], v[232:235], v[52:55]
    s_cbranch_vccnz L_rt5
L_bk5:
    ds_read_b64_tr_b16 a[224:225], v253 offset:49536
    v_cvt_pk_bf16_f32 v231, v222, v223
    v_mfma_f32_16x16x32_bf16 v[56:59], a[112:115], v[232:235], v[56:59]
    ds_read_b64_tr_b16 a[226:227], v253 offset:53664
    v_mfma_f32_16x16x32_bf16 v[56:59], a[116:119], v[236:239], v[56:59]
    ds_read_b64_tr_b16 a[228:229], v253 offset:57792
    v_mfma_f32_16x16x32_bf16 v[60:63], a[124:127], v[236:239], v[60:63]
    ds_read_b64_tr_b16 a[230:231], v253 offset:61920
    v_mfma_f32_16x16x32_bf16 v[60:63], a[120:123], v[232:235], v[60:63]
    ds_read_b64_tr_b16 a[236:237], v253 offset:57800
    v_mfma_f32_16x16x32_bf16 v[208:211], a[0:3], v[176:179], v[204:207]
    s_add_u32 s25, s25, 1
    ds_read_b128 a[0:3], v252 offset:50688
    v_mfma_f32_16x16x32_bf16 v[208:211], a[4:7], v[180:183], v[208:211]
    ds_read_b128 a[4:7], v252 offset:50944
    v_mfma_f32_16x16x32_bf16 v[208:211], a[8:11], v[184:187], v[208:211]
    ds_read_b128 a[8:11], v252 offset:51200
    v_mfma_f32_16x16x32_bf16 v[208:211], a[12:15], v[188:191], v[208:211]
    ds_read_b128 a[12:15], v252 offset:51456
    v_mfma_f32_16x16x32_bf16 v[212:215], a[28:31], v[188:191], v[204:207]
    ds_read_b128 a[28:31], v252 offset:55680
    v_mfma_f32_16x16x32_bf16 v[212:215], a[24:27], v[184:187], v[212:215]
    v_exp_f32_e32 v208, v208
    v_mfma_f32_16x16x32_bf16 v[212:215], a[20:23], v[180:183], v[212:215]
    s_mov_b32 m0, s78
    v_exp_f32_e32 v209, v209
    v_mfma_f32_16x16x32_bf16 v[212:215], a[16:19], v[176:179], v[212:215]
    v_exp_f32_e32 v210, v210
    v_mfma_f32_16x16x32_bf16 v[216:219], a[32:35], v[176:179], v[204:207]
    buffer_store_dwordx4 a[188:191], v255, s[16:19], s22 offen offset:3072 sc0 sc1 nt
    v_mfma_f32_16x16x32_bf16 v[216:219], a[36:39], v[180:183], v[216:219]
    s_xor_b32 s22, s22, 49152
    v_exp_f32_e32 v211, v211
    v_mfma_f32_16x16x32_bf16 v[216:219], a[40:43], v[184:187], v[216:219]
    s_add_u32 s22, s22, s48
    ds_read_b128 a[24:27], v252 offset:55424
    v_cvt_pk_bf16_f32 v232, v208, v209
    v_mfma_f32_16x16x32_bf16 v[216:219], a[44:47], v[188:191], v[216:219]
    s_mov_b32 s18, 0x4000000
    ds_read_b128 a[20:23], v252 offset:55168
    v_cvt_pk_bf16_f32 v233, v210, v211
    v_mfma_f32_16x16x32_bf16 v[220:223], a[60:63], v[188:191], v[204:207]
    s_mov_b32 s48, 16777216
    buffer_load_dwordx4 v254, s[12:15], s20 offen nt lds
    v_mfma_f32_16x16x32_bf16 v[220:223], a[56:59], v[184:187], v[220:223]
    v_exp_f32_e32 v212, v212
    v_mfma_f32_16x16x32_bf16 v[220:223], a[52:55], v[180:183], v[220:223]
    v_exp_f32_e32 v213, v213
    v_mfma_f32_16x16x32_bf16 v[220:223], a[48:51], v[176:179], v[220:223]
    v_exp_f32_e32 v214, v214
    v_smfmac_f32_16x16x64_bf16 a[200:203], a[208:211], v[224:231], v245
    ds_read_b128 a[16:19], v252 offset:54912
    v_mfma_f32_16x16x32_bf16 v[64:67], a[64:67], v[224:227], v[64:67]
    v_exp_f32_e32 v215, v215
    v_mfma_f32_16x16x32_bf16 v[64:67], a[68:71], v[228:231], v[64:67]
    ds_read_b128 a[32:35], v252 offset:59136
    v_cvt_pk_bf16_f32 v234, v212, v213
    v_mfma_f32_16x16x32_bf16 v[68:71], a[76:79], v[228:231], v[68:71]
    ds_read_b128 a[36:39], v252 offset:59392
    v_cvt_pk_bf16_f32 v235, v214, v215
    v_mfma_f32_16x16x32_bf16 v[68:71], a[72:75], v[224:227], v[68:71]
    v_exp_f32_e32 v216, v216
    v_mfma_f32_16x16x32_bf16 v[72:75], a[80:83], v[224:227], v[72:75]
    v_exp_f32_e32 v217, v217
    v_mfma_f32_16x16x32_bf16 v[72:75], a[84:87], v[228:231], v[72:75]
    s_mov_b32 m0, s79
    ds_read_b128 a[40:43], v252 offset:59648
    v_cvt_pk_bf16_f32 v236, v216, v217
    v_mfma_f32_16x16x32_bf16 v[76:79], a[92:95], v[228:231], v[76:79]
    v_exp_f32_e32 v218, v218
    v_mfma_f32_16x16x32_bf16 v[76:79], a[88:91], v[224:227], v[76:79]
    v_exp_f32_e32 v219, v219
    v_mfma_f32_16x16x32_bf16 v[80:83], a[96:99], v[224:227], v[80:83]
    ds_read_b128 a[44:47], v252 offset:59904
    v_cvt_pk_bf16_f32 v237, v218, v219
    v_mfma_f32_16x16x32_bf16 v[80:83], a[100:103], v[228:231], v[80:83]
    v_exp_f32_e32 v220, v220
    v_mfma_f32_16x16x32_bf16 v[84:87], a[108:111], v[228:231], v[84:87]
    v_exp_f32_e32 v221, v221
    v_mfma_f32_16x16x32_bf16 v[84:87], a[104:107], v[224:227], v[84:87]
    ds_read_b128 a[60:63], v252 offset:64128
    v_cvt_pk_bf16_f32 v238, v220, v221
    v_mfma_f32_16x16x32_bf16 v[88:91], a[112:115], v[224:227], v[88:91]
    v_exp_f32_e32 v222, v222
    v_mfma_f32_16x16x32_bf16 v[88:91], a[116:119], v[228:231], v[88:91]
    v_exp_f32_e32 v223, v223
    v_mfma_f32_16x16x32_bf16 v[92:95], a[124:127], v[228:231], v[92:95]
    ds_read_b128 a[56:59], v252 offset:63872
    v_cvt_pk_bf16_f32 v239, v222, v223
    v_mfma_f32_16x16x32_bf16 v[92:95], a[120:123], v[224:227], v[92:95]
    s_waitcnt lgkmcnt(4)
    buffer_load_dwordx4 v254, s[12:15], s20 offen offset:1024 nt lds
    v_mfma_f32_16x16x32_bf16 v[208:211], a[0:3], v[128:131], v[192:195]
    ds_read_b128 a[52:55], v252 offset:63616
    v_mfma_f32_16x16x32_bf16 v[208:211], a[4:7], v[132:135], v[208:211]
    ds_read_b128 a[48:51], v252 offset:63360
    v_mfma_f32_16x16x32_bf16 v[208:211], a[8:11], v[136:139], v[208:211]
    ds_read_b64_tr_b16 a[238:239], v253 offset:61928
    v_mfma_f32_16x16x32_bf16 v[208:211], a[12:15], v[140:143], v[208:211]
    ds_read_b64_tr_b16 a[232:233], v253 offset:49544
    v_mfma_f32_16x16x32_bf16 v[212:215], a[28:31], v[140:143], v[192:195]
    ds_read_b64_tr_b16 a[234:235], v253 offset:53672
    v_mfma_f32_16x16x32_bf16 v[212:215], a[24:27], v[136:139], v[212:215]
    v_exp_f32_e32 v208, v208
    v_mfma_f32_16x16x32_bf16 v[212:215], a[20:23], v[132:135], v[212:215]
    s_mov_b32 m0, s80
    v_exp_f32_e32 v209, v209
    v_mfma_f32_16x16x32_bf16 v[212:215], a[16:19], v[128:131], v[212:215]
    v_exp_f32_e32 v210, v210
    v_mfma_f32_16x16x32_bf16 v[216:219], a[32:35], v[128:131], v[192:195]
    buffer_load_dwordx4 v254, s[12:15], s20 offen offset:2048 nt lds
    v_mfma_f32_16x16x32_bf16 v[216:219], a[36:39], v[132:135], v[216:219]
    s_waitcnt lgkmcnt(6)
    v_exp_f32_e32 v211, v211
    v_mfma_f32_16x16x32_bf16 v[216:219], a[40:43], v[136:139], v[216:219]
    v_exp_f32_e32 v212, v212
    v_mfma_f32_16x16x32_bf16 v[216:219], a[44:47], v[140:143], v[216:219]
    v_exp_f32_e32 v213, v213
    v_mfma_f32_16x16x32_bf16 v[220:223], a[60:63], v[140:143], v[192:195]
    s_waitcnt lgkmcnt(5)
    v_exp_f32_e32 v214, v214
    v_mfma_f32_16x16x32_bf16 v[220:223], a[56:59], v[136:139], v[220:223]
    s_waitcnt lgkmcnt(4)
    v_exp_f32_e32 v215, v215
    v_mfma_f32_16x16x32_bf16 v[220:223], a[52:55], v[132:135], v[220:223]
    s_waitcnt lgkmcnt(3)
    ds_read_b64_tr_b16 a[240:241], v253 offset:49792
    v_cvt_pk_bf16_f32 v224, v208, v209
    v_mfma_f32_16x16x32_bf16 v[220:223], a[48:51], v[128:131], v[220:223]
    ds_read_b64_tr_b16 a[242:243], v253 offset:53920
    v_cvt_pk_bf16_f32 v225, v210, v211
    v_smfmac_f32_16x16x64_bf16 a[204:207], a[208:211], v[232:239], v245
    v_cvt_pk_bf16_f32 v226, v212, v213
    v_mfma_f32_16x16x32_bf16 v[96:99], a[64:67], v[232:235], v[96:99]
    v_exp_f32_e32 v216, v216
    v_mfma_f32_16x16x32_bf16 v[96:99], a[68:71], v[236:239], v[96:99]
    v_exp_f32_e32 v217, v217
    v_mfma_f32_16x16x32_bf16 v[100:103], a[76:79], v[236:239], v[100:103]
    v_exp_f32_e32 v218, v218
    v_mfma_f32_16x16x32_bf16 v[100:103], a[72:75], v[232:235], v[100:103]
    v_exp_f32_e32 v219, v219
    v_mfma_f32_16x16x32_bf16 v[104:107], a[80:83], v[232:235], v[104:107]
    ds_read_b64_tr_b16 a[244:245], v253 offset:58048
    v_cvt_pk_bf16_f32 v227, v214, v215
    v_mfma_f32_16x16x32_bf16 v[104:107], a[84:87], v[236:239], v[104:107]
    s_mov_b32 m0, s81
    v_exp_f32_e64 v220, v220
    v_mfma_f32_16x16x32_bf16 v[108:111], a[92:95], v[236:239], v[108:111]
    v_exp_f32_e64 v221, v221
    v_mfma_f32_16x16x32_bf16 v[108:111], a[88:91], v[232:235], v[108:111]
    s_waitcnt vmcnt(10)
    ds_read_b128 a[176:179], v246 offset:0
    v_cvt_pk_bf16_f32 v228, v216, v217
    v_mfma_f32_16x16x32_bf16 v[112:115], a[96:99], v[232:235], v[112:115]
    ds_read_b128 a[180:183], v246 offset:256
    v_cvt_pk_bf16_f32 v229, v218, v219
    v_mfma_f32_16x16x32_bf16 v[112:115], a[100:103], v[236:239], v[112:115]
    ds_read_b128 a[184:187], v246 offset:512
    v_cvt_pk_bf16_f32 v230, v220, v221
    v_mfma_f32_16x16x32_bf16 v[116:119], a[108:111], v[236:239], v[116:119]
    buffer_load_dwordx4 v254, s[12:15], s20 offen offset:3072 nt lds
    v_mfma_f32_16x16x32_bf16 v[116:119], a[104:107], v[232:235], v[116:119]
    s_xor_b32 s20, s20, 49152
    v_exp_f32_e32 v222, v222
    v_mfma_f32_16x16x32_bf16 v[120:123], a[112:115], v[232:235], v[120:123]
    v_exp_f32_e64 v223, v223
    v_mfma_f32_16x16x32_bf16 v[120:123], a[116:119], v[236:239], v[120:123]
    ds_read_b128 a[188:191], v246 offset:768
    v_cvt_pk_bf16_f32 v231, v222, v223
    v_mfma_f32_16x16x32_bf16 v[124:127], a[124:127], v[236:239], v[124:127]
    ds_read_b64_tr_b16 a[246:247], v253 offset:62176
    v_mfma_f32_16x16x32_bf16 v[124:127], a[120:123], v[232:235], v[124:127]
    ds_read_b64_tr_b16 a[252:253], v253 offset:58056
    v_mfma_f32_4x4x4_16b_bf16 v[136:139], a[212:213], a[128:129], 0
    ds_read_b64_tr_b16 a[254:255], v253 offset:62184
    v_mfma_f32_4x4x4_16b_bf16 v[192:195], a[212:213], a[130:131], 0
    ds_read_b64_tr_b16 a[248:249], v253 offset:49800
    v_mfma_f32_4x4x4_16b_bf16 v[136:139], a[214:215], a[128:129], v[136:139]
    ds_read_b64_tr_b16 a[250:251], v253 offset:53928
    v_mfma_f32_4x4x4_16b_bf16 v[140:143], a[212:213], a[132:133], 0
    ds_read_b64_tr_b16 a[96:97], v253 offset:50048
    v_mfma_f32_4x4x4_16b_bf16 v[192:195], a[214:215], a[130:131], v[192:195]
    ds_read_b64_tr_b16 a[98:99], v253 offset:54176
    v_mfma_f32_4x4x4_16b_bf16 v[248:251], a[212:213], a[134:135], 0
    v_cvt_pk_bf16_f32 v128, v136, v137
    v_mfma_f32_4x4x4_16b_bf16 v[140:143], a[214:215], a[132:133], v[140:143]
    v_cvt_pk_bf16_f32 v129, v138, v139
    v_mfma_f32_4x4x4_16b_bf16 v[136:139], a[212:213], a[136:137], 0
    v_cvt_pk_bf16_f32 v130, v192, v193
    v_mfma_f32_4x4x4_16b_bf16 v[248:251], a[214:215], a[134:135], v[248:251]
    v_cvt_pk_bf16_f32 v131, v194, v195
    v_mfma_f32_4x4x4_16b_bf16 v[192:195], a[212:213], a[138:139], 0
    v_cvt_pk_bf16_f32 v132, v140, v141
    v_mfma_f32_4x4x4_16b_bf16 v[136:139], a[214:215], a[136:137], v[136:139]
    v_cvt_pk_bf16_f32 v133, v142, v143
    v_mfma_f32_4x4x4_16b_bf16 v[140:143], a[212:213], a[140:141], 0
    v_cvt_pk_bf16_f32 v134, v248, v249
    v_mfma_f32_4x4x4_16b_bf16 v[192:195], a[214:215], a[138:139], v[192:195]
    v_cvt_pk_bf16_f32 v135, v250, v251
    v_mfma_f32_4x4x4_16b_bf16 v[248:251], a[212:213], a[142:143], 0
    ds_read_b64_tr_b16 a[100:101], v253 offset:58304
    v_mfma_f32_4x4x4_16b_bf16 v[140:143], a[214:215], a[140:141], v[140:143]
    ds_read_b64_tr_b16 a[102:103], v253 offset:62432
    v_mfma_f32_4x4x4_16b_bf16 v[248:251], a[214:215], a[142:143], v[248:251]
    ds_read_b64_tr_b16 a[108:109], v253 offset:58312
    v_mfma_f32_16x16x32_bf16 v[208:211], a[0:3], v[144:147], v[196:199]
    s_add_u32 s44, s44, 1
    ds_read_b64_tr_b16 a[110:111], v253 offset:62440
    v_cvt_pk_bf16_f32 v140, v140, v141
    v_mfma_f32_16x16x32_bf16 v[208:211], a[4:7], v[148:151], v[208:211]
    ds_read_b64_tr_b16 a[104:105], v253 offset:50056
    v_cvt_pk_bf16_f32 v141, v142, v143
    v_mfma_f32_16x16x32_bf16 v[208:211], a[8:11], v[152:155], v[208:211]
    ds_read_b64_tr_b16 a[106:107], v253 offset:54184
    v_cvt_pk_bf16_f32 v142, v248, v249
    v_mfma_f32_16x16x32_bf16 v[208:211], a[12:15], v[156:159], v[208:211]
    ds_read_b64_tr_b16 a[112:113], v253 offset:50304
    v_cvt_pk_bf16_f32 v143, v250, v251
    v_mfma_f32_16x16x32_bf16 v[212:215], a[28:31], v[156:159], v[196:199]
    ds_read_b64_tr_b16 a[114:115], v253 offset:54432
    v_cvt_pk_bf16_f32 v136, v136, v137
    v_mfma_f32_16x16x32_bf16 v[212:215], a[24:27], v[152:155], v[212:215]
    ds_read_b64_tr_b16 a[116:117], v253 offset:58560
    v_cvt_pk_bf16_f32 v137, v138, v139
    v_mfma_f32_16x16x32_bf16 v[212:215], a[20:23], v[148:151], v[212:215]
    s_mov_b32 m0, s82
    ds_read_b64_tr_b16 a[118:119], v253 offset:62688
    v_cvt_pk_bf16_f32 v138, v192, v193
    v_mfma_f32_16x16x32_bf16 v[212:215], a[16:19], v[144:147], v[212:215]
    ds_read_b64_tr_b16 a[124:125], v253 offset:58568
    v_cvt_pk_bf16_f32 v139, v194, v195
    v_mfma_f32_16x16x32_bf16 v[216:219], a[32:35], v[144:147], v[196:199]
    buffer_load_dwordx4 v254, s[8:11], s20 offen nt lds
    v_mfma_f32_16x16x32_bf16 v[216:219], a[36:39], v[148:151], v[216:219]
    ds_read_b64_tr_b16 a[126:127], v253 offset:62696
    v_mov_b32_e32 v244, s44
    v_mfma_f32_16x16x32_bf16 v[216:219], a[40:43], v[152:155], v[216:219]
    v_exp_f32_e32 v208, v208
    v_mfma_f32_16x16x32_bf16 v[216:219], a[44:47], v[156:159], v[216:219]
    v_exp_f32_e32 v209, v209
    v_mfma_f32_16x16x32_bf16 v[220:223], a[60:63], v[156:159], v[196:199]
    ds_read_b64_tr_b16 a[120:121], v253 offset:50312
    v_cvt_pk_bf16_f32 v232, v208, v209
    v_mfma_f32_16x16x32_bf16 v[220:223], a[56:59], v[152:155], v[220:223]
    s_waitcnt vmcnt(11)
    v_exp_f32_e32 v210, v210
    v_mfma_f32_16x16x32_bf16 v[220:223], a[52:55], v[148:151], v[220:223]
    s_mov_b32 m0, s45
    v_exp_f32_e64 v211, v211
    v_mfma_f32_16x16x32_bf16 v[220:223], a[48:51], v[144:147], v[220:223]
    ds_read_b64_tr_b16 a[122:123], v253 offset:54440
    v_cvt_pk_bf16_f32 v233, v210, v211
    v_smfmac_f32_16x16x64_bf16 a[192:195], a[208:211], v[224:231], v245
    ds_write_addtid_b32 v244
    v_mfma_f32_16x16x32_bf16 v[0:3], a[224:227], v[224:227], v[0:3]
    v_exp_f32_e64 v212, v212
    v_mfma_f32_16x16x32_bf16 v[0:3], a[228:231], v[228:231], v[0:3]
    s_waitcnt lgkmcnt(6)
    v_exp_f32_e32 v213, v213
    v_mfma_f32_16x16x32_bf16 v[4:7], a[236:239], v[228:231], v[4:7]
    v_exp_f32_e64 v214, v214
    v_mfma_f32_16x16x32_bf16 v[4:7], a[232:235], v[224:227], v[4:7]
    v_exp_f32_e64 v215, v215
    v_mfma_f32_16x16x32_bf16 v[8:11], a[240:243], v[224:227], v[8:11]
    v_exp_f32_e64 v216, v216
    v_mfma_f32_16x16x32_bf16 v[8:11], a[244:247], v[228:231], v[8:11]
    v_exp_f32_e64 v217, v217
    v_mfma_f32_16x16x32_bf16 v[12:15], a[252:255], v[228:231], v[12:15]
    v_accvgpr_read_b32 v240, a192
    v_accvgpr_read_b32 v241, a193
    v_add_f32_e32 v241, v241, v240
    v_rcp_f32_e32 v240, v241
    v_cmp_ngt_f32_e64 s[30:31], s26, v241
    v_accvgpr_read_b32 v241, a218
    v_mul_f32_e64 v241, -v241, v240
    v_pk_fma_f32 v[0:1], v[0:1], v[240:241], v[240:241] op_sel:[0,0,1] op_sel_hi:[1,0,1]
    v_pk_fma_f32 v[2:3], v[2:3], v[240:241], v[240:241] op_sel:[0,0,1] op_sel_hi:[1,0,1]
    v_pk_fma_f32 v[4:5], v[4:5], v[240:241], v[240:241] op_sel:[0,0,1] op_sel_hi:[1,0,1]
    v_pk_fma_f32 v[6:7], v[6:7], v[240:241], v[240:241] op_sel:[0,0,1] op_sel_hi:[1,0,1]
    v_mfma_f32_16x16x32_bf16 v[12:15], a[248:251], v[224:227], v[12:15]
    s_waitcnt lgkmcnt(0)
    v_exp_f32_e32 v218, v218
    v_mfma_f32_16x16x32_bf16 v[16:19], a[96:99], v[224:227], v[16:19]
    s_mov_b32 m0, s83
    v_exp_f32_e32 v219, v219
    v_mfma_f32_16x16x32_bf16 v[16:19], a[100:103], v[228:231], v[16:19]
    s_or_b64 s[28:29], s[28:29], s[30:31]
    v_cvt_pk_bf16_f32 v0, v0, v1
    v_cvt_pk_bf16_f32 v234, v212, v213
    v_mfma_f32_16x16x32_bf16 v[20:23], a[108:111], v[228:231], v[20:23]
    v_cvt_pk_bf16_f32 v1, v2, v3
    v_cvt_pk_bf16_f32 v235, v214, v215
    v_mfma_f32_16x16x32_bf16 v[20:23], a[104:107], v[224:227], v[20:23]
    v_cvt_pk_bf16_f32 v2, v4, v5
    v_cvt_pk_bf16_f32 v3, v6, v7
    v_mfma_f32_16x16x32_bf16 v[24:27], a[112:115], v[224:227], v[24:27]
    v_exp_f32_e32 v220, v220
    v_mfma_f32_16x16x32_bf16 v[24:27], a[116:119], v[228:231], v[24:27]
    v_exp_f32_e64 v221, v221
    v_mfma_f32_16x16x32_bf16 v[28:31], a[124:127], v[228:231], v[28:31]
    ds_write_b128 v242, v[0:3] offset:0
    v_pk_fma_f32 v[8:9], v[8:9], v[240:241], v[240:241] op_sel:[0,0,1] op_sel_hi:[1,0,1]
    v_pk_fma_f32 v[10:11], v[10:11], v[240:241], v[240:241] op_sel:[0,0,1] op_sel_hi:[1,0,1]
    v_pk_fma_f32 v[12:13], v[12:13], v[240:241], v[240:241] op_sel:[0,0,1] op_sel_hi:[1,0,1]
    v_pk_fma_f32 v[14:15], v[14:15], v[240:241], v[240:241] op_sel:[0,0,1] op_sel_hi:[1,0,1]
    v_mfma_f32_16x16x32_bf16 v[28:31], a[120:123], v[224:227], v[28:31]
    v_exp_f32_e64 v222, v222
    v_mfma_f32_16x16x32_bf16 v[208:211], a[0:3], v[160:163], v[200:203]
    v_exp_f32_e64 v223, v223
    v_mfma_f32_16x16x32_bf16 v[208:211], a[4:7], v[164:167], v[208:211]
    v_cvt_pk_bf16_f32 v236, v216, v217
    v_cvt_pk_bf16_f32 v237, v218, v219
    v_mfma_f32_16x16x32_bf16 v[208:211], a[8:11], v[168:171], v[208:211]
    v_cvt_pk_bf16_f32 v8, v8, v9
    v_cvt_pk_bf16_f32 v238, v220, v221
    v_mfma_f32_16x16x32_bf16 v[208:211], a[12:15], v[172:175], v[208:211]
    v_cvt_pk_bf16_f32 v9, v10, v11
    v_cvt_pk_bf16_f32 v239, v222, v223
    v_mfma_f32_16x16x32_bf16 v[212:215], a[28:31], v[172:175], v[200:203]
    v_cvt_pk_bf16_f32 v10, v12, v13
    v_cvt_pk_bf16_f32 v11, v14, v15
    v_mfma_f32_16x16x32_bf16 v[212:215], a[24:27], v[168:171], v[212:215]
    ds_write_b128 v242, v[8:11] offset:64
    v_pk_fma_f32 v[16:17], v[16:17], v[240:241], v[240:241] op_sel:[0,0,1] op_sel_hi:[1,0,1]
    v_pk_fma_f32 v[18:19], v[18:19], v[240:241], v[240:241] op_sel:[0,0,1] op_sel_hi:[1,0,1]
    v_pk_fma_f32 v[20:21], v[20:21], v[240:241], v[240:241] op_sel:[0,0,1] op_sel_hi:[1,0,1]
    v_pk_fma_f32 v[22:23], v[22:23], v[240:241], v[240:241] op_sel:[0,0,1] op_sel_hi:[1,0,1]
    v_mfma_f32_16x16x32_bf16 v[212:215], a[20:23], v[164:167], v[212:215]
    buffer_load_dwordx4 v254, s[8:11], s20 offen offset:1024 nt lds
    v_mfma_f32_16x16x32_bf16 v[212:215], a[16:19], v[160:163], v[212:215]
    s_mov_b32 m0, s84
    v_cvt_pk_bf16_f32 v16, v16, v17
    v_accvgpr_write_b32 a192, 0
    v_mfma_f32_16x16x32_bf16 v[216:219], a[32:35], v[160:163], v[200:203]
    v_cvt_pk_bf16_f32 v17, v18, v19
    v_accvgpr_write_b32 a193, 0
    v_mfma_f32_16x16x32_bf16 v[216:219], a[36:39], v[164:167], v[216:219]
    v_cvt_pk_bf16_f32 v18, v20, v21
    v_cvt_pk_bf16_f32 v19, v22, v23
    v_mfma_f32_16x16x32_bf16 v[216:219], a[40:43], v[168:171], v[216:219]
    buffer_load_dwordx4 v254, s[8:11], s20 offen offset:2048 nt lds
    v_mfma_f32_16x16x32_bf16 v[216:219], a[44:47], v[172:175], v[216:219]
    ds_write_b128 v242, v[16:19] offset:128
    v_pk_fma_f32 v[24:25], v[24:25], v[240:241], v[240:241] op_sel:[0,0,1] op_sel_hi:[1,0,1]
    v_pk_fma_f32 v[26:27], v[26:27], v[240:241], v[240:241] op_sel:[0,0,1] op_sel_hi:[1,0,1]
    v_pk_fma_f32 v[28:29], v[28:29], v[240:241], v[240:241] op_sel:[0,0,1] op_sel_hi:[1,0,1]
    v_pk_fma_f32 v[30:31], v[30:31], v[240:241], v[240:241] op_sel:[0,0,1] op_sel_hi:[1,0,1]
    v_mfma_f32_16x16x32_bf16 v[220:223], a[60:63], v[172:175], v[200:203]
    v_cvt_pk_bf16_f32 v24, v24, v25
    v_cvt_pk_bf16_f32 v25, v26, v27
    v_mfma_f32_16x16x32_bf16 v[220:223], a[56:59], v[168:171], v[220:223]
    v_cvt_pk_bf16_f32 v26, v28, v29
    v_cvt_pk_bf16_f32 v27, v30, v31
    v_mfma_f32_16x16x32_bf16 v[220:223], a[52:55], v[164:167], v[220:223]
    v_exp_f32_e32 v208, v208
    v_mfma_f32_16x16x32_bf16 v[220:223], a[48:51], v[160:163], v[220:223]
    v_exp_f32_e32 v209, v209
    v_smfmac_f32_16x16x64_bf16 a[196:199], a[208:211], v[232:239], v245
    v_cvt_pk_bf16_f32 v224, v208, v209
    v_mfma_f32_16x16x32_bf16 v[32:35], a[224:227], v[232:235], v[32:35]
    v_exp_f32_e32 v210, v210
    v_mfma_f32_16x16x32_bf16 v[32:35], a[228:231], v[236:239], v[32:35]
    ds_write_b128 v242, v[24:27] offset:192
    v_mfma_f32_16x16x32_bf16 v[36:39], a[236:239], v[236:239], v[36:39]
    v_exp_f32_e32 v211, v211
    v_mfma_f32_16x16x32_bf16 v[36:39], a[232:235], v[232:235], v[36:39]
    ds_read_b128 a[128:131], v247 offset:0
    v_cvt_pk_bf16_f32 v225, v210, v211
    v_mfma_f32_16x16x32_bf16 v[40:43], a[240:243], v[232:235], v[40:43]
    v_exp_f32_e32 v212, v212
    v_mfma_f32_16x16x32_bf16 v[40:43], a[244:247], v[236:239], v[40:43]
    s_mov_b32 m0, s85
    v_exp_f32_e32 v213, v213
    v_mfma_f32_16x16x32_bf16 v[44:47], a[252:255], v[236:239], v[44:47]
    v_exp_f32_e64 v214, v214
    v_mfma_f32_16x16x32_bf16 v[44:47], a[248:251], v[232:235], v[44:47]
    buffer_load_dwordx4 v254, s[8:11], s20 offen offset:3072 nt lds
    v_mfma_f32_16x16x32_bf16 v[48:51], a[96:99], v[232:235], v[48:51]
    v_exp_f32_e64 v215, v215
    v_mfma_f32_16x16x32_bf16 v[48:51], a[100:103], v[236:239], v[48:51]
    v_exp_f32_e64 v216, v216
    v_mfma_f32_16x16x32_bf16 v[52:55], a[108:111], v[236:239], v[52:55]
    v_exp_f32_e64 v217, v217
    v_mfma_f32_16x16x32_bf16 v[52:55], a[104:107], v[232:235], v[52:55]
    s_waitcnt lgkmcnt(0)
    buffer_store_dwordx4 a[128:131], v255, s[16:19], s22 offen sc0 sc1 nt
    v_mfma_f32_16x16x32_bf16 v[56:59], a[112:115], v[232:235], v[56:59]
    v_exp_f32_e32 v218, v218
    v_mfma_f32_16x16x32_bf16 v[56:59], a[116:119], v[236:239], v[56:59]
    v_exp_f32_e64 v219, v219
    v_mfma_f32_16x16x32_bf16 v[60:63], a[124:127], v[236:239], v[60:63]
    ds_read_b128 a[132:135], v247 offset:1088
    v_cvt_pk_bf16_f32 v226, v212, v213
    v_mfma_f32_16x16x32_bf16 v[60:63], a[120:123], v[232:235], v[60:63]
    ds_read_b128 a[136:139], v247 offset:2176
    v_cvt_pk_bf16_f32 v227, v214, v215
    v_mfma_f32_4x4x4_16b_bf16 v[152:155], a[212:213], a[144:145], 0
    v_cvt_pk_bf16_f32 v228, v216, v217
    v_mfma_f32_4x4x4_16b_bf16 v[196:199], a[212:213], a[146:147], 0
    v_cvt_pk_bf16_f32 v229, v218, v219
    v_mfma_f32_4x4x4_16b_bf16 v[152:155], a[214:215], a[144:145], v[152:155]
    ds_read_b128 a[140:143], v247 offset:3264
    v_mfma_f32_4x4x4_16b_bf16 v[156:159], a[212:213], a[148:149], 0
    v_mfma_f32_4x4x4_16b_bf16 v[196:199], a[214:215], a[146:147], v[196:199]
    v_mfma_f32_4x4x4_16b_bf16 v[248:251], a[212:213], a[150:151], 0
    v_cvt_pk_bf16_f32 v144, v152, v153
    v_mfma_f32_4x4x4_16b_bf16 v[156:159], a[214:215], a[148:149], v[156:159]
    v_cvt_pk_bf16_f32 v145, v154, v155
    v_mfma_f32_4x4x4_16b_bf16 v[152:155], a[212:213], a[152:153], 0
    v_cvt_pk_bf16_f32 v146, v196, v197
    v_mfma_f32_4x4x4_16b_bf16 v[248:251], a[214:215], a[150:151], v[248:251]
    v_cvt_pk_bf16_f32 v147, v198, v199
    v_mfma_f32_4x4x4_16b_bf16 v[196:199], a[212:213], a[154:155], 0
    v_cvt_pk_bf16_f32 v148, v156, v157
    v_mfma_f32_4x4x4_16b_bf16 v[152:155], a[214:215], a[152:153], v[152:155]
    v_cvt_pk_bf16_f32 v149, v158, v159
    v_mfma_f32_4x4x4_16b_bf16 v[156:159], a[212:213], a[156:157], 0
    v_cvt_pk_bf16_f32 v150, v248, v249
    v_mfma_f32_4x4x4_16b_bf16 v[196:199], a[214:215], a[154:155], v[196:199]
    v_cvt_pk_bf16_f32 v151, v250, v251
    v_mfma_f32_4x4x4_16b_bf16 v[248:251], a[212:213], a[158:159], 0
    v_cvt_pk_bf16_f32 v152, v152, v153
    v_mfma_f32_4x4x4_16b_bf16 v[156:159], a[214:215], a[156:157], v[156:159]
    v_cvt_pk_bf16_f32 v153, v154, v155
    v_mfma_f32_4x4x4_16b_bf16 v[168:171], a[212:213], a[160:161], 0
    v_cvt_pk_bf16_f32 v154, v196, v197
    v_mfma_f32_4x4x4_16b_bf16 v[248:251], a[214:215], a[158:159], v[248:251]
    v_cvt_pk_bf16_f32 v155, v198, v199
    v_mfma_f32_4x4x4_16b_bf16 v[200:203], a[212:213], a[162:163], 0
    ds_read_b32 v244, v255
    v_mfma_f32_4x4x4_16b_bf16 v[168:171], a[214:215], a[160:161], v[168:171]
    v_cvt_pk_bf16_f32 v156, v156, v157
    v_mfma_f32_4x4x4_16b_bf16 v[172:175], a[212:213], a[164:165], 0
    v_cvt_pk_bf16_f32 v157, v158, v159
    v_mfma_f32_4x4x4_16b_bf16 v[200:203], a[214:215], a[162:163], v[200:203]
    v_cvt_pk_bf16_f32 v158, v248, v249
    v_cvt_pk_bf16_f32 v159, v250, v251
    v_mfma_f32_4x4x4_16b_bf16 v[248:251], a[212:213], a[166:167], 0
    v_cvt_pk_bf16_f32 v160, v168, v169
    v_mfma_f32_4x4x4_16b_bf16 v[172:175], a[214:215], a[164:165], v[172:175]
    v_cvt_pk_bf16_f32 v161, v170, v171
    v_mfma_f32_4x4x4_16b_bf16 v[168:171], a[212:213], a[168:169], 0
    v_cvt_pk_bf16_f32 v162, v200, v201
    v_mfma_f32_4x4x4_16b_bf16 v[248:251], a[214:215], a[166:167], v[248:251]
    v_cvt_pk_bf16_f32 v163, v202, v203
    v_mfma_f32_4x4x4_16b_bf16 v[200:203], a[212:213], a[170:171], 0
    v_cvt_pk_bf16_f32 v164, v172, v173
    v_mfma_f32_4x4x4_16b_bf16 v[168:171], a[214:215], a[168:169], v[168:171]
    v_cvt_pk_bf16_f32 v165, v174, v175
    v_mfma_f32_4x4x4_16b_bf16 v[172:175], a[212:213], a[172:173], 0
    s_waitcnt lgkmcnt(0)
    v_cmp_gt_u32_e32 vcc, s44, v244
    v_mfma_f32_4x4x4_16b_bf16 v[200:203], a[214:215], a[170:171], v[200:203]
    v_cvt_pk_bf16_f32 v166, v248, v249
    v_cvt_pk_bf16_f32 v167, v250, v251
    v_mfma_f32_4x4x4_16b_bf16 v[248:251], a[212:213], a[174:175], 0
    s_cbranch_vccnz L_rt6
L_bk6:
    ds_read_b64_tr_b16 a[72:73], v253 offset:8
    v_mfma_f32_4x4x4_16b_bf16 v[172:175], a[214:215], a[172:173], v[172:175]
    ds_read_b64_tr_b16 a[82:83], v253 offset:4384
    v_mfma_f32_4x4x4_16b_bf16 v[248:251], a[214:215], a[174:175], v[248:251]
    ds_read_b64_tr_b16 a[92:93], v253 offset:8520
    v_mfma_f32_16x16x32_bf16 v[208:211], a[0:3], v[176:179], v[204:207]
    v_exp_f32_e32 v220, v220
    v_mfma_f32_16x16x32_bf16 v[208:211], a[4:7], v[180:183], v[208:211]
    v_exp_f32_e32 v221, v221
    v_mfma_f32_16x16x32_bf16 v[208:211], a[8:11], v[184:187], v[208:211]
    v_exp_f32_e32 v222, v222
    v_mfma_f32_16x16x32_bf16 v[208:211], a[12:15], v[188:191], v[208:211]
    v_exp_f32_e32 v223, v223
    v_mfma_f32_16x16x32_bf16 v[212:215], a[28:31], v[188:191], v[204:207]
    ds_read_b128 a[0:3], v252 offset:0
    v_cvt_pk_bf16_f32 v230, v220, v221
    v_mfma_f32_16x16x32_bf16 v[212:215], a[24:27], v[184:187], v[212:215]
    ds_read_b128 a[4:7], v252 offset:256
    v_cvt_pk_bf16_f32 v231, v222, v223
    v_mfma_f32_16x16x32_bf16 v[212:215], a[20:23], v[180:183], v[212:215]
    s_mov_b32 m0, s86
    ds_read_b128 a[8:11], v252 offset:512
    v_cvt_pk_bf16_f32 v172, v172, v173
    v_mfma_f32_16x16x32_bf16 v[212:215], a[16:19], v[176:179], v[212:215]
    v_exp_f32_e32 v208, v208
    v_mfma_f32_16x16x32_bf16 v[216:219], a[32:35], v[176:179], v[204:207]
    ds_read_b128 a[12:15], v252 offset:768
    v_exp_f32_e32 v209, v209
    v_mfma_f32_16x16x32_bf16 v[216:219], a[36:39], v[180:183], v[216:219]
    v_exp_f32_e32 v210, v210
    v_mfma_f32_16x16x32_bf16 v[216:219], a[40:43], v[184:187], v[216:219]
    v_exp_f32_e32 v211, v211
    v_mfma_f32_16x16x32_bf16 v[216:219], a[44:47], v[188:191], v[216:219]
    ds_read_b128 a[28:31], v252 offset:4992
    v_cvt_pk_bf16_f32 v232, v208, v209
    v_mfma_f32_16x16x32_bf16 v[220:223], a[60:63], v[188:191], v[204:207]
    ds_read_b128 a[24:27], v252 offset:4736
    v_cvt_pk_bf16_f32 v233, v210, v211
    v_mfma_f32_16x16x32_bf16 v[220:223], a[56:59], v[184:187], v[220:223]
    buffer_load_dwordx4 v254, s[12:15], s20 offen nt lds
    v_mfma_f32_16x16x32_bf16 v[220:223], a[52:55], v[180:183], v[220:223]
    ds_read_b128 a[20:23], v252 offset:4480
    v_cvt_pk_bf16_f32 v173, v174, v175
    v_mfma_f32_16x16x32_bf16 v[220:223], a[48:51], v[176:179], v[220:223]
    s_waitcnt lgkmcnt(6)
    ds_read_b128 a[16:19], v252 offset:4224
    v_cvt_pk_bf16_f32 v174, v248, v249
    v_mfma_f32_16x16x32_bf16 v[208:211], a[0:3], v[128:131], 0
    s_waitcnt lgkmcnt(6)
    buffer_store_dwordx4 a[132:135], v255, s[16:19], s22 offen offset:1024 sc0 sc1 nt
    v_mfma_f32_16x16x32_bf16 v[208:211], a[4:7], v[132:135], v[208:211]
    s_waitcnt lgkmcnt(5)
    ds_read_b128 a[32:35], v252 offset:8448
    v_cvt_pk_bf16_f32 v175, v250, v251
    v_mfma_f32_16x16x32_bf16 v[208:211], a[8:11], v[136:139], v[208:211]
    s_waitcnt lgkmcnt(5)
    v_exp_f32_e32 v212, v212
    v_mfma_f32_16x16x32_bf16 v[208:211], a[12:15], v[140:143], v[208:211]
    v_exp_f32_e32 v213, v213
    v_smfmac_f32_16x16x64_bf16 a[200:203], a[208:211], v[224:231], v245
    ds_read_b128 a[36:39], v252 offset:8704
    v_mfma_f32_16x16x32_bf16 v[64:67], a[224:227], v[224:227], v[64:67]
    v_exp_f32_e32 v214, v214
    v_mfma_f32_16x16x32_bf16 v[64:67], a[228:231], v[228:231], v[64:67]
    s_mov_b32 m0, s87
    v_exp_f32_e32 v215, v215
    v_mfma_f32_16x16x32_bf16 v[68:71], a[236:239], v[228:231], v[68:71]
    ds_read_b128 a[40:43], v252 offset:8960
    v_max3_f32 v192, v208, v209, v210
    v_mfma_f32_16x16x32_bf16 v[68:71], a[232:235], v[224:227], v[68:71]
    buffer_load_dwordx4 v254, s[12:15], s20 offen offset:1024 nt lds
    v_mfma_f32_16x16x32_bf16 v[72:75], a[240:243], v[224:227], v[72:75]
    ds_read_b128 a[44:47], v252 offset:9216
    v_max_f32_e32 v193, v192, v211
    v_mfma_f32_16x16x32_bf16 v[72:75], a[244:247], v[228:231], v[72:75]
    v_exp_f32_e64 v216, v216
    v_mfma_f32_16x16x32_bf16 v[76:79], a[252:255], v[228:231], v[76:79]
    v_exp_f32_e64 v217, v217
    v_mfma_f32_16x16x32_bf16 v[76:79], a[248:251], v[224:227], v[76:79]
    v_exp_f32_e64 v218, v218
    v_mfma_f32_16x16x32_bf16 v[80:83], a[96:99], v[224:227], v[80:83]
    v_exp_f32_e64 v219, v219
    v_mfma_f32_16x16x32_bf16 v[80:83], a[100:103], v[228:231], v[80:83]
    ds_read_b128 a[60:63], v252 offset:13440
    v_max_f32_e64 v192, v192, v211
    v_mfma_f32_16x16x32_bf16 v[84:87], a[108:111], v[228:231], v[84:87]
    ds_read_b128 a[56:59], v252 offset:13184
    v_cvt_pk_bf16_f32 v234, v212, v213
    v_mfma_f32_16x16x32_bf16 v[84:87], a[104:107], v[224:227], v[84:87]
    v_permlane32_swap_b32_e32 v192, v193
    v_mfma_f32_16x16x32_bf16 v[88:91], a[112:115], v[224:227], v[88:91]
    ds_read_b128 a[52:55], v252 offset:12928
    v_max_f32_e32 v194, v192, v193
    v_mfma_f32_16x16x32_bf16 v[88:91], a[116:119], v[228:231], v[88:91]
    ds_read_b128 a[48:51], v252 offset:12672
    v_max_f32_e64 v195, v192, v193
    v_mfma_f32_16x16x32_bf16 v[92:95], a[124:127], v[228:231], v[92:95]
    ds_read_b64_tr_b16 a[64:65], v253 offset:0
    v_cvt_pk_bf16_f32 v235, v214, v215
    v_mfma_f32_16x16x32_bf16 v[92:95], a[120:123], v[224:227], v[92:95]
    v_exp_f32_e64 v220, v220
    v_mfma_f32_4x4x4_16b_bf16 v[184:187], a[212:213], a[176:177], 0
    v_cvt_pk_bf16_f32 v236, v216, v217
    v_mfma_f32_4x4x4_16b_bf16 v[204:207], a[212:213], a[178:179], 0
    v_cvt_pk_bf16_f32 v237, v218, v219
    v_mfma_f32_4x4x4_16b_bf16 v[184:187], a[214:215], a[176:177], v[184:187]
    ds_read_b64_tr_b16 a[66:67], v253 offset:4128
    v_mfma_f32_4x4x4_16b_bf16 v[188:191], a[212:213], a[180:181], 0
    ds_read_b64_tr_b16 a[68:69], v253 offset:8256
    v_mfma_f32_4x4x4_16b_bf16 v[204:207], a[214:215], a[178:179], v[204:207]
    ds_read_b64_tr_b16 a[70:71], v253 offset:12384
    v_mfma_f32_4x4x4_16b_bf16 v[248:251], a[212:213], a[182:183], 0
    v_cvt_pk_bf16_f32 v176, v184, v185
    v_mfma_f32_4x4x4_16b_bf16 v[188:191], a[214:215], a[180:181], v[188:191]
    v_cvt_pk_bf16_f32 v177, v186, v187
    v_mfma_f32_4x4x4_16b_bf16 v[184:187], a[212:213], a[184:185], 0
    v_cvt_pk_bf16_f32 v178, v204, v205
    v_mfma_f32_4x4x4_16b_bf16 v[248:251], a[214:215], a[182:183], v[248:251]
    v_cvt_pk_bf16_f32 v179, v206, v207
    v_mfma_f32_4x4x4_16b_bf16 v[204:207], a[212:213], a[186:187], 0
    v_cvt_pk_bf16_f32 v180, v188, v189
    v_mfma_f32_4x4x4_16b_bf16 v[184:187], a[214:215], a[184:185], v[184:187]
    v_cvt_pk_bf16_f32 v181, v190, v191
    v_mfma_f32_4x4x4_16b_bf16 v[188:191], a[212:213], a[188:189], 0
    v_cvt_pk_bf16_f32 v182, v248, v249
    v_mfma_f32_4x4x4_16b_bf16 v[204:207], a[214:215], a[186:187], v[204:207]
    v_cvt_pk_bf16_f32 v183, v250, v251
    v_mfma_f32_4x4x4_16b_bf16 v[248:251], a[212:213], a[190:191], 0
    ds_read_b64_tr_b16 a[76:77], v253 offset:8264
    v_mfma_f32_4x4x4_16b_bf16 v[188:191], a[214:215], a[188:189], v[188:191]
    ds_read_b64_tr_b16 a[78:79], v253 offset:12392
    v_mfma_f32_4x4x4_16b_bf16 v[248:251], a[214:215], a[190:191], v[248:251]
    s_waitcnt lgkmcnt(8)
    v_permlane16_swap_b32_e32 v194, v195
    v_max_f32_e64 v195, v194, v195
    v_sub_f32_e32 v192, -4.0, v195
    v_sub_f32_e32 v193, -4.0, v195
    v_pk_mov_b32 v[194:195], v[192:193], v[192:193] op_sel:[0,1]
    v_pk_add_f32 v[208:209], v[208:209], v[192:193]
    v_pk_add_f32 v[210:211], v[210:211], v[192:193]
    v_mfma_f32_16x16x32_bf16 v[212:215], a[28:31], v[140:143], v[192:195]
    v_exp_f32_e64 v221, v221
    v_mfma_f32_16x16x32_bf16 v[212:215], a[24:27], v[136:139], v[212:215]
    v_exp_f32_e64 v222, v222
    v_mfma_f32_16x16x32_bf16 v[212:215], a[20:23], v[132:135], v[212:215]
    v_exp_f32_e64 v223, v223
    v_mfma_f32_16x16x32_bf16 v[212:215], a[16:19], v[128:131], v[212:215]
    v_exp_f32_e64 v208, v208
    v_mfma_f32_16x16x32_bf16 v[216:219], a[32:35], v[128:131], v[192:195]
    v_exp_f32_e64 v209, v209
    v_mfma_f32_16x16x32_bf16 v[216:219], a[36:39], v[132:135], v[216:219]
    v_exp_f32_e64 v210, v210
    v_mfma_f32_16x16x32_bf16 v[216:219], a[40:43], v[136:139], v[216:219]
    s_mov_b32 m0, s88
    v_exp_f32_e32 v211, v211
    v_mfma_f32_16x16x32_bf16 v[216:219], a[44:47], v[140:143], v[216:219]
    v_cvt_pk_bf16_f32 v238, v220, v221
    v_cvt_pk_bf16_f32 v239, v222, v223
    v_mfma_f32_16x16x32_bf16 v[220:223], a[60:63], v[140:143], v[192:195]
    v_accvgpr_read_b32 v240, a196
    v_accvgpr_read_b32 v241, a197
    v_add_f32_e32 v241, v241, v240
    v_rcp_f32_e32 v240, v241
    v_cmp_ngt_f32_e64 s[32:33], s26, v241
    v_accvgpr_read_b32 v241, a218
    v_mul_f32_e64 v241, -v241, v240
    v_pk_fma_f32 v[32:33], v[32:33], v[240:241], v[240:241] op_sel:[0,0,1] op_sel_hi:[1,0,1]
    v_pk_fma_f32 v[34:35], v[34:35], v[240:241], v[240:241] op_sel:[0,0,1] op_sel_hi:[1,0,1]
    v_pk_fma_f32 v[36:37], v[36:37], v[240:241], v[240:241] op_sel:[0,0,1] op_sel_hi:[1,0,1]
    v_pk_fma_f32 v[38:39], v[38:39], v[240:241], v[240:241] op_sel:[0,0,1] op_sel_hi:[1,0,1]
    v_mfma_f32_16x16x32_bf16 v[220:223], a[56:59], v[136:139], v[220:223]
    s_waitcnt lgkmcnt(0)
    v_cvt_pk_bf16_f32 v224, v208, v209
    v_cvt_pk_bf16_f32 v225, v210, v211
    v_mfma_f32_16x16x32_bf16 v[220:223], a[52:55], v[132:135], v[220:223]
    s_or_b64 s[28:29], s[28:29], s[32:33]
    buffer_store_dwordx4 a[136:139], v255, s[16:19], s22 offen offset:2048 sc0 sc1 nt
    v_mfma_f32_16x16x32_bf16 v[220:223], a[48:51], v[128:131], v[220:223]
    ds_read_b64_tr_b16 a[74:75], v253 offset:4136
    v_cvt_pk_bf16_f32 v32, v32, v33
    v_mfma_f32_16x16x32_bf16 v[208:211], a[0:3], v[144:147], 0
    ds_read_b64_tr_b16 a[80:81], v253 offset:256
    v_cvt_pk_bf16_f32 v33, v34, v35
    v_mfma_f32_16x16x32_bf16 v[208:211], a[4:7], v[148:151], v[208:211]
    ds_read_b64_tr_b16 a[84:85], v253 offset:8512
    v_cvt_pk_bf16_f32 v34, v36, v37
    v_mfma_f32_16x16x32_bf16 v[208:211], a[8:11], v[152:155], v[208:211]
    ds_read_b64_tr_b16 a[86:87], v253 offset:12640
    v_cvt_pk_bf16_f32 v35, v38, v39
    v_mfma_f32_16x16x32_bf16 v[208:211], a[12:15], v[156:159], v[208:211]
    ds_write_b128 v242, v[32:35] offset:0
    v_pk_fma_f32 v[40:41], v[40:41], v[240:241], v[240:241] op_sel:[0,0,1] op_sel_hi:[1,0,1]
    v_pk_fma_f32 v[42:43], v[42:43], v[240:241], v[240:241] op_sel:[0,0,1] op_sel_hi:[1,0,1]
    v_pk_fma_f32 v[44:45], v[44:45], v[240:241], v[240:241] op_sel:[0,0,1] op_sel_hi:[1,0,1]
    v_pk_fma_f32 v[46:47], v[46:47], v[240:241], v[240:241] op_sel:[0,0,1] op_sel_hi:[1,0,1]
    v_smfmac_f32_16x16x64_bf16 a[204:207], a[208:211], v[232:239], v245
    v_cvt_pk_bf16_f32 v40, v40, v41
    v_mfma_f32_16x16x32_bf16 v[96:99], a[224:227], v[232:235], v[96:99]
    v_exp_f32_e64 v212, v212
    v_mfma_f32_16x16x32_bf16 v[96:99], a[228:231], v[236:239], v[96:99]
    v_exp_f32_e64 v213, v213
    v_mfma_f32_16x16x32_bf16 v[100:103], a[236:239], v[236:239], v[100:103]
    v_exp_f32_e64 v214, v214
    v_mfma_f32_16x16x32_bf16 v[100:103], a[232:235], v[232:235], v[100:103]
    v_exp_f32_e64 v215, v215
    v_mfma_f32_16x16x32_bf16 v[104:107], a[240:243], v[232:235], v[104:107]
    ds_read_b64_tr_b16 a[94:95], v253 offset:12648
    v_cvt_pk_bf16_f32 v41, v42, v43
    v_mfma_f32_16x16x32_bf16 v[104:107], a[244:247], v[236:239], v[104:107]
    ds_read_b64_tr_b16 a[88:89], v253 offset:264
    v_cvt_pk_bf16_f32 v42, v44, v45
    v_mfma_f32_16x16x32_bf16 v[108:111], a[252:255], v[236:239], v[108:111]
    ds_read_b64_tr_b16 a[90:91], v253 offset:4392
    v_cvt_pk_bf16_f32 v43, v46, v47
    v_mfma_f32_16x16x32_bf16 v[108:111], a[248:251], v[232:235], v[108:111]
    ds_write_b128 v242, v[40:43] offset:64
    v_pk_fma_f32 v[48:49], v[48:49], v[240:241], v[240:241] op_sel:[0,0,1] op_sel_hi:[1,0,1]
    v_pk_fma_f32 v[50:51], v[50:51], v[240:241], v[240:241] op_sel:[0,0,1] op_sel_hi:[1,0,1]
    v_pk_fma_f32 v[52:53], v[52:53], v[240:241], v[240:241] op_sel:[0,0,1] op_sel_hi:[1,0,1]
    v_pk_fma_f32 v[54:55], v[54:55], v[240:241], v[240:241] op_sel:[0,0,1] op_sel_hi:[1,0,1]
    v_mfma_f32_16x16x32_bf16 v[112:115], a[96:99], v[232:235], v[112:115]
    ds_read_b64_tr_b16 a[96:97], v253 offset:512
    v_max3_f32 v196, v208, v209, v210
    v_mfma_f32_16x16x32_bf16 v[112:115], a[100:103], v[236:239], v[112:115]
    buffer_load_dwordx4 v254, s[12:15], s20 offen offset:2048 nt lds
    v_mfma_f32_16x16x32_bf16 v[116:119], a[108:111], v[236:239], v[116:119]
    s_mov_b32 m0, s89
    ds_read_b64_tr_b16 a[98:99], v253 offset:4640
    v_max_f32_e32 v197, v196, v211
    v_mfma_f32_16x16x32_bf16 v[116:119], a[104:107], v[232:235], v[116:119]
    v_exp_f32_e32 v216, v216
    v_exp_f32_e32 v217, v217
    v_mfma_f32_16x16x32_bf16 v[120:123], a[112:115], v[232:235], v[120:123]
    v_exp_f32_e32 v218, v218
    v_exp_f32_e64 v219, v219
    v_max_f32_e32 v196, v196, v211
    v_mfma_f32_16x16x32_bf16 v[120:123], a[116:119], v[236:239], v[120:123]
    v_cvt_pk_bf16_f32 v48, v48, v49
    v_cvt_pk_bf16_f32 v226, v212, v213
    v_cvt_pk_bf16_f32 v227, v214, v215
    v_cvt_pk_bf16_f32 v228, v216, v217
    v_permlane32_swap_b32_e32 v196, v197
    v_mfma_f32_16x16x32_bf16 v[124:127], a[124:127], v[236:239], v[124:127]
    v_max_f32_e64 v198, v196, v197
    v_max_f32_e32 v199, v196, v197
    v_cvt_pk_bf16_f32 v49, v50, v51
    v_mfma_f32_16x16x32_bf16 v[124:127], a[120:123], v[232:235], v[124:127]
    v_cvt_pk_bf16_f32 v50, v52, v53
    v_cvt_pk_bf16_f32 v51, v54, v55
    v_permlane16_swap_b32_e32 v198, v199
    v_max_f32_e32 v199, v198, v199
    v_sub_f32_e32 v196, -4.0, v199
    v_sub_f32_e32 v197, -4.0, v199
    v_pk_mov_b32 v[198:199], v[196:197], v[196:197] op_sel:[0,1]
    v_pk_add_f32 v[208:209], v[208:209], v[196:197]
    v_pk_add_f32 v[210:211], v[210:211], v[196:197]
    v_mfma_f32_16x16x32_bf16 v[212:215], a[28:31], v[156:159], v[196:199]
    s_add_u32 s44, s44, 1
    ds_write_b128 v242, v[48:51] offset:128
    v_pk_fma_f32 v[56:57], v[56:57], v[240:241], v[240:241] op_sel:[0,0,1] op_sel_hi:[1,0,1]
    v_pk_fma_f32 v[58:59], v[58:59], v[240:241], v[240:241] op_sel:[0,0,1] op_sel_hi:[1,0,1]
    v_pk_fma_f32 v[60:61], v[60:61], v[240:241], v[240:241] op_sel:[0,0,1] op_sel_hi:[1,0,1]
    v_pk_fma_f32 v[62:63], v[62:63], v[240:241], v[240:241] op_sel:[0,0,1] op_sel_hi:[1,0,1]
    v_mfma_f32_16x16x32_bf16 v[212:215], a[24:27], v[152:155], v[212:215]
    buffer_store_dwordx4 a[140:143], v255, s[16:19], s22 offen offset:3072 sc0 sc1 nt
    v_exp_f32_e32 v220, v220
    v_exp_f32_e32 v221, v221
    v_mfma_f32_16x16x32_bf16 v[212:215], a[20:23], v[148:151], v[212:215]
    s_xor_b32 s22, s22, 16384
    v_exp_f32_e32 v222, v222
    v_mfma_f32_16x16x32_bf16 v[212:215], a[16:19], v[144:147], v[212:215]
    v_exp_f32_e32 v223, v223
    v_cvt_pk_bf16_f32 v229, v218, v219
    v_cvt_pk_bf16_f32 v56, v56, v57
    v_mfma_f32_16x16x32_bf16 v[216:219], a[32:35], v[144:147], v[196:199]
    v_exp_f32_e32 v208, v208
    v_exp_f32_e32 v209, v209
    v_mfma_f32_16x16x32_bf16 v[216:219], a[36:39], v[148:151], v[216:219]
    v_exp_f32_e32 v210, v210
    v_exp_f32_e32 v211, v211
    v_cvt_pk_bf16_f32 v57, v58, v59
    v_mfma_f32_16x16x32_bf16 v[216:219], a[40:43], v[152:155], v[216:219]
    v_cvt_pk_bf16_f32 v58, v60, v61
    v_cvt_pk_bf16_f32 v59, v62, v63
    v_cvt_pk_bf16_f32 v230, v220, v221
    v_mfma_f32_16x16x32_bf16 v[216:219], a[44:47], v[156:159], v[216:219]
    ds_write_b128 v242, v[56:59] offset:192
    v_cvt_pk_bf16_f32 v231, v222, v223
    v_mfma_f32_16x16x32_bf16 v[220:223], a[60:63], v[156:159], v[196:199]
    ds_read_b128 a[144:147], v247 offset:0
    v_cvt_pk_bf16_f32 v188, v188, v189
    v_cvt_pk_bf16_f32 v168, v168, v169
    v_cvt_pk_bf16_f32 v232, v208, v209
    v_cvt_pk_bf16_f32 v233, v210, v211
    v_mfma_f32_16x16x32_bf16 v[220:223], a[56:59], v[152:155], v[220:223]
    buffer_load_dwordx4 v254, s[12:15], s20 offen offset:3072 nt lds
    v_cvt_pk_bf16_f32 v189, v190, v191
    v_cvt_pk_bf16_f32 v169, v170, v171
    v_mfma_f32_16x16x32_bf16 v[220:223], a[52:55], v[148:151], v[220:223]
    s_xor_b32 s20, s20, 16384
    v_cvt_pk_bf16_f32 v190, v248, v249
    v_cvt_pk_bf16_f32 v191, v250, v251
    v_cvt_pk_bf16_f32 v170, v200, v201
    v_cvt_pk_bf16_f32 v171, v202, v203
    v_accvgpr_read_b32 v248, a72
    v_accvgpr_read_b32 v249, a73
    v_mfma_f32_16x16x32_bf16 v[220:223], a[48:51], v[144:147], v[220:223]
    s_mov_b32 m0, s67
    v_max_f32_e64 v248, |v248|, |v249|
    v_accvgpr_read_b32 v250, a83
    v_accvgpr_read_b32 v251, a93
    v_accvgpr_read_b32 v249, a82
    v_mfma_f32_16x16x32_bf16 v[208:211], a[0:3], v[160:163], 0
    ds_read_b64_tr_b16 a[100:101], v253 offset:8768
    v_max_f32_e64 v249, |v249|, |v250|
    v_accvgpr_read_b32 v250, a92
    v_mfma_f32_16x16x32_bf16 v[208:211], a[4:7], v[164:167], v[208:211]
    s_waitcnt vmcnt(12)
    ds_read_b64_tr_b16 a[102:103], v253 offset:12896
    v_max_f32_e64 v250, |v250|, |v251|
    v_med3_f32 v248, |v248|, |v249|, |v250|
    v_mfma_f32_16x16x32_bf16 v[208:211], a[8:11], v[168:171], v[208:211]
    ds_read_b64_tr_b16 a[108:109], v253 offset:8776
    ds_read_b64_tr_b16 a[110:111], v253 offset:12904
    v_and_b32_e32 v248, 0x7f800000, v248
    v_mov_b32_e32 v244, s44
    v_mul_f32_e32 v251, s46, v248
    v_mul_f32_e32 v250, s46, v248
    v_mul_f32_e32 v249, s46, v248
    v_mfma_f32_16x16x32_bf16 v[208:211], a[12:15], v[172:175], v[208:211]
    ds_read_b64_tr_b16 a[104:105], v253 offset:520
    v_mul_f32_e32 v248, s46, v248
    v_smfmac_f32_16x16x64_bf16 a[192:195], a[208:211], v[224:231], v245
    ds_read_b64_tr_b16 a[106:107], v253 offset:4648
    v_mfma_f32_16x16x32_bf16 v[0:3], a[64:67], v[224:227], v[248:251]
    ds_read_b64_tr_b16 a[112:113], v253 offset:768
    ds_read_b64_tr_b16 a[114:115], v253 offset:4896
    v_mfma_f32_16x16x32_bf16 v[0:3], a[68:71], v[228:231], v[0:3]
    s_waitcnt lgkmcnt(8)
    buffer_store_dwordx4 a[144:147], v255, s[16:19], s22 offen sc0 sc1 nt
    buffer_load_dwordx4 v254, s[8:11], s20 offen nt lds
    v_mfma_f32_16x16x32_bf16 v[4:7], a[76:79], v[228:231], v[248:251]
    s_mov_b32 m0, s45
    ds_read_b64_tr_b16 a[116:117], v253 offset:9024
    ds_read_b64_tr_b16 a[118:119], v253 offset:13152
    v_mfma_f32_16x16x32_bf16 v[4:7], a[72:75], v[224:227], v[4:7]
    ds_read_b64_tr_b16 a[124:125], v253 offset:9032
    ds_read_b64_tr_b16 a[126:127], v253 offset:13160
    ds_write_addtid_b32 v244
    v_mfma_f32_16x16x32_bf16 v[8:11], a[80:83], v[224:227], v[248:251]
    ds_read_b64_tr_b16 a[120:121], v253 offset:776
    ds_read_b64_tr_b16 a[122:123], v253 offset:4904
    v_mfma_f32_16x16x32_bf16 v[8:11], a[84:87], v[228:231], v[8:11]
    v_accvgpr_read_b32 v240, a200
    v_accvgpr_read_b32 v241, a201
    v_add_f32_e32 v241, v241, v240
    v_rcp_f32_e32 v240, v241
    v_cmp_ngt_f32_e64 s[30:31], s26, v241
    v_accvgpr_read_b32 v241, a218
    v_mul_f32_e64 v241, -v241, v240
    v_pk_fma_f32 v[64:65], v[64:65], v[240:241], v[240:241] op_sel:[0,0,1] op_sel_hi:[1,0,1]
    v_pk_fma_f32 v[66:67], v[66:67], v[240:241], v[240:241] op_sel:[0,0,1] op_sel_hi:[1,0,1]
    v_pk_fma_f32 v[68:69], v[68:69], v[240:241], v[240:241] op_sel:[0,0,1] op_sel_hi:[1,0,1]
    v_pk_fma_f32 v[70:71], v[70:71], v[240:241], v[240:241] op_sel:[0,0,1] op_sel_hi:[1,0,1]
    v_mfma_f32_16x16x32_bf16 v[12:15], a[92:95], v[228:231], v[248:251]
    ds_read_b128 a[148:151], v247 offset:1088
    v_max3_f32 v200, v208, v209, v210
    v_mfma_f32_16x16x32_bf16 v[12:15], a[88:91], v[224:227], v[12:15]
    s_or_b64 s[28:29], s[28:29], s[30:31]
    v_exp_f32_e32 v212, v212
    v_mfma_f32_16x16x32_bf16 v[16:19], a[96:99], v[224:227], v[248:251]
    s_waitcnt lgkmcnt(8)
    v_exp_f32_e32 v213, v213
    v_mfma_f32_16x16x32_bf16 v[16:19], a[100:103], v[228:231], v[16:19]
    s_waitcnt lgkmcnt(3)
    v_exp_f32_e32 v214, v214
    v_mfma_f32_16x16x32_bf16 v[20:23], a[108:111], v[228:231], v[248:251]
    s_mov_b32 m0, s68
    v_exp_f32_e32 v215, v215
    v_mfma_f32_16x16x32_bf16 v[20:23], a[104:107], v[224:227], v[20:23]
    ds_read_b128 a[152:155], v247 offset:2176
    v_max_f32_e64 v201, v200, v211
    v_mfma_f32_16x16x32_bf16 v[24:27], a[112:115], v[224:227], v[248:251]
    v_cvt_pk_bf16_f32 v64, v64, v65
    v_exp_f32_e32 v216, v216
    v_max_f32_e32 v200, v200, v211
    v_cvt_pk_bf16_f32 v65, v66, v67
    v_mfma_f32_16x16x32_bf16 v[24:27], a[116:119], v[228:231], v[24:27]
    ds_read_b128 a[156:159], v247 offset:3264
    v_permlane32_swap_b32_e32 v200, v201
    v_exp_f32_e32 v217, v217
    v_cvt_pk_bf16_f32 v66, v68, v69
    v_cvt_pk_bf16_f32 v67, v70, v71
    v_mfma_f32_16x16x32_bf16 v[28:31], a[124:127], v[228:231], v[248:251]
    s_waitcnt lgkmcnt(3)
    ds_write_b128 v242, v[64:67] offset:0
    v_pk_fma_f32 v[72:73], v[72:73], v[240:241], v[240:241] op_sel:[0,0,1] op_sel_hi:[1,0,1]
    v_pk_fma_f32 v[74:75], v[74:75], v[240:241], v[240:241] op_sel:[0,0,1] op_sel_hi:[1,0,1]
    v_pk_fma_f32 v[76:77], v[76:77], v[240:241], v[240:241] op_sel:[0,0,1] op_sel_hi:[1,0,1]
    v_pk_fma_f32 v[78:79], v[78:79], v[240:241], v[240:241] op_sel:[0,0,1] op_sel_hi:[1,0,1]
    v_max_f32_e64 v202, v200, v201
    v_max_f32_e32 v203, v200, v201
    v_mfma_f32_16x16x32_bf16 v[28:31], a[120:123], v[224:227], v[28:31]
    v_exp_f32_e32 v218, v218
    v_exp_f32_e32 v219, v219
    v_cvt_pk_bf16_f32 v234, v212, v213
    v_cvt_pk_bf16_f32 v235, v214, v215
    v_permlane16_swap_b32_e32 v202, v203
    v_max_f32_e32 v203, v202, v203
    v_sub_f32_e32 v200, -4.0, v203
    v_sub_f32_e32 v201, -4.0, v203
    v_pk_mov_b32 v[202:203], v[200:201], v[200:201] op_sel:[0,1]
    v_pk_add_f32 v[208:209], v[208:209], v[200:201]
    v_pk_add_f32 v[210:211], v[210:211], v[200:201]
    v_mfma_f32_16x16x32_bf16 v[212:215], a[28:31], v[172:175], v[200:203]
    s_xor_b32 s21, s21, 49152
    v_exp_f32_e64 v220, v220
    v_mfma_f32_16x16x32_bf16 v[212:215], a[24:27], v[168:171], v[212:215]
    s_ashr_i32 s49, s25, 31
    s_waitcnt lgkmcnt(2)
    buffer_store_dwordx4 a[148:151], v255, s[16:19], s22 offen offset:1024 sc0 sc1 nt
    v_exp_f32_e64 v221, v221
    v_mfma_f32_16x16x32_bf16 v[212:215], a[20:23], v[164:167], v[212:215]
    s_add_u32 s21, s21, 16777216
    v_exp_f32_e64 v222, v222
    v_cvt_pk_bf16_f32 v72, v72, v73
    v_mfma_f32_16x16x32_bf16 v[212:215], a[16:19], v[160:163], v[212:215]
    s_and_b32 s21, s21, s49
    v_exp_f32_e32 v223, v223
    v_cvt_pk_bf16_f32 v73, v74, v75
    v_cvt_pk_bf16_f32 v236, v216, v217
    v_cvt_pk_bf16_f32 v237, v218, v219
    v_cvt_pk_bf16_f32 v74, v76, v77
    v_cvt_pk_bf16_f32 v75, v78, v79
    v_mfma_f32_16x16x32_bf16 v[216:219], a[32:35], v[160:163], v[200:203]
    s_and_b32 s6, s6, s49
    ds_write_b128 v242, v[72:75] offset:64
    v_pk_fma_f32 v[80:81], v[80:81], v[240:241], v[240:241] op_sel:[0,0,1] op_sel_hi:[1,0,1]
    v_pk_fma_f32 v[82:83], v[82:83], v[240:241], v[240:241] op_sel:[0,0,1] op_sel_hi:[1,0,1]
    v_pk_fma_f32 v[84:85], v[84:85], v[240:241], v[240:241] op_sel:[0,0,1] op_sel_hi:[1,0,1]
    v_pk_fma_f32 v[86:87], v[86:87], v[240:241], v[240:241] op_sel:[0,0,1] op_sel_hi:[1,0,1]
    v_mfma_f32_16x16x32_bf16 v[216:219], a[36:39], v[164:167], v[216:219]
    v_exp_f32_e32 v208, v208
    v_mfma_f32_16x16x32_bf16 v[216:219], a[40:43], v[168:171], v[216:219]
    v_exp_f32_e64 v209, v209
    v_mfma_f32_16x16x32_bf16 v[216:219], a[44:47], v[172:175], v[216:219]
    v_exp_f32_e64 v210, v210
    v_cvt_pk_bf16_f32 v238, v220, v221
    v_cvt_pk_bf16_f32 v239, v222, v223
    v_mfma_f32_16x16x32_bf16 v[220:223], a[60:63], v[172:175], v[200:203]
    v_exp_f32_e64 v211, v211
    v_mfma_f32_16x16x32_bf16 v[220:223], a[56:59], v[168:171], v[220:223]
    v_cvt_pk_bf16_f32 v80, v80, v81
    v_cvt_pk_bf16_f32 v184, v184, v185
    v_cvt_pk_bf16_f32 v224, v208, v209
    v_cvt_pk_bf16_f32 v225, v210, v211
    v_cvt_pk_bf16_f32 v81, v82, v83
    v_mfma_f32_16x16x32_bf16 v[220:223], a[52:55], v[164:167], v[220:223]
    v_cvt_pk_bf16_f32 v82, v84, v85
    v_cvt_pk_bf16_f32 v83, v86, v87
    v_cvt_pk_bf16_f32 v185, v186, v187
    v_mfma_f32_16x16x32_bf16 v[220:223], a[48:51], v[160:163], v[220:223]
    buffer_load_dwordx4 v254, s[8:11], s20 offen offset:1024 nt lds
    ds_write_b128 v242, v[80:83] offset:128
    v_pk_fma_f32 v[88:89], v[88:89], v[240:241], v[240:241] op_sel:[0,0,1] op_sel_hi:[1,0,1]
    v_pk_fma_f32 v[90:91], v[90:91], v[240:241], v[240:241] op_sel:[0,0,1] op_sel_hi:[1,0,1]
    v_pk_fma_f32 v[92:93], v[92:93], v[240:241], v[240:241] op_sel:[0,0,1] op_sel_hi:[1,0,1]
    v_pk_fma_f32 v[94:95], v[94:95], v[240:241], v[240:241] op_sel:[0,0,1] op_sel_hi:[1,0,1]
    v_mfma_f32_16x16x32_bf16 v[208:211], a[0:3], v[176:179], 0
    s_mov_b32 m0, s69
    v_cvt_pk_bf16_f32 v186, v204, v205
    v_cvt_pk_bf16_f32 v187, v206, v207
    v_mfma_f32_16x16x32_bf16 v[208:211], a[4:7], v[180:183], v[208:211]
    v_accvgpr_write_b32 a196, 0
    v_accvgpr_write_b32 a197, 0
    v_mfma_f32_16x16x32_bf16 v[208:211], a[8:11], v[184:187], v[208:211]
    v_accvgpr_read_b32 v240, a204
    v_accvgpr_read_b32 v241, a205
    v_add_f32_e64 v241, v241, v240
    v_rcp_f32_e32 v240, v241
    v_cmp_ngt_f32_e64 s[32:33], s26, v241
    v_accvgpr_read_b32 v241, a218
    v_mul_f32_e64 v241, -v241, v240
    v_pk_fma_f32 v[96:97], v[96:97], v[240:241], v[240:241] op_sel:[0,0,1] op_sel_hi:[1,0,1]
    v_pk_fma_f32 v[98:99], v[98:99], v[240:241], v[240:241] op_sel:[0,0,1] op_sel_hi:[1,0,1]
    v_pk_fma_f32 v[100:101], v[100:101], v[240:241], v[240:241] op_sel:[0,0,1] op_sel_hi:[1,0,1]
    v_pk_fma_f32 v[102:103], v[102:103], v[240:241], v[240:241] op_sel:[0,0,1] op_sel_hi:[1,0,1]
    v_mfma_f32_16x16x32_bf16 v[208:211], a[12:15], v[188:191], v[208:211]
    v_cvt_pk_bf16_f32 v88, v88, v89
    v_cvt_pk_bf16_f32 v96, v96, v97
    v_smfmac_f32_16x16x64_bf16 a[196:199], a[208:211], v[232:239], v245
    s_or_b64 s[28:29], s[28:29], s[32:33]
    v_cvt_pk_bf16_f32 v89, v90, v91
    v_mfma_f32_16x16x32_bf16 v[32:35], a[64:67], v[232:235], v[248:251]
    v_cvt_pk_bf16_f32 v90, v92, v93
    v_cvt_pk_bf16_f32 v91, v94, v95
    v_cvt_pk_bf16_f32 v97, v98, v99
    v_mfma_f32_16x16x32_bf16 v[32:35], a[68:71], v[236:239], v[32:35]
    buffer_store_dwordx4 a[152:155], v255, s[16:19], s22 offen offset:2048 sc0 sc1 nt
    ds_read_b32 v244, v255
    ds_write_b128 v242, v[88:91] offset:192
    v_mfma_f32_16x16x32_bf16 v[36:39], a[76:79], v[236:239], v[248:251]
    ds_read_b128 a[160:163], v247 offset:0
    v_cvt_pk_bf16_f32 v98, v100, v101
    v_mfma_f32_16x16x32_bf16 v[36:39], a[72:75], v[232:235], v[36:39]
    ds_read_b128 a[164:167], v247 offset:1088
    v_cvt_pk_bf16_f32 v99, v102, v103
    v_mfma_f32_16x16x32_bf16 v[40:43], a[80:83], v[232:235], v[248:251]
    ds_read_b128 a[168:171], v247 offset:2176
    v_max3_f32 v204, v208, v209, v210
    v_mfma_f32_16x16x32_bf16 v[40:43], a[84:87], v[236:239], v[40:43]
    ds_read_b128 a[172:175], v247 offset:3264
    v_max_f32_e32 v205, v204, v211
    v_mfma_f32_16x16x32_bf16 v[44:47], a[92:95], v[236:239], v[248:251]
    ds_write_b128 v242, v[96:99] offset:0
    v_pk_fma_f32 v[104:105], v[104:105], v[240:241], v[240:241] op_sel:[0,0,1] op_sel_hi:[1,0,1]
    v_pk_fma_f32 v[106:107], v[106:107], v[240:241], v[240:241] op_sel:[0,0,1] op_sel_hi:[1,0,1]
    v_pk_fma_f32 v[108:109], v[108:109], v[240:241], v[240:241] op_sel:[0,0,1] op_sel_hi:[1,0,1]
    v_pk_fma_f32 v[110:111], v[110:111], v[240:241], v[240:241] op_sel:[0,0,1] op_sel_hi:[1,0,1]
    v_mfma_f32_16x16x32_bf16 v[44:47], a[88:91], v[232:235], v[44:47]
    s_waitcnt lgkmcnt(6)
    v_exp_f32_e32 v212, v212
    v_mfma_f32_16x16x32_bf16 v[48:51], a[96:99], v[232:235], v[248:251]
    v_exp_f32_e64 v213, v213
    v_mfma_f32_16x16x32_bf16 v[48:51], a[100:103], v[236:239], v[48:51]
    v_exp_f32_e64 v214, v214
    v_mfma_f32_16x16x32_bf16 v[52:55], a[108:111], v[236:239], v[248:251]
    v_exp_f32_e64 v215, v215
    v_mfma_f32_16x16x32_bf16 v[52:55], a[104:107], v[232:235], v[52:55]
    buffer_load_dwordx4 v254, s[8:11], s20 offen offset:2048 nt lds
    v_cvt_pk_bf16_f32 v104, v104, v105
    v_cmp_gt_u32_e32 vcc, s44, v244
    v_max_f32_e32 v204, v204, v211
    v_cvt_pk_bf16_f32 v105, v106, v107
    v_mfma_f32_16x16x32_bf16 v[56:59], a[112:115], v[232:235], v[248:251]
    s_mov_b32 m0, s70
    v_permlane32_swap_b32_e32 v204, v205
    v_cvt_pk_bf16_f32 v106, v108, v109
    v_cvt_pk_bf16_f32 v107, v110, v111
    v_mfma_f32_16x16x32_bf16 v[56:59], a[116:119], v[236:239], v[56:59]
    s_cbranch_vccnz L_rt7
L_bk7:
    ds_write_b128 v242, v[104:107] offset:64
    v_pk_fma_f32 v[112:113], v[112:113], v[240:241], v[240:241] op_sel:[0,0,1] op_sel_hi:[1,0,1]
    v_pk_fma_f32 v[114:115], v[114:115], v[240:241], v[240:241] op_sel:[0,0,1] op_sel_hi:[1,0,1]
    v_pk_fma_f32 v[116:117], v[116:117], v[240:241], v[240:241] op_sel:[0,0,1] op_sel_hi:[1,0,1]
    v_pk_fma_f32 v[118:119], v[118:119], v[240:241], v[240:241] op_sel:[0,0,1] op_sel_hi:[1,0,1]
    v_mfma_f32_16x16x32_bf16 v[60:63], a[124:127], v[236:239], v[248:251]
    v_exp_f32_e32 v216, v216
    v_exp_f32_e64 v217, v217
    v_max_f32_e32 v206, v204, v205
    v_max_f32_e32 v207, v204, v205
    v_mfma_f32_16x16x32_bf16 v[60:63], a[120:123], v[232:235], v[60:63]
    v_exp_f32_e32 v218, v218
    v_exp_f32_e32 v219, v219
    v_cvt_pk_bf16_f32 v226, v212, v213
    v_cvt_pk_bf16_f32 v227, v214, v215
    v_permlane16_swap_b32_e32 v206, v207
    v_max_f32_e32 v207, v206, v207
    v_sub_f32_e32 v204, -4.0, v207
    v_sub_f32_e32 v205, -4.0, v207
    v_pk_mov_b32 v[206:207], v[204:205], v[204:205] op_sel:[0,1]
    v_pk_add_f32 v[208:209], v[208:209], v[204:205]
    v_pk_add_f32 v[210:211], v[210:211], v[204:205]
    v_mfma_f32_16x16x32_bf16 v[212:215], a[28:31], v[188:191], v[204:207]
    v_exp_f32_e64 v220, v220
    v_mfma_f32_16x16x32_bf16 v[212:215], a[24:27], v[184:187], v[212:215]
    buffer_store_dwordx4 a[156:159], v255, s[16:19], s22 offen offset:3072 sc0 sc1 nt
    v_exp_f32_e64 v221, v221
    v_cvt_pk_bf16_f32 v112, v112, v113
    v_mfma_f32_16x16x32_bf16 v[212:215], a[20:23], v[180:183], v[212:215]
    s_xor_b32 s22, s22, 49152
    v_exp_f32_e64 v222, v222
    v_cvt_pk_bf16_f32 v113, v114, v115
    v_cvt_pk_bf16_f32 v114, v116, v117
    v_cvt_pk_bf16_f32 v115, v118, v119
    v_mfma_f32_16x16x32_bf16 v[212:215], a[16:19], v[176:179], v[212:215]
    ds_write_b128 v242, v[112:115] offset:128
    v_pk_fma_f32 v[120:121], v[120:121], v[240:241], v[240:241] op_sel:[0,0,1] op_sel_hi:[1,0,1]
    v_pk_fma_f32 v[122:123], v[122:123], v[240:241], v[240:241] op_sel:[0,0,1] op_sel_hi:[1,0,1]
    v_pk_fma_f32 v[124:125], v[124:125], v[240:241], v[240:241] op_sel:[0,0,1] op_sel_hi:[1,0,1]
    v_pk_fma_f32 v[126:127], v[126:127], v[240:241], v[240:241] op_sel:[0,0,1] op_sel_hi:[1,0,1]
    v_cvt_pk_bf16_f32 v228, v216, v217
    v_cvt_pk_bf16_f32 v229, v218, v219
    v_mfma_f32_16x16x32_bf16 v[216:219], a[32:35], v[176:179], v[204:207]
    v_exp_f32_e32 v223, v223
    v_mfma_f32_16x16x32_bf16 v[216:219], a[36:39], v[180:183], v[216:219]
    v_cvt_pk_bf16_f32 v230, v220, v221
    v_cvt_pk_bf16_f32 v231, v222, v223
    v_mfma_f32_16x16x32_bf16 v[216:219], a[40:43], v[184:187], v[216:219]
    ds_read_b128 a[0:3], v252 offset:16896
    v_cvt_pk_bf16_f32 v120, v120, v121
    v_mfma_f32_16x16x32_bf16 v[216:219], a[44:47], v[188:191], v[216:219]
    ds_read_b128 a[4:7], v252 offset:17152
    v_cvt_pk_bf16_f32 v121, v122, v123
    v_mfma_f32_16x16x32_bf16 v[220:223], a[60:63], v[188:191], v[204:207]
    v_cvt_pk_bf16_f32 v122, v124, v125
    v_cvt_pk_bf16_f32 v123, v126, v127
    v_mfma_f32_16x16x32_bf16 v[220:223], a[56:59], v[184:187], v[220:223]
    v_accvgpr_write_b32 a200, 0
    v_accvgpr_write_b32 a201, 0
    v_mfma_f32_16x16x32_bf16 v[220:223], a[52:55], v[180:183], v[220:223]
    ds_write_b128 v242, v[120:123] offset:192
    v_mfma_f32_16x16x32_bf16 v[220:223], a[48:51], v[176:179], v[220:223]
    ds_read_b128 a[176:179], v247 offset:0
    buffer_load_dwordx4 v254, s[8:11], s20 offen offset:3072 nt lds
    v_smfmac_f32_16x16x64_bf16 a[200:203], a[208:211], v[224:231], v245
    s_mov_b32 m0, s27
    ds_read_b128 a[180:183], v247 offset:1088
    v_mfma_f32_16x16x32_bf16 v[64:67], a[64:67], v[224:227], v[248:251]
    ds_read_b128 a[184:187], v247 offset:2176
    v_accvgpr_write_b32 a204, 0
    v_mfma_f32_16x16x32_bf16 v[64:67], a[68:71], v[228:231], v[64:67]
    ds_read_b128 a[188:191], v247 offset:3264
    v_accvgpr_write_b32 a205, 0
    v_mfma_f32_16x16x32_bf16 v[68:71], a[76:79], v[228:231], v[248:251]
    v_exp_f32_e32 v208, v208
    v_mfma_f32_16x16x32_bf16 v[68:71], a[72:75], v[224:227], v[68:71]
    v_exp_f32_e32 v209, v209
    v_mfma_f32_16x16x32_bf16 v[72:75], a[80:83], v[224:227], v[248:251]
    ds_read_b128 a[8:11], v252 offset:17408
    v_cvt_pk_bf16_f32 v232, v208, v209
    v_mfma_f32_16x16x32_bf16 v[72:75], a[84:87], v[228:231], v[72:75]
    v_exp_f32_e32 v210, v210
    v_mfma_f32_16x16x32_bf16 v[76:79], a[92:95], v[228:231], v[248:251]
    v_exp_f32_e32 v211, v211
    v_mfma_f32_16x16x32_bf16 v[76:79], a[88:91], v[224:227], v[76:79]
    ds_read_b128 a[12:15], v252 offset:17664
    v_cvt_pk_bf16_f32 v233, v210, v211
    v_mfma_f32_16x16x32_bf16 v[80:83], a[96:99], v[224:227], v[248:251]
    ds_read_b128 a[28:31], v252 offset:21888
    v_mfma_f32_16x16x32_bf16 v[80:83], a[100:103], v[228:231], v[80:83]
    ds_read_b128 a[24:27], v252 offset:21632
    v_mfma_f32_16x16x32_bf16 v[84:87], a[108:111], v[228:231], v[248:251]
    s_waitcnt lgkmcnt(4)
    buffer_load_dwordx4 v254, s[4:7], s21 offen nt lds
    v_mfma_f32_16x16x32_bf16 v[84:87], a[104:107], v[224:227], v[84:87]
    s_mov_b32 m0, s90
    ds_read_b128 a[20:23], v252 offset:21376
    v_mfma_f32_16x16x32_bf16 v[88:91], a[112:115], v[224:227], v[248:251]
    ds_read_b128 a[16:19], v252 offset:21120
    v_exp_f32_e32 v212, v212
    v_mfma_f32_16x16x32_bf16 v[88:91], a[116:119], v[228:231], v[88:91]
    ds_read_b128 a[32:35], v252 offset:25344
    v_exp_f32_e32 v213, v213
    v_mfma_f32_16x16x32_bf16 v[92:95], a[124:127], v[228:231], v[248:251]
    ds_read_b128 a[36:39], v252 offset:25600
    v_exp_f32_e32 v214, v214
    v_mfma_f32_16x16x32_bf16 v[92:95], a[120:123], v[224:227], v[92:95]
    ds_read_b128 a[40:43], v252 offset:25856
    buffer_load_dwordx4 v254, s[12:15], s20 offen nt lds
    v_exp_f32_e32 v215, v215
    v_mfma_f32_16x16x32_bf16 v[208:211], a[0:3], v[128:131], v[192:195]
    s_mov_b32 m0, s71
    ds_read_b128 a[44:47], v252 offset:26112
    v_exp_f32_e32 v216, v216
    v_mfma_f32_16x16x32_bf16 v[208:211], a[4:7], v[132:135], v[208:211]
    s_waitcnt lgkmcnt(9)
    ds_read_b128 a[60:63], v252 offset:30336
    v_exp_f32_e32 v217, v217
    v_mfma_f32_16x16x32_bf16 v[208:211], a[8:11], v[136:139], v[208:211]
    s_waitcnt lgkmcnt(9)
    ds_read_b128 a[56:59], v252 offset:30080
    v_exp_f32_e32 v218, v218
    v_mfma_f32_16x16x32_bf16 v[208:211], a[12:15], v[140:143], v[208:211]
    s_waitcnt lgkmcnt(8)
    ds_read_b128 a[52:55], v252 offset:29824
    v_exp_f32_e32 v219, v219
    v_cvt_pk_bf16_f32 v234, v212, v213
    v_cvt_pk_bf16_f32 v235, v214, v215
    v_mfma_f32_16x16x32_bf16 v[212:215], a[28:31], v[140:143], v[192:195]
    ds_read_b128 a[48:51], v252 offset:29568
    v_exp_f32_e32 v220, v220
    v_mfma_f32_16x16x32_bf16 v[212:215], a[24:27], v[136:139], v[212:215]
    s_waitcnt lgkmcnt(8)
    v_exp_f32_e32 v221, v221
    v_mfma_f32_16x16x32_bf16 v[212:215], a[20:23], v[132:135], v[212:215]
    v_exp_f32_e32 v222, v222
    v_mfma_f32_16x16x32_bf16 v[212:215], a[16:19], v[128:131], v[212:215]
    s_waitcnt lgkmcnt(7)
    v_exp_f32_e32 v223, v223
    v_cvt_pk_bf16_f32 v236, v216, v217
    v_cvt_pk_bf16_f32 v237, v218, v219
    v_mfma_f32_16x16x32_bf16 v[216:219], a[32:35], v[128:131], v[192:195]
    s_waitcnt lgkmcnt(6)
    ds_read_b64_tr_b16 a[224:225], v253 offset:16512
    v_cvt_pk_bf16_f32 v238, v220, v221
    v_mfma_f32_16x16x32_bf16 v[216:219], a[36:39], v[132:135], v[216:219]
    s_waitcnt lgkmcnt(6)
    ds_read_b64_tr_b16 a[226:227], v253 offset:20640
    v_cvt_pk_bf16_f32 v239, v222, v223
    v_mfma_f32_16x16x32_bf16 v[216:219], a[40:43], v[136:139], v[216:219]
    s_waitcnt lgkmcnt(6)
    buffer_load_dwordx4 v254, s[4:7], s21 offen offset:1024 nt lds
    v_mfma_f32_16x16x32_bf16 v[216:219], a[44:47], v[140:143], v[216:219]
    s_waitcnt lgkmcnt(5)
    v_exp_f32_e32 v208, v208
    v_mfma_f32_16x16x32_bf16 v[220:223], a[60:63], v[140:143], v[192:195]
    s_waitcnt lgkmcnt(4)
    v_exp_f32_e32 v209, v209
    v_mfma_f32_16x16x32_bf16 v[220:223], a[56:59], v[136:139], v[220:223]
    s_waitcnt lgkmcnt(3)
    v_exp_f32_e32 v210, v210
    v_mfma_f32_16x16x32_bf16 v[220:223], a[52:55], v[132:135], v[220:223]
    s_waitcnt lgkmcnt(2)
    s_mov_b32 m0, s91
    v_cvt_pk_bf16_f32 v224, v208, v209
    v_mfma_f32_16x16x32_bf16 v[220:223], a[48:51], v[128:131], v[220:223]
    buffer_load_dwordx4 v254, s[12:15], s20 offen offset:1024 nt lds
    v_smfmac_f32_16x16x64_bf16 a[204:207], a[208:211], v[232:239], v245
    s_mov_b32 m0, s92
    ds_read_b64_tr_b16 a[228:229], v253 offset:24768
    v_mfma_f32_16x16x32_bf16 v[96:99], a[64:67], v[232:235], v[248:251]
    v_exp_f32_e32 v211, v211
    v_mfma_f32_16x16x32_bf16 v[96:99], a[68:71], v[236:239], v[96:99]
    buffer_load_dwordx4 v254, s[12:15], s20 offen offset:2048 nt lds
    v_mfma_f32_16x16x32_bf16 v[100:103], a[76:79], v[236:239], v[248:251]
    s_mov_b32 m0, s72
    v_exp_f32_e32 v212, v212
    v_mfma_f32_16x16x32_bf16 v[100:103], a[72:75], v[232:235], v[100:103]
    v_exp_f32_e32 v213, v213
    v_mfma_f32_16x16x32_bf16 v[104:107], a[80:83], v[232:235], v[248:251]
    v_exp_f32_e32 v214, v214
    v_mfma_f32_16x16x32_bf16 v[104:107], a[84:87], v[236:239], v[104:107]
    v_exp_f32_e32 v215, v215
    v_mfma_f32_16x16x32_bf16 v[108:111], a[92:95], v[236:239], v[248:251]
    ds_read_b64_tr_b16 a[230:231], v253 offset:28896
    v_cvt_pk_bf16_f32 v225, v210, v211
    v_mfma_f32_16x16x32_bf16 v[108:111], a[88:91], v[232:235], v[108:111]
    v_exp_f32_e32 v216, v216
    v_mfma_f32_16x16x32_bf16 v[112:115], a[96:99], v[232:235], v[248:251]
    v_exp_f32_e32 v217, v217
    v_mfma_f32_16x16x32_bf16 v[112:115], a[100:103], v[236:239], v[112:115]
    v_exp_f32_e32 v218, v218
    v_mfma_f32_16x16x32_bf16 v[116:119], a[108:111], v[236:239], v[248:251]
    v_exp_f32_e32 v219, v219
    v_mfma_f32_16x16x32_bf16 v[116:119], a[104:107], v[232:235], v[116:119]
    ds_read_b64_tr_b16 a[236:237], v253 offset:24776
    v_cvt_pk_bf16_f32 v226, v212, v213
    v_mfma_f32_16x16x32_bf16 v[120:123], a[112:115], v[232:235], v[248:251]
    ds_read_b64_tr_b16 a[238:239], v253 offset:28904
    v_cvt_pk_bf16_f32 v227, v214, v215
    v_mfma_f32_16x16x32_bf16 v[120:123], a[116:119], v[236:239], v[120:123]
    v_exp_f32_e32 v220, v220
    v_mfma_f32_16x16x32_bf16 v[124:127], a[124:127], v[236:239], v[248:251]
    v_exp_f32_e32 v221, v221
    v_mfma_f32_16x16x32_bf16 v[124:127], a[120:123], v[232:235], v[124:127]
    v_exp_f32_e32 v222, v222
    v_mfma_f32_16x16x32_bf16 v[208:211], a[0:3], v[144:147], v[196:199]
    s_add_u32 s44, s44, 1
    v_exp_f32_e32 v223, v223
    v_mfma_f32_16x16x32_bf16 v[208:211], a[4:7], v[148:151], v[208:211]
    ds_read_b64_tr_b16 a[232:233], v253 offset:16520
    v_cvt_pk_bf16_f32 v228, v216, v217
    v_mfma_f32_16x16x32_bf16 v[208:211], a[8:11], v[152:155], v[208:211]
    ds_read_b64_tr_b16 a[234:235], v253 offset:20648
    v_cvt_pk_bf16_f32 v229, v218, v219
    v_mfma_f32_16x16x32_bf16 v[208:211], a[12:15], v[156:159], v[208:211]
    buffer_load_dwordx4 v254, s[4:7], s21 offen offset:2048 nt lds
    v_mfma_f32_16x16x32_bf16 v[212:215], a[28:31], v[156:159], v[196:199]
    s_mov_b32 m0, s93
    ds_read_b64_tr_b16 a[240:241], v253 offset:16768
    v_cvt_pk_bf16_f32 v230, v220, v221
    v_mfma_f32_16x16x32_bf16 v[212:215], a[24:27], v[152:155], v[212:215]
    ds_read_b64_tr_b16 a[242:243], v253 offset:20896
    v_cvt_pk_bf16_f32 v231, v222, v223
    v_mfma_f32_16x16x32_bf16 v[212:215], a[20:23], v[148:151], v[212:215]
    buffer_load_dwordx4 v254, s[12:15], s20 offen offset:3072 nt lds
    v_mfma_f32_16x16x32_bf16 v[212:215], a[16:19], v[144:147], v[212:215]
    s_mov_b32 m0, s73
    v_exp_f32_e32 v208, v208
    v_mfma_f32_16x16x32_bf16 v[216:219], a[32:35], v[144:147], v[196:199]
    s_xor_b32 s20, s20, 114688
    ds_read_b64_tr_b16 a[244:245], v253 offset:25024
    ds_read_b64_tr_b16 a[246:247], v253 offset:29152
    v_mfma_f32_16x16x32_bf16 v[216:219], a[36:39], v[148:151], v[216:219]
    ds_read_b64_tr_b16 a[252:253], v253 offset:25032
    ds_read_b64_tr_b16 a[254:255], v253 offset:29160
    v_mfma_f32_16x16x32_bf16 v[216:219], a[40:43], v[152:155], v[216:219]
    ds_read_b64_tr_b16 a[248:249], v253 offset:16776
    ds_read_b64_tr_b16 a[250:251], v253 offset:20904
    v_mfma_f32_16x16x32_bf16 v[216:219], a[44:47], v[156:159], v[216:219]
    ds_read_b64_tr_b16 a[96:97], v253 offset:17024
    ds_read_b64_tr_b16 a[98:99], v253 offset:21152
    v_mfma_f32_16x16x32_bf16 v[220:223], a[60:63], v[156:159], v[196:199]
    ds_read_b64_tr_b16 a[100:101], v253 offset:25280
    ds_read_b64_tr_b16 a[102:103], v253 offset:29408
    v_mfma_f32_16x16x32_bf16 v[220:223], a[56:59], v[152:155], v[220:223]
    s_waitcnt vmcnt(15)
    ds_read_b64_tr_b16 a[108:109], v253 offset:25288
    ds_read_b64_tr_b16 a[110:111], v253 offset:29416
    v_mfma_f32_16x16x32_bf16 v[220:223], a[52:55], v[148:151], v[220:223]
    buffer_load_dwordx4 v254, s[4:7], s21 offen offset:3072 nt lds
    v_mfma_f32_16x16x32_bf16 v[220:223], a[48:51], v[144:147], v[220:223]
    s_mov_b32 m0, s23
    ds_read_b64_tr_b16 a[104:105], v253 offset:17032
    ds_read_b64_tr_b16 a[106:107], v253 offset:21160
    v_smfmac_f32_16x16x64_bf16 a[192:195], a[208:211], v[224:231], v245
    s_waitcnt lgkmcnt(15)
    ds_read_b64_tr_b16 a[112:113], v253 offset:17280
    v_mfma_f32_16x16x32_bf16 v[0:3], a[224:227], v[224:227], v[0:3]
    s_xor_b32 s21, s21, 16384
    ds_read_b64_tr_b16 a[114:115], v253 offset:21408
    ds_read_b64_tr_b16 a[116:117], v253 offset:25536
    v_mfma_f32_16x16x32_bf16 v[0:3], a[228:231], v[228:231], v[0:3]
    buffer_load_dwordx4 v254, s[8:11], s20 offen nt lds
    v_mfma_f32_16x16x32_bf16 v[4:7], a[236:239], v[228:231], v[4:7]
    s_mov_b32 m0, s45
    ds_read_b64_tr_b16 a[118:119], v253 offset:29664
    v_mov_b32_e32 v244, s44
    v_mfma_f32_16x16x32_bf16 v[4:7], a[232:235], v[224:227], v[4:7]
    s_waitcnt lgkmcnt(15)
    ds_read_b64_tr_b16 a[124:125], v253 offset:25544
    ds_read_b64_tr_b16 a[126:127], v253 offset:29672
    ds_write_addtid_b32 v244
    v_mfma_f32_16x16x32_bf16 v[8:11], a[240:243], v[224:227], v[8:11]
    ds_read_b64_tr_b16 a[120:121], v253 offset:17288
    ds_read_b64_tr_b16 a[122:123], v253 offset:21416
    v_mfma_f32_16x16x32_bf16 v[8:11], a[244:247], v[228:231], v[8:11]
    s_waitcnt lgkmcnt(15)
    v_exp_f32_e32 v209, v209
    v_mfma_f32_16x16x32_bf16 v[12:15], a[252:255], v[228:231], v[12:15]
    v_exp_f32_e32 v210, v210
    v_mfma_f32_16x16x32_bf16 v[12:15], a[248:251], v[224:227], v[12:15]
    v_exp_f32_e32 v211, v211
    v_mfma_f32_16x16x32_bf16 v[16:19], a[96:99], v[224:227], v[16:19]
    s_waitcnt lgkmcnt(11)
    v_exp_f32_e32 v212, v212
    v_mfma_f32_16x16x32_bf16 v[16:19], a[100:103], v[228:231], v[16:19]
    v_exp_f32_e32 v213, v213
    v_mfma_f32_16x16x32_bf16 v[20:23], a[108:111], v[228:231], v[20:23]
    s_waitcnt lgkmcnt(9)
    v_exp_f32_e32 v214, v214
    v_mfma_f32_16x16x32_bf16 v[20:23], a[104:107], v[224:227], v[20:23]
    s_waitcnt lgkmcnt(7)
    v_exp_f32_e32 v215, v215
    v_mfma_f32_16x16x32_bf16 v[24:27], a[112:115], v[224:227], v[24:27]
    s_waitcnt lgkmcnt(5)
    v_cvt_pk_bf16_f32 v232, v208, v209
    v_cvt_pk_bf16_f32 v233, v210, v211
    v_mfma_f32_16x16x32_bf16 v[24:27], a[116:119], v[228:231], v[24:27]
    s_waitcnt lgkmcnt(3)
    v_exp_f32_e32 v216, v216
    v_mfma_f32_16x16x32_bf16 v[28:31], a[124:127], v[228:231], v[28:31]
    s_waitcnt lgkmcnt(0)
    v_exp_f32_e32 v217, v217
    v_mfma_f32_16x16x32_bf16 v[28:31], a[120:123], v[224:227], v[28:31]
    s_mov_b32 m0, s94
    v_exp_f32_e32 v218, v218
    v_mfma_f32_16x16x32_bf16 v[208:211], a[0:3], v[160:163], v[200:203]
    v_exp_f32_e32 v219, v219
    v_mfma_f32_16x16x32_bf16 v[208:211], a[4:7], v[164:167], v[208:211]
    v_cvt_pk_bf16_f32 v234, v212, v213
    v_cvt_pk_bf16_f32 v235, v214, v215
    v_mfma_f32_16x16x32_bf16 v[208:211], a[8:11], v[168:171], v[208:211]
    v_exp_f32_e32 v220, v220
    v_mfma_f32_16x16x32_bf16 v[208:211], a[12:15], v[172:175], v[208:211]
    v_exp_f32_e32 v221, v221
    v_mfma_f32_16x16x32_bf16 v[212:215], a[28:31], v[172:175], v[200:203]
    v_exp_f32_e32 v222, v222
    v_mfma_f32_16x16x32_bf16 v[212:215], a[24:27], v[168:171], v[212:215]
    v_exp_f32_e32 v223, v223
    v_mfma_f32_16x16x32_bf16 v[212:215], a[20:23], v[164:167], v[212:215]
    v_cvt_pk_bf16_f32 v236, v216, v217
    v_cvt_pk_bf16_f32 v237, v218, v219
    v_mfma_f32_16x16x32_bf16 v[212:215], a[16:19], v[160:163], v[212:215]
    v_cvt_pk_bf16_f32 v238, v220, v221
    v_cvt_pk_bf16_f32 v239, v222, v223
    v_mfma_f32_16x16x32_bf16 v[216:219], a[32:35], v[160:163], v[200:203]
    buffer_load_dwordx4 v254, s[8:11], s20 offen offset:1024 nt lds
    v_mfma_f32_16x16x32_bf16 v[216:219], a[36:39], v[164:167], v[216:219]
    s_mov_b32 m0, s95
    v_exp_f32_e32 v208, v208
    v_mfma_f32_16x16x32_bf16 v[216:219], a[40:43], v[168:171], v[216:219]
    v_exp_f32_e32 v209, v209
    v_mfma_f32_16x16x32_bf16 v[216:219], a[44:47], v[172:175], v[216:219]
    v_exp_f32_e32 v210, v210
    v_mfma_f32_16x16x32_bf16 v[220:223], a[60:63], v[172:175], v[200:203]
    v_exp_f32_e32 v211, v211
    v_mfma_f32_16x16x32_bf16 v[220:223], a[56:59], v[168:171], v[220:223]
    buffer_load_dwordx4 v254, s[8:11], s20 offen offset:2048 nt lds
    v_mfma_f32_16x16x32_bf16 v[220:223], a[52:55], v[164:167], v[220:223]
    v_exp_f32_e32 v212, v212
    v_mfma_f32_16x16x32_bf16 v[220:223], a[48:51], v[160:163], v[220:223]
    v_exp_f32_e32 v213, v213
    v_smfmac_f32_16x16x64_bf16 a[196:199], a[208:211], v[232:239], v245
    v_cvt_pk_bf16_f32 v224, v208, v209
    v_mfma_f32_16x16x32_bf16 v[32:35], a[224:227], v[232:235], v[32:35]
    v_exp_f32_e32 v214, v214
    v_mfma_f32_16x16x32_bf16 v[32:35], a[228:231], v[236:239], v[32:35]
    ds_read_b32 v244, v255
    v_cvt_pk_bf16_f32 v225, v210, v211
    v_mfma_f32_16x16x32_bf16 v[36:39], a[236:239], v[236:239], v[36:39]
    v_exp_f32_e32 v215, v215
    v_mfma_f32_16x16x32_bf16 v[36:39], a[232:235], v[232:235], v[36:39]
    v_exp_f32_e32 v216, v216
    v_mfma_f32_16x16x32_bf16 v[40:43], a[240:243], v[232:235], v[40:43]
    v_exp_f32_e32 v217, v217
    v_mfma_f32_16x16x32_bf16 v[40:43], a[244:247], v[236:239], v[40:43]
    s_mov_b32 m0, s96
    v_exp_f32_e32 v218, v218
    v_mfma_f32_16x16x32_bf16 v[44:47], a[252:255], v[236:239], v[44:47]
    v_exp_f32_e32 v219, v219
    v_mfma_f32_16x16x32_bf16 v[44:47], a[248:251], v[232:235], v[44:47]
    buffer_store_dwordx4 a[160:163], v255, s[16:19], s22 offen sc0 sc1 nt
    v_mfma_f32_16x16x32_bf16 v[48:51], a[96:99], v[232:235], v[48:51]
    s_waitcnt lgkmcnt(0)
    v_cmp_gt_u32_e32 vcc, s44, v244
    v_cvt_pk_bf16_f32 v226, v212, v213
    v_mfma_f32_16x16x32_bf16 v[48:51], a[100:103], v[236:239], v[48:51]
    v_cvt_pk_bf16_f32 v227, v214, v215
    v_cvt_pk_bf16_f32 v228, v216, v217
    v_mfma_f32_16x16x32_bf16 v[52:55], a[108:111], v[236:239], v[52:55]
    s_cbranch_vccnz L_rt8
L_bk8:
    v_exp_f32_e32 v220, v220
    v_mfma_f32_16x16x32_bf16 v[52:55], a[104:107], v[232:235], v[52:55]
    v_exp_f32_e32 v221, v221
    v_mfma_f32_16x16x32_bf16 v[56:59], a[112:115], v[232:235], v[56:59]
    v_exp_f32_e32 v222, v222
    v_mfma_f32_16x16x32_bf16 v[56:59], a[116:119], v[236:239], v[56:59]
    v_exp_f32_e32 v223, v223
    v_mfma_f32_16x16x32_bf16 v[60:63], a[124:127], v[236:239], v[60:63]
    ds_read_b64_tr_b16 a[64:65], v253 offset:33024
    v_cvt_pk_bf16_f32 v229, v218, v219
    v_mfma_f32_16x16x32_bf16 v[60:63], a[120:123], v[232:235], v[60:63]
    ds_read_b64_tr_b16 a[66:67], v253 offset:37152
    v_cvt_pk_bf16_f32 v230, v220, v221
    v_mfma_f32_16x16x32_bf16 v[208:211], a[0:3], v[176:179], v[204:207]
    ds_read_b128 a[0:3], v252 offset:33792
    v_cvt_pk_bf16_f32 v231, v222, v223
    v_mfma_f32_16x16x32_bf16 v[208:211], a[4:7], v[180:183], v[208:211]
    buffer_load_dwordx4 v254, s[8:11], s20 offen offset:3072 nt lds
    v_mfma_f32_16x16x32_bf16 v[208:211], a[8:11], v[184:187], v[208:211]
    ds_read_b128 a[4:7], v252 offset:34048
    v_mfma_f32_16x16x32_bf16 v[208:211], a[12:15], v[188:191], v[208:211]
    ds_read_b128 a[8:11], v252 offset:34304
    v_mfma_f32_16x16x32_bf16 v[212:215], a[28:31], v[188:191], v[204:207]
    ds_read_b128 a[12:15], v252 offset:34560
    v_mfma_f32_16x16x32_bf16 v[212:215], a[24:27], v[184:187], v[212:215]
    v_exp_f32_e32 v208, v208
    v_mfma_f32_16x16x32_bf16 v[212:215], a[20:23], v[180:183], v[212:215]
    s_mov_b32 m0, s24
    v_exp_f32_e32 v209, v209
    v_mfma_f32_16x16x32_bf16 v[212:215], a[16:19], v[176:179], v[212:215]
    v_exp_f32_e32 v210, v210
    v_mfma_f32_16x16x32_bf16 v[216:219], a[32:35], v[176:179], v[204:207]
    v_exp_f32_e32 v211, v211
    v_mfma_f32_16x16x32_bf16 v[216:219], a[36:39], v[180:183], v[216:219]
    ds_read_b128 a[28:31], v252 offset:38784
    v_cvt_pk_bf16_f32 v232, v208, v209
    v_mfma_f32_16x16x32_bf16 v[216:219], a[40:43], v[184:187], v[216:219]
    ds_read_b128 a[24:27], v252 offset:38528
    v_cvt_pk_bf16_f32 v233, v210, v211
    v_mfma_f32_16x16x32_bf16 v[216:219], a[44:47], v[188:191], v[216:219]
    buffer_load_dwordx4 v254, s[12:15], s20 offen nt lds
    v_mfma_f32_16x16x32_bf16 v[220:223], a[60:63], v[188:191], v[204:207]
    v_exp_f32_e32 v212, v212
    v_mfma_f32_16x16x32_bf16 v[220:223], a[56:59], v[184:187], v[220:223]
    v_exp_f32_e32 v213, v213
    v_mfma_f32_16x16x32_bf16 v[220:223], a[52:55], v[180:183], v[220:223]
    ds_read_b128 a[20:23], v252 offset:38272
    v_cvt_pk_bf16_f32 v234, v212, v213
    v_mfma_f32_16x16x32_bf16 v[220:223], a[48:51], v[176:179], v[220:223]
    v_exp_f32_e32 v214, v214
    v_smfmac_f32_16x16x64_bf16 a[200:203], a[208:211], v[224:231], v245
    ds_read_b128 a[16:19], v252 offset:38016
    v_mfma_f32_16x16x32_bf16 v[64:67], a[224:227], v[224:227], v[64:67]
    v_exp_f32_e32 v215, v215
    v_mfma_f32_16x16x32_bf16 v[64:67], a[228:231], v[228:231], v[64:67]
    ds_read_b128 a[32:35], v252 offset:42240
    v_cvt_pk_bf16_f32 v235, v214, v215
    v_mfma_f32_16x16x32_bf16 v[68:71], a[236:239], v[228:231], v[68:71]
    v_exp_f32_e32 v216, v216
    v_mfma_f32_16x16x32_bf16 v[68:71], a[232:235], v[224:227], v[68:71]
    v_exp_f32_e32 v217, v217
    v_mfma_f32_16x16x32_bf16 v[72:75], a[240:243], v[224:227], v[72:75]
    ds_read_b128 a[36:39], v252 offset:42496
    v_cvt_pk_bf16_f32 v236, v216, v217
    v_mfma_f32_16x16x32_bf16 v[72:75], a[244:247], v[228:231], v[72:75]
    s_mov_b32 m0, s64
    v_exp_f32_e32 v218, v218
    v_mfma_f32_16x16x32_bf16 v[76:79], a[252:255], v[228:231], v[76:79]
    v_exp_f32_e32 v219, v219
    v_mfma_f32_16x16x32_bf16 v[76:79], a[248:251], v[224:227], v[76:79]
    ds_read_b128 a[40:43], v252 offset:42752
    v_cvt_pk_bf16_f32 v237, v218, v219
    v_mfma_f32_16x16x32_bf16 v[80:83], a[96:99], v[224:227], v[80:83]
    v_exp_f32_e32 v220, v220
    v_mfma_f32_16x16x32_bf16 v[80:83], a[100:103], v[228:231], v[80:83]
    v_exp_f32_e32 v221, v221
    v_mfma_f32_16x16x32_bf16 v[84:87], a[108:111], v[228:231], v[84:87]
    ds_read_b128 a[44:47], v252 offset:43008
    v_cvt_pk_bf16_f32 v238, v220, v221
    v_mfma_f32_16x16x32_bf16 v[84:87], a[104:107], v[224:227], v[84:87]
    v_exp_f32_e32 v222, v222
    v_mfma_f32_16x16x32_bf16 v[88:91], a[112:115], v[224:227], v[88:91]
    v_exp_f32_e32 v223, v223
    v_mfma_f32_16x16x32_bf16 v[88:91], a[116:119], v[228:231], v[88:91]
    ds_read_b128 a[60:63], v252 offset:47232
    v_cvt_pk_bf16_f32 v239, v222, v223
    v_mfma_f32_16x16x32_bf16 v[92:95], a[124:127], v[228:231], v[92:95]
    buffer_load_dwordx4 v254, s[12:15], s20 offen offset:1024 nt lds
    v_mfma_f32_16x16x32_bf16 v[92:95], a[120:123], v[224:227], v[92:95]
    s_waitcnt lgkmcnt(4)
    ds_read_b128 a[56:59], v252 offset:46976
    v_mfma_f32_16x16x32_bf16 v[208:211], a[0:3], v[128:131], v[192:195]
    ds_read_b128 a[52:55], v252 offset:46720
    v_mfma_f32_16x16x32_bf16 v[208:211], a[4:7], v[132:135], v[208:211]
    ds_read_b128 a[48:51], v252 offset:46464
    v_mfma_f32_16x16x32_bf16 v[208:211], a[8:11], v[136:139], v[208:211]
    ds_read_b64_tr_b16 a[68:69], v253 offset:41280
    v_mfma_f32_16x16x32_bf16 v[208:211], a[12:15], v[140:143], v[208:211]
    ds_read_b64_tr_b16 a[70:71], v253 offset:45408
    v_mfma_f32_16x16x32_bf16 v[212:215], a[28:31], v[140:143], v[192:195]
    ds_read_b64_tr_b16 a[76:77], v253 offset:41288
    v_mfma_f32_16x16x32_bf16 v[212:215], a[24:27], v[136:139], v[212:215]
    v_exp_f32_e32 v208, v208
    v_mfma_f32_16x16x32_bf16 v[212:215], a[20:23], v[132:135], v[212:215]
    s_mov_b32 m0, s65
    v_exp_f32_e32 v209, v209
    v_mfma_f32_16x16x32_bf16 v[212:215], a[16:19], v[128:131], v[212:215]
    v_exp_f32_e32 v210, v210
    v_mfma_f32_16x16x32_bf16 v[216:219], a[32:35], v[128:131], v[192:195]
    s_waitcnt lgkmcnt(7)
    buffer_store_dwordx4 a[164:167], v255, s[16:19], s22 offen offset:1024 sc0 sc1 nt
    v_mfma_f32_16x16x32_bf16 v[216:219], a[36:39], v[132:135], v[216:219]
    v_exp_f32_e32 v211, v211
    v_mfma_f32_16x16x32_bf16 v[216:219], a[40:43], v[136:139], v[216:219]
    buffer_load_dwordx4 v254, s[12:15], s20 offen offset:2048 nt lds
    v_mfma_f32_16x16x32_bf16 v[216:219], a[44:47], v[140:143], v[216:219]
    s_waitcnt lgkmcnt(5)
    v_exp_f32_e32 v212, v212
    v_mfma_f32_16x16x32_bf16 v[220:223], a[60:63], v[140:143], v[192:195]
    v_exp_f32_e32 v213, v213
    v_mfma_f32_16x16x32_bf16 v[220:223], a[56:59], v[136:139], v[220:223]
    s_waitcnt lgkmcnt(3)
    v_exp_f32_e32 v214, v214
    v_mfma_f32_16x16x32_bf16 v[220:223], a[52:55], v[132:135], v[220:223]
    v_exp_f32_e32 v215, v215
    v_mfma_f32_16x16x32_bf16 v[220:223], a[48:51], v[128:131], v[220:223]
    ds_read_b64_tr_b16 a[78:79], v253 offset:45416
    v_cvt_pk_bf16_f32 v224, v208, v209
    v_smfmac_f32_16x16x64_bf16 a[204:207], a[208:211], v[232:239], v245
    v_cvt_pk_bf16_f32 v225, v210, v211
    v_mfma_f32_16x16x32_bf16 v[96:99], a[224:227], v[232:235], v[96:99]
    v_exp_f32_e32 v216, v216
    v_mfma_f32_16x16x32_bf16 v[96:99], a[228:231], v[236:239], v[96:99]
    v_exp_f32_e32 v217, v217
    v_mfma_f32_16x16x32_bf16 v[100:103], a[236:239], v[236:239], v[100:103]
    v_exp_f32_e32 v218, v218
    v_mfma_f32_16x16x32_bf16 v[100:103], a[232:235], v[232:235], v[100:103]
    v_exp_f32_e32 v219, v219
    v_mfma_f32_16x16x32_bf16 v[104:107], a[240:243], v[232:235], v[104:107]
    ds_read_b64_tr_b16 a[72:73], v253 offset:33032
    v_cvt_pk_bf16_f32 v226, v212, v213
    v_mfma_f32_16x16x32_bf16 v[104:107], a[244:247], v[236:239], v[104:107]
    s_mov_b32 m0, s66
    ds_read_b64_tr_b16 a[74:75], v253 offset:37160
    v_cvt_pk_bf16_f32 v227, v214, v215
    v_mfma_f32_16x16x32_bf16 v[108:111], a[252:255], v[236:239], v[108:111]
    v_exp_f32_e32 v220, v220
    v_mfma_f32_16x16x32_bf16 v[108:111], a[248:251], v[232:235], v[108:111]
    v_exp_f32_e32 v221, v221
    v_mfma_f32_16x16x32_bf16 v[112:115], a[96:99], v[232:235], v[112:115]
    v_exp_f32_e32 v222, v222
    v_mfma_f32_16x16x32_bf16 v[112:115], a[100:103], v[236:239], v[112:115]
    v_exp_f32_e32 v223, v223
    v_mfma_f32_16x16x32_bf16 v[116:119], a[108:111], v[236:239], v[116:119]
    ds_read_b64_tr_b16 a[80:81], v253 offset:33280
    v_cvt_pk_bf16_f32 v228, v216, v217
    v_mfma_f32_16x16x32_bf16 v[116:119], a[104:107], v[232:235], v[116:119]
    ds_read_b64_tr_b16 a[82:83], v253 offset:37408
    v_cvt_pk_bf16_f32 v229, v218, v219
    v_mfma_f32_16x16x32_bf16 v[120:123], a[112:115], v[232:235], v[120:123]
    ds_read_b64_tr_b16 a[84:85], v253 offset:41536
    v_cvt_pk_bf16_f32 v230, v220, v221
    v_mfma_f32_16x16x32_bf16 v[120:123], a[116:119], v[236:239], v[120:123]
    ds_read_b64_tr_b16 a[86:87], v253 offset:45664
    v_cvt_pk_bf16_f32 v231, v222, v223
    v_mfma_f32_16x16x32_bf16 v[124:127], a[124:127], v[236:239], v[124:127]
    buffer_load_dwordx4 v254, s[12:15], s20 offen offset:3072 nt lds
    v_mfma_f32_16x16x32_bf16 v[124:127], a[120:123], v[232:235], v[124:127]
    s_xor_b32 s20, s20, 16384
    ds_read_b64_tr_b16 a[92:93], v253 offset:41544
    s_sub_u32 s47, s47, 1
    s_cbranch_scc1 L_drain
    v_mfma_f32_16x16x32_bf16 v[208:211], a[0:3], v[144:147], v[196:199]
    s_add_u32 s44, s44, 1
    ds_read_b64_tr_b16 a[94:95], v253 offset:45672
    v_mfma_f32_16x16x32_bf16 v[208:211], a[4:7], v[148:151], v[208:211]
    ds_read_b64_tr_b16 a[88:89], v253 offset:33288
    v_mfma_f32_16x16x32_bf16 v[208:211], a[8:11], v[152:155], v[208:211]
    ds_read_b64_tr_b16 a[90:91], v253 offset:37416
    v_mfma_f32_16x16x32_bf16 v[208:211], a[12:15], v[156:159], v[208:211]
    ds_read_b64_tr_b16 a[96:97], v253 offset:33536
    v_mfma_f32_16x16x32_bf16 v[212:215], a[28:31], v[156:159], v[196:199]
    ds_read_b64_tr_b16 a[98:99], v253 offset:37664
    v_mfma_f32_16x16x32_bf16 v[212:215], a[24:27], v[152:155], v[212:215]
    v_exp_f32_e32 v208, v208
    v_mfma_f32_16x16x32_bf16 v[212:215], a[20:23], v[148:151], v[212:215]
    s_mov_b32 m0, s74
    v_exp_f32_e32 v209, v209
    v_mfma_f32_16x16x32_bf16 v[212:215], a[16:19], v[144:147], v[212:215]
    ds_read_b64_tr_b16 a[100:101], v253 offset:41792
    v_cvt_pk_bf16_f32 v232, v208, v209
    v_mfma_f32_16x16x32_bf16 v[216:219], a[32:35], v[144:147], v[196:199]
    s_waitcnt vmcnt(10)
    ds_read_b64_tr_b16 a[102:103], v253 offset:45920
    v_mov_b32_e32 v244, s44
    v_mfma_f32_16x16x32_bf16 v[216:219], a[36:39], v[148:151], v[216:219]
    buffer_load_dwordx4 v254, s[8:11], s20 offen nt lds
    v_mfma_f32_16x16x32_bf16 v[216:219], a[40:43], v[152:155], v[216:219]
    v_exp_f32_e32 v210, v210
    v_mfma_f32_16x16x32_bf16 v[216:219], a[44:47], v[156:159], v[216:219]
    v_exp_f32_e32 v211, v211
    v_mfma_f32_16x16x32_bf16 v[220:223], a[60:63], v[156:159], v[196:199]
    ds_read_b64_tr_b16 a[108:109], v253 offset:41800
    v_cvt_pk_bf16_f32 v233, v210, v211
    v_mfma_f32_16x16x32_bf16 v[220:223], a[56:59], v[152:155], v[220:223]
    v_exp_f32_e32 v212, v212
    v_mfma_f32_16x16x32_bf16 v[220:223], a[52:55], v[148:151], v[220:223]
    s_mov_b32 m0, s45
    ds_read_b64_tr_b16 a[110:111], v253 offset:45928
    ds_read_b64_tr_b16 a[104:105], v253 offset:33544
    v_mfma_f32_16x16x32_bf16 v[220:223], a[48:51], v[144:147], v[220:223]
    ds_read_b64_tr_b16 a[106:107], v253 offset:37672
    ds_read_b64_tr_b16 a[112:113], v253 offset:33792
    v_smfmac_f32_16x16x64_bf16 a[192:195], a[208:211], v[224:231], v245
    ds_read_b64_tr_b16 a[114:115], v253 offset:37920
    v_mfma_f32_16x16x32_bf16 v[0:3], a[64:67], v[224:227], v[0:3]
    s_waitcnt lgkmcnt(8)
    ds_read_b64_tr_b16 a[116:117], v253 offset:42048
    ds_read_b64_tr_b16 a[118:119], v253 offset:46176
    v_mfma_f32_16x16x32_bf16 v[0:3], a[68:71], v[228:231], v[0:3]
    ds_read_b64_tr_b16 a[124:125], v253 offset:42056
    ds_read_b64_tr_b16 a[126:127], v253 offset:46184
    v_mfma_f32_16x16x32_bf16 v[4:7], a[76:79], v[228:231], v[4:7]
    ds_write_addtid_b32 v244
    ds_read_b64_tr_b16 a[120:121], v253 offset:33800
    v_mfma_f32_16x16x32_bf16 v[4:7], a[72:75], v[224:227], v[4:7]
    ds_read_b64_tr_b16 a[122:123], v253 offset:37928
    ds_read_b128 a[128:131], v246 offset:0
    v_mfma_f32_16x16x32_bf16 v[8:11], a[80:83], v[224:227], v[8:11]
    v_exp_f32_e32 v213, v213
    v_mfma_f32_16x16x32_bf16 v[8:11], a[84:87], v[228:231], v[8:11]
    ds_read_b128 a[132:135], v246 offset:256
    ds_read_b128 a[136:139], v246 offset:512
    ds_read_b128 a[140:143], v246 offset:768
    v_mfma_f32_16x16x32_bf16 v[12:15], a[92:95], v[228:231], v[12:15]
    v_exp_f32_e32 v214, v214
    v_mfma_f32_16x16x32_bf16 v[12:15], a[88:91], v[224:227], v[12:15]
    v_exp_f32_e32 v215, v215
    v_mfma_f32_16x16x32_bf16 v[16:19], a[96:99], v[224:227], v[16:19]
    s_waitcnt lgkmcnt(15)
    v_exp_f32_e32 v216, v216
    v_mfma_f32_16x16x32_bf16 v[16:19], a[100:103], v[228:231], v[16:19]
    s_waitcnt lgkmcnt(6)
    v_exp_f32_e32 v217, v217
    v_mfma_f32_16x16x32_bf16 v[20:23], a[108:111], v[228:231], v[20:23]
    s_mov_b32 m0, s27
    v_exp_f32_e32 v218, v218
    v_mfma_f32_16x16x32_bf16 v[20:23], a[104:107], v[224:227], v[20:23]
    v_exp_f32_e32 v219, v219
    v_mfma_f32_16x16x32_bf16 v[24:27], a[112:115], v[224:227], v[24:27]
    v_cvt_pk_bf16_f32 v234, v212, v213
    v_cvt_pk_bf16_f32 v235, v214, v215
    v_mfma_f32_16x16x32_bf16 v[24:27], a[116:119], v[228:231], v[24:27]
    v_exp_f32_e32 v220, v220
    v_mfma_f32_16x16x32_bf16 v[28:31], a[124:127], v[228:231], v[28:31]
    s_waitcnt lgkmcnt(4)
    v_exp_f32_e32 v221, v221
    v_mfma_f32_16x16x32_bf16 v[28:31], a[120:123], v[224:227], v[28:31]
    v_exp_f32_e32 v222, v222
    v_mfma_f32_16x16x32_bf16 v[208:211], a[0:3], v[160:163], v[200:203]
    v_exp_f32_e32 v223, v223
    v_mfma_f32_16x16x32_bf16 v[208:211], a[4:7], v[164:167], v[208:211]
    v_cvt_pk_bf16_f32 v236, v216, v217
    v_cvt_pk_bf16_f32 v237, v218, v219
    v_mfma_f32_16x16x32_bf16 v[208:211], a[8:11], v[168:171], v[208:211]
    s_waitcnt lgkmcnt(0)
    buffer_load_dwordx4 v254, s[4:7], s21 offen nt lds
    v_mfma_f32_16x16x32_bf16 v[208:211], a[12:15], v[172:175], v[208:211]
    s_mov_b32 m0, s75
    v_cvt_pk_bf16_f32 v238, v220, v221
    v_cvt_pk_bf16_f32 v239, v222, v223
    v_mfma_f32_16x16x32_bf16 v[212:215], a[28:31], v[172:175], v[200:203]
    buffer_load_dwordx4 v254, s[8:11], s20 offen offset:1024 nt lds
    v_mfma_f32_16x16x32_bf16 v[212:215], a[24:27], v[168:171], v[212:215]
    v_exp_f32_e32 v208, v208
    v_mfma_f32_16x16x32_bf16 v[212:215], a[20:23], v[164:167], v[212:215]
    s_mov_b32 m0, s71
    v_exp_f32_e32 v209, v209
    v_mfma_f32_16x16x32_bf16 v[212:215], a[16:19], v[160:163], v[212:215]
    v_exp_f32_e32 v210, v210
    v_mfma_f32_16x16x32_bf16 v[216:219], a[32:35], v[160:163], v[200:203]
    v_exp_f32_e32 v211, v211
    v_mfma_f32_16x16x32_bf16 v[216:219], a[36:39], v[164:167], v[216:219]
    buffer_load_dwordx4 v254, s[4:7], s21 offen offset:1024 nt lds
    v_mfma_f32_16x16x32_bf16 v[216:219], a[40:43], v[168:171], v[216:219]
    s_mov_b32 m0, s76
    v_exp_f32_e32 v212, v212
    v_mfma_f32_16x16x32_bf16 v[216:219], a[44:47], v[172:175], v[216:219]
    buffer_load_dwordx4 v254, s[8:11], s20 offen offset:2048 nt lds
    v_mfma_f32_16x16x32_bf16 v[220:223], a[60:63], v[172:175], v[200:203]
    v_exp_f32_e32 v213, v213
    v_mfma_f32_16x16x32_bf16 v[220:223], a[56:59], v[168:171], v[220:223]
    v_exp_f32_e32 v214, v214
    v_mfma_f32_16x16x32_bf16 v[220:223], a[52:55], v[164:167], v[220:223]
    v_exp_f32_e32 v215, v215
    v_mfma_f32_16x16x32_bf16 v[220:223], a[48:51], v[160:163], v[220:223]
    v_cvt_pk_bf16_f32 v224, v208, v209
    v_cvt_pk_bf16_f32 v225, v210, v211
    v_smfmac_f32_16x16x64_bf16 a[196:199], a[208:211], v[232:239], v245
    v_cvt_pk_bf16_f32 v226, v212, v213
    v_mfma_f32_16x16x32_bf16 v[32:35], a[64:67], v[232:235], v[32:35]
    v_exp_f32_e32 v216, v216
    v_mfma_f32_16x16x32_bf16 v[32:35], a[68:71], v[236:239], v[32:35]
    ds_read_b32 v244, v255
    v_cvt_pk_bf16_f32 v227, v214, v215
    v_mfma_f32_16x16x32_bf16 v[36:39], a[76:79], v[236:239], v[36:39]
    v_exp_f32_e32 v217, v217
    v_mfma_f32_16x16x32_bf16 v[36:39], a[72:75], v[232:235], v[36:39]
    v_exp_f32_e32 v218, v218
    v_mfma_f32_16x16x32_bf16 v[40:43], a[80:83], v[232:235], v[40:43]
    v_exp_f32_e32 v219, v219
    v_mfma_f32_16x16x32_bf16 v[40:43], a[84:87], v[236:239], v[40:43]
    s_mov_b32 m0, s77
    v_exp_f32_e32 v220, v220
    v_mfma_f32_16x16x32_bf16 v[44:47], a[92:95], v[236:239], v[44:47]
    v_exp_f32_e32 v221, v221
    v_mfma_f32_16x16x32_bf16 v[44:47], a[88:91], v[232:235], v[44:47]
    v_exp_f32_e32 v222, v222
    v_mfma_f32_16x16x32_bf16 v[48:51], a[96:99], v[232:235], v[48:51]
    v_exp_f32_e32 v223, v223
    v_mfma_f32_16x16x32_bf16 v[48:51], a[100:103], v[236:239], v[48:51]
    s_waitcnt lgkmcnt(0)
    v_cmp_gt_u32_e32 vcc, s44, v244
    v_cvt_pk_bf16_f32 v228, v216, v217
    v_mfma_f32_16x16x32_bf16 v[52:55], a[108:111], v[236:239], v[52:55]
    v_cvt_pk_bf16_f32 v229, v218, v219
    v_cvt_pk_bf16_f32 v230, v220, v221
    v_mfma_f32_16x16x32_bf16 v[52:55], a[104:107], v[232:235], v[52:55]
    s_cbranch_vccnz L_rt9
L_bk9:
    ds_read_b64_tr_b16 a[224:225], v253 offset:49536
    v_cvt_pk_bf16_f32 v231, v222, v223
    v_mfma_f32_16x16x32_bf16 v[56:59], a[112:115], v[232:235], v[56:59]
    buffer_load_dwordx4 v254, s[8:11], s20 offen offset:3072 nt lds
    v_mfma_f32_16x16x32_bf16 v[56:59], a[116:119], v[236:239], v[56:59]
    ds_read_b64_tr_b16 a[226:227], v253 offset:53664
    v_mfma_f32_16x16x32_bf16 v[60:63], a[124:127], v[236:239], v[60:63]
    s_mov_b32 m0, s72
    ds_read_b64_tr_b16 a[228:229], v253 offset:57792
    v_mfma_f32_16x16x32_bf16 v[60:63], a[120:123], v[232:235], v[60:63]
    ds_read_b64_tr_b16 a[230:231], v253 offset:61920
    v_mfma_f32_16x16x32_bf16 v[208:211], a[0:3], v[176:179], v[204:207]
    buffer_load_dwordx4 v254, s[4:7], s21 offen offset:2048 nt lds
    v_mfma_f32_16x16x32_bf16 v[208:211], a[4:7], v[180:183], v[208:211]
    ds_read_b128 a[0:3], v252 offset:50688
    v_mfma_f32_16x16x32_bf16 v[208:211], a[8:11], v[184:187], v[208:211]
    ds_read_b128 a[4:7], v252 offset:50944
    v_mfma_f32_16x16x32_bf16 v[208:211], a[12:15], v[188:191], v[208:211]
    ds_read_b128 a[8:11], v252 offset:51200
    v_mfma_f32_16x16x32_bf16 v[212:215], a[28:31], v[188:191], v[204:207]
    ds_read_b128 a[12:15], v252 offset:51456
    v_mfma_f32_16x16x32_bf16 v[212:215], a[24:27], v[184:187], v[212:215]
    v_exp_f32_e32 v208, v208
    v_mfma_f32_16x16x32_bf16 v[212:215], a[20:23], v[180:183], v[212:215]
    s_mov_b32 m0, s78
    v_exp_f32_e32 v209, v209
    v_mfma_f32_16x16x32_bf16 v[212:215], a[16:19], v[176:179], v[212:215]
    v_exp_f32_e32 v210, v210
    v_mfma_f32_16x16x32_bf16 v[216:219], a[32:35], v[176:179], v[204:207]
    v_exp_f32_e32 v211, v211
    v_mfma_f32_16x16x32_bf16 v[216:219], a[36:39], v[180:183], v[216:219]
    ds_read_b128 a[28:31], v252 offset:55680
    v_cvt_pk_bf16_f32 v232, v208, v209
    v_mfma_f32_16x16x32_bf16 v[216:219], a[40:43], v[184:187], v[216:219]
    ds_read_b128 a[24:27], v252 offset:55424
    v_cvt_pk_bf16_f32 v233, v210, v211
    v_mfma_f32_16x16x32_bf16 v[216:219], a[44:47], v[188:191], v[216:219]
    buffer_load_dwordx4 v254, s[12:15], s20 offen nt lds
    v_mfma_f32_16x16x32_bf16 v[220:223], a[60:63], v[188:191], v[204:207]
    v_exp_f32_e32 v212, v212
    v_mfma_f32_16x16x32_bf16 v[220:223], a[56:59], v[184:187], v[220:223]
    v_exp_f32_e32 v213, v213
    v_mfma_f32_16x16x32_bf16 v[220:223], a[52:55], v[180:183], v[220:223]
    ds_read_b128 a[20:23], v252 offset:55168
    v_cvt_pk_bf16_f32 v234, v212, v213
    v_mfma_f32_16x16x32_bf16 v[220:223], a[48:51], v[176:179], v[220:223]
    v_exp_f32_e32 v214, v214
    v_smfmac_f32_16x16x64_bf16 a[200:203], a[208:211], v[224:231], v245
    ds_read_b128 a[16:19], v252 offset:54912
    v_mfma_f32_16x16x32_bf16 v[64:67], a[64:67], v[224:227], v[64:67]
    v_exp_f32_e32 v215, v215
    v_mfma_f32_16x16x32_bf16 v[64:67], a[68:71], v[228:231], v[64:67]
    ds_read_b128 a[32:35], v252 offset:59136
    v_cvt_pk_bf16_f32 v235, v214, v215
    v_mfma_f32_16x16x32_bf16 v[68:71], a[76:79], v[228:231], v[68:71]
    v_exp_f32_e32 v216, v216
    v_mfma_f32_16x16x32_bf16 v[68:71], a[72:75], v[224:227], v[68:71]
    v_exp_f32_e32 v217, v217
    v_mfma_f32_16x16x32_bf16 v[72:75], a[80:83], v[224:227], v[72:75]
    ds_read_b128 a[36:39], v252 offset:59392
    v_cvt_pk_bf16_f32 v236, v216, v217
    v_mfma_f32_16x16x32_bf16 v[72:75], a[84:87], v[228:231], v[72:75]
    s_mov_b32 m0, s73
    v_exp_f32_e32 v218, v218
    v_mfma_f32_16x16x32_bf16 v[76:79], a[92:95], v[228:231], v[76:79]
    v_exp_f32_e32 v219, v219
    v_mfma_f32_16x16x32_bf16 v[76:79], a[88:91], v[224:227], v[76:79]
    ds_read_b128 a[40:43], v252 offset:59648
    v_cvt_pk_bf16_f32 v237, v218, v219
    v_mfma_f32_16x16x32_bf16 v[80:83], a[96:99], v[224:227], v[80:83]
    v_exp_f32_e32 v220, v220
    v_mfma_f32_16x16x32_bf16 v[80:83], a[100:103], v[228:231], v[80:83]
    v_exp_f32_e32 v221, v221
    v_mfma_f32_16x16x32_bf16 v[84:87], a[108:111], v[228:231], v[84:87]
    ds_read_b128 a[44:47], v252 offset:59904
    v_cvt_pk_bf16_f32 v238, v220, v221
    v_mfma_f32_16x16x32_bf16 v[84:87], a[104:107], v[224:227], v[84:87]
    v_exp_f32_e32 v222, v222
    v_mfma_f32_16x16x32_bf16 v[88:91], a[112:115], v[224:227], v[88:91]
    v_exp_f32_e32 v223, v223
    v_mfma_f32_16x16x32_bf16 v[88:91], a[116:119], v[228:231], v[88:91]
    ds_read_b128 a[60:63], v252 offset:64128
    v_cvt_pk_bf16_f32 v239, v222, v223
    v_mfma_f32_16x16x32_bf16 v[92:95], a[124:127], v[228:231], v[92:95]
    buffer_load_dwordx4 v254, s[4:7], s21 offen offset:3072 nt lds
    v_mfma_f32_16x16x32_bf16 v[92:95], a[120:123], v[224:227], v[92:95]
    s_waitcnt lgkmcnt(4)
    ds_read_b128 a[56:59], v252 offset:63872
    v_mfma_f32_16x16x32_bf16 v[208:211], a[0:3], v[128:131], v[192:195]
    s_mov_b32 m0, s79
    ds_read_b128 a[52:55], v252 offset:63616
    v_mfma_f32_16x16x32_bf16 v[208:211], a[4:7], v[132:135], v[208:211]
    s_xor_b32 s21, s21, 49152
    buffer_load_dwordx4 v254, s[12:15], s20 offen offset:1024 nt lds
    v_mfma_f32_16x16x32_bf16 v[208:211], a[8:11], v[136:139], v[208:211]
    ds_read_b128 a[48:51], v252 offset:63360
    v_mfma_f32_16x16x32_bf16 v[208:211], a[12:15], v[140:143], v[208:211]
    ds_read_b64_tr_b16 a[236:237], v253 offset:57800
    v_mfma_f32_16x16x32_bf16 v[212:215], a[28:31], v[140:143], v[192:195]
    ds_read_b64_tr_b16 a[238:239], v253 offset:61928
    v_mfma_f32_16x16x32_bf16 v[212:215], a[24:27], v[136:139], v[212:215]
    v_exp_f32_e32 v208, v208
    v_mfma_f32_16x16x32_bf16 v[212:215], a[20:23], v[132:135], v[212:215]
    s_mov_b32 m0, s80
    v_exp_f32_e32 v209, v209
    v_mfma_f32_16x16x32_bf16 v[212:215], a[16:19], v[128:131], v[212:215]
    v_exp_f32_e32 v210, v210
    v_mfma_f32_16x16x32_bf16 v[216:219], a[32:35], v[128:131], v[192:195]
    s_waitcnt lgkmcnt(6)
    v_exp_f32_e32 v211, v211
    v_mfma_f32_16x16x32_bf16 v[216:219], a[36:39], v[132:135], v[216:219]
    buffer_load_dwordx4 v254, s[12:15], s20 offen offset:2048 nt lds
    v_mfma_f32_16x16x32_bf16 v[216:219], a[40:43], v[136:139], v[216:219]
    v_exp_f32_e32 v212, v212
    v_mfma_f32_16x16x32_bf16 v[216:219], a[44:47], v[140:143], v[216:219]
    s_waitcnt lgkmcnt(5)
    v_exp_f32_e32 v213, v213
    v_mfma_f32_16x16x32_bf16 v[220:223], a[60:63], v[140:143], v[192:195]
    s_waitcnt lgkmcnt(4)
    v_exp_f32_e32 v214, v214
    v_mfma_f32_16x16x32_bf16 v[220:223], a[56:59], v[136:139], v[220:223]
    s_waitcnt lgkmcnt(3)
    v_exp_f32_e32 v215, v215
    v_mfma_f32_16x16x32_bf16 v[220:223], a[52:55], v[132:135], v[220:223]
    s_waitcnt lgkmcnt(2)
    ds_read_b64_tr_b16 a[232:233], v253 offset:49544
    v_cvt_pk_bf16_f32 v224, v208, v209
    v_mfma_f32_16x16x32_bf16 v[220:223], a[48:51], v[128:131], v[220:223]
    ds_read_b64_tr_b16 a[234:235], v253 offset:53672
    v_cvt_pk_bf16_f32 v225, v210, v211
    v_smfmac_f32_16x16x64_bf16 a[204:207], a[208:211], v[232:239], v245
    v_cvt_pk_bf16_f32 v226, v212, v213
    v_mfma_f32_16x16x32_bf16 v[96:99], a[64:67], v[232:235], v[96:99]
    v_exp_f32_e32 v216, v216
    v_mfma_f32_16x16x32_bf16 v[96:99], a[68:71], v[236:239], v[96:99]
    v_exp_f32_e32 v217, v217
    v_mfma_f32_16x16x32_bf16 v[100:103], a[76:79], v[236:239], v[100:103]
    v_exp_f32_e32 v218, v218
    v_mfma_f32_16x16x32_bf16 v[100:103], a[72:75], v[232:235], v[100:103]
    v_exp_f32_e32 v219, v219
    v_mfma_f32_16x16x32_bf16 v[104:107], a[80:83], v[232:235], v[104:107]
    ds_read_b64_tr_b16 a[240:241], v253 offset:49792
    v_cvt_pk_bf16_f32 v227, v214, v215
    v_mfma_f32_16x16x32_bf16 v[104:107], a[84:87], v[236:239], v[104:107]
    s_mov_b32 m0, s81
    v_exp_f32_e32 v220, v220
    v_mfma_f32_16x16x32_bf16 v[108:111], a[92:95], v[236:239], v[108:111]
    v_exp_f32_e32 v221, v221
    v_mfma_f32_16x16x32_bf16 v[108:111], a[88:91], v[232:235], v[108:111]
    v_exp_f32_e32 v222, v222
    v_mfma_f32_16x16x32_bf16 v[112:115], a[96:99], v[232:235], v[112:115]
    v_exp_f32_e32 v223, v223
    v_mfma_f32_16x16x32_bf16 v[112:115], a[100:103], v[236:239], v[112:115]
    ds_read_b64_tr_b16 a[242:243], v253 offset:53920
    v_cvt_pk_bf16_f32 v228, v216, v217
    v_mfma_f32_16x16x32_bf16 v[116:119], a[108:111], v[236:239], v[116:119]
    ds_read_b64_tr_b16 a[244:245], v253 offset:58048
    v_cvt_pk_bf16_f32 v229, v218, v219
    v_mfma_f32_16x16x32_bf16 v[116:119], a[104:107], v[232:235], v[116:119]
    ds_read_b64_tr_b16 a[246:247], v253 offset:62176
    v_cvt_pk_bf16_f32 v230, v220, v221
    v_mfma_f32_16x16x32_bf16 v[120:123], a[112:115], v[232:235], v[120:123]
    ds_read_b64_tr_b16 a[252:253], v253 offset:58056
    v_cvt_pk_bf16_f32 v231, v222, v223
    v_mfma_f32_16x16x32_bf16 v[120:123], a[116:119], v[236:239], v[120:123]
    buffer_load_dwordx4 v254, s[12:15], s20 offen offset:3072 nt lds
    v_mfma_f32_16x16x32_bf16 v[124:127], a[124:127], v[236:239], v[124:127]
    s_xor_b32 s20, s20, 49152
    ds_read_b64_tr_b16 a[254:255], v253 offset:62184
    v_mfma_f32_16x16x32_bf16 v[124:127], a[120:123], v[232:235], v[124:127]
    ds_read_b64_tr_b16 a[248:249], v253 offset:49800
    v_mfma_f32_16x16x32_bf16 v[208:211], a[0:3], v[144:147], v[196:199]
    s_add_u32 s44, s44, 1
    ds_read_b64_tr_b16 a[250:251], v253 offset:53928
    v_mfma_f32_16x16x32_bf16 v[208:211], a[4:7], v[148:151], v[208:211]
    ds_read_b64_tr_b16 a[96:97], v253 offset:50048
    v_mfma_f32_16x16x32_bf16 v[208:211], a[8:11], v[152:155], v[208:211]
    ds_read_b64_tr_b16 a[98:99], v253 offset:54176
    v_mfma_f32_16x16x32_bf16 v[208:211], a[12:15], v[156:159], v[208:211]
    ds_read_b64_tr_b16 a[100:101], v253 offset:58304
    v_mfma_f32_16x16x32_bf16 v[212:215], a[28:31], v[156:159], v[196:199]
    ds_read_b64_tr_b16 a[102:103], v253 offset:62432
    v_mfma_f32_16x16x32_bf16 v[212:215], a[24:27], v[152:155], v[212:215]
    v_exp_f32_e32 v208, v208
    v_mfma_f32_16x16x32_bf16 v[212:215], a[20:23], v[148:151], v[212:215]
    s_mov_b32 m0, s82
    v_exp_f32_e32 v209, v209
    v_mfma_f32_16x16x32_bf16 v[212:215], a[16:19], v[144:147], v[212:215]
    ds_read_b64_tr_b16 a[108:109], v253 offset:58312
    v_cvt_pk_bf16_f32 v232, v208, v209
    v_mfma_f32_16x16x32_bf16 v[216:219], a[32:35], v[144:147], v[196:199]
    ds_read_b64_tr_b16 a[110:111], v253 offset:62440
    v_mov_b32_e32 v244, s44
    v_mfma_f32_16x16x32_bf16 v[216:219], a[36:39], v[148:151], v[216:219]
    buffer_store_dwordx4 a[168:171], v255, s[16:19], s22 offen offset:2048 sc0 sc1 nt
    v_mfma_f32_16x16x32_bf16 v[216:219], a[40:43], v[152:155], v[216:219]
    buffer_load_dwordx4 v254, s[8:11], s20 offen nt lds
    v_mfma_f32_16x16x32_bf16 v[216:219], a[44:47], v[156:159], v[216:219]
    v_exp_f32_e32 v210, v210
    v_mfma_f32_16x16x32_bf16 v[220:223], a[60:63], v[156:159], v[196:199]
    v_exp_f32_e32 v211, v211
    v_mfma_f32_16x16x32_bf16 v[220:223], a[56:59], v[152:155], v[220:223]
    s_waitcnt vmcnt(14)
    ds_read_b64_tr_b16 a[104:105], v253 offset:50056
    v_cvt_pk_bf16_f32 v233, v210, v211
    v_mfma_f32_16x16x32_bf16 v[220:223], a[52:55], v[148:151], v[220:223]
    s_mov_b32 m0, s45
    v_exp_f32_e32 v212, v212
    v_mfma_f32_16x16x32_bf16 v[220:223], a[48:51], v[144:147], v[220:223]
    ds_read_b64_tr_b16 a[106:107], v253 offset:54184
    ds_read_b64_tr_b16 a[112:113], v253 offset:50304
    v_smfmac_f32_16x16x64_bf16 a[192:195], a[208:211], v[224:231], v245
    ds_read_b64_tr_b16 a[114:115], v253 offset:54432
    v_mfma_f32_16x16x32_bf16 v[0:3], a[224:227], v[224:227], v[0:3]
    ds_read_b64_tr_b16 a[116:117], v253 offset:58560
    ds_read_b64_tr_b16 a[118:119], v253 offset:62688
    v_mfma_f32_16x16x32_bf16 v[0:3], a[228:231], v[228:231], v[0:3]
    s_waitcnt lgkmcnt(7)
    ds_read_b64_tr_b16 a[124:125], v253 offset:58568
    ds_read_b64_tr_b16 a[126:127], v253 offset:62696
    v_mfma_f32_16x16x32_bf16 v[4:7], a[236:239], v[228:231], v[4:7]
    ds_write_addtid_b32 v244
    ds_read_b64_tr_b16 a[120:121], v253 offset:50312
    v_mfma_f32_16x16x32_bf16 v[4:7], a[232:235], v[224:227], v[4:7]
    ds_read_b64_tr_b16 a[122:123], v253 offset:54440
    v_mfma_f32_16x16x32_bf16 v[8:11], a[240:243], v[224:227], v[8:11]
    v_exp_f32_e32 v213, v213
    v_mfma_f32_16x16x32_bf16 v[8:11], a[244:247], v[228:231], v[8:11]
    v_exp_f32_e32 v214, v214
    v_mfma_f32_16x16x32_bf16 v[12:15], a[252:255], v[228:231], v[12:15]
    v_exp_f32_e32 v215, v215
    v_mfma_f32_16x16x32_bf16 v[12:15], a[248:251], v[224:227], v[12:15]
    v_exp_f32_e32 v216, v216
    v_mfma_f32_16x16x32_bf16 v[16:19], a[96:99], v[224:227], v[16:19]
    v_exp_f32_e32 v217, v217
    v_mfma_f32_16x16x32_bf16 v[16:19], a[100:103], v[228:231], v[16:19]
    s_waitcnt lgkmcnt(10)
    v_exp_f32_e32 v218, v218
    v_mfma_f32_16x16x32_bf16 v[20:23], a[108:111], v[228:231], v[20:23]
    s_waitcnt lgkmcnt(8)
    v_exp_f32_e32 v219, v219
    v_mfma_f32_16x16x32_bf16 v[20:23], a[104:107], v[224:227], v[20:23]
    s_waitcnt lgkmcnt(7)
    v_cvt_pk_bf16_f32 v234, v212, v213
    v_cvt_pk_bf16_f32 v235, v214, v215
    v_mfma_f32_16x16x32_bf16 v[24:27], a[112:115], v[224:227], v[24:27]
    s_waitcnt lgkmcnt(5)
    v_exp_f32_e32 v220, v220
    v_mfma_f32_16x16x32_bf16 v[24:27], a[116:119], v[228:231], v[24:27]
    s_waitcnt lgkmcnt(3)
    v_exp_f32_e32 v221, v221
    v_mfma_f32_16x16x32_bf16 v[28:31], a[124:127], v[228:231], v[28:31]
    s_waitcnt lgkmcnt(0)
    v_exp_f32_e32 v222, v222
    v_mfma_f32_16x16x32_bf16 v[28:31], a[120:123], v[224:227], v[28:31]
    s_mov_b32 m0, s83
    v_exp_f32_e32 v223, v223
    v_mfma_f32_16x16x32_bf16 v[208:211], a[0:3], v[160:163], v[200:203]
    v_cvt_pk_bf16_f32 v236, v216, v217
    v_cvt_pk_bf16_f32 v237, v218, v219
    v_mfma_f32_16x16x32_bf16 v[208:211], a[4:7], v[164:167], v[208:211]
    v_cvt_pk_bf16_f32 v238, v220, v221
    v_cvt_pk_bf16_f32 v239, v222, v223
    v_mfma_f32_16x16x32_bf16 v[208:211], a[8:11], v[168:171], v[208:211]
    buffer_load_dwordx4 v254, s[8:11], s20 offen offset:1024 nt lds
    v_mfma_f32_16x16x32_bf16 v[208:211], a[12:15], v[172:175], v[208:211]
    v_mfma_f32_16x16x32_bf16 v[212:215], a[28:31], v[172:175], v[200:203]
    v_mfma_f32_16x16x32_bf16 v[212:215], a[24:27], v[168:171], v[212:215]
    v_exp_f32_e32 v208, v208
    v_mfma_f32_16x16x32_bf16 v[212:215], a[20:23], v[164:167], v[212:215]
    s_mov_b32 m0, s84
    v_exp_f32_e32 v209, v209
    v_mfma_f32_16x16x32_bf16 v[212:215], a[16:19], v[160:163], v[212:215]
    v_exp_f32_e32 v210, v210
    v_mfma_f32_16x16x32_bf16 v[216:219], a[32:35], v[160:163], v[200:203]
    v_exp_f32_e32 v211, v211
    v_mfma_f32_16x16x32_bf16 v[216:219], a[36:39], v[164:167], v[216:219]
    buffer_load_dwordx4 v254, s[8:11], s20 offen offset:2048 nt lds
    v_mfma_f32_16x16x32_bf16 v[216:219], a[40:43], v[168:171], v[216:219]
    v_exp_f32_e32 v212, v212
    v_mfma_f32_16x16x32_bf16 v[216:219], a[44:47], v[172:175], v[216:219]
    v_exp_f32_e32 v213, v213
    v_mfma_f32_16x16x32_bf16 v[220:223], a[60:63], v[172:175], v[200:203]
    v_exp_f32_e32 v214, v214
    v_mfma_f32_16x16x32_bf16 v[220:223], a[56:59], v[168:171], v[220:223]
    v_exp_f32_e32 v215, v215
    v_mfma_f32_16x16x32_bf16 v[220:223], a[52:55], v[164:167], v[220:223]
    v_cvt_pk_bf16_f32 v224, v208, v209
    v_cvt_pk_bf16_f32 v225, v210, v211
    v_mfma_f32_16x16x32_bf16 v[220:223], a[48:51], v[160:163], v[220:223]
    v_exp_f32_e32 v216, v216
    v_smfmac_f32_16x16x64_bf16 a[196:199], a[208:211], v[232:239], v245
    v_cvt_pk_bf16_f32 v226, v212, v213
    v_mfma_f32_16x16x32_bf16 v[32:35], a[224:227], v[232:235], v[32:35]
    v_exp_f32_e32 v217, v217
    v_mfma_f32_16x16x32_bf16 v[32:35], a[228:231], v[236:239], v[32:35]
    ds_read_b32 v244, v255
    v_cvt_pk_bf16_f32 v227, v214, v215
    v_mfma_f32_16x16x32_bf16 v[36:39], a[236:239], v[236:239], v[36:39]
    v_exp_f32_e32 v218, v218
    v_mfma_f32_16x16x32_bf16 v[36:39], a[232:235], v[232:235], v[36:39]
    v_exp_f32_e32 v219, v219
    v_mfma_f32_16x16x32_bf16 v[40:43], a[240:243], v[232:235], v[40:43]
    v_exp_f32_e32 v220, v220
    v_mfma_f32_16x16x32_bf16 v[40:43], a[244:247], v[236:239], v[40:43]
    s_mov_b32 m0, s85
    v_exp_f32_e32 v221, v221
    v_mfma_f32_16x16x32_bf16 v[44:47], a[252:255], v[236:239], v[44:47]
    v_exp_f32_e32 v222, v222
    v_mfma_f32_16x16x32_bf16 v[44:47], a[248:251], v[232:235], v[44:47]
    buffer_store_dwordx4 a[172:175], v255, s[16:19], s22 offen offset:3072 sc0 sc1 nt
    v_mfma_f32_16x16x32_bf16 v[48:51], a[96:99], v[232:235], v[48:51]
    s_waitcnt lgkmcnt(0)
    v_cmp_gt_u32_e32 vcc, s44, v244
    v_cvt_pk_bf16_f32 v228, v216, v217
    v_mfma_f32_16x16x32_bf16 v[48:51], a[100:103], v[236:239], v[48:51]
    s_xor_b32 s22, s22, 16384
    v_exp_f32_e32 v223, v223
    v_mfma_f32_16x16x32_bf16 v[52:55], a[108:111], v[236:239], v[52:55]
    s_cbranch_vccnz L_rt10
L_bk10:
    ds_read_b64_tr_b16 a[64:65], v253 offset:0
    v_cvt_pk_bf16_f32 v229, v218, v219
    v_mfma_f32_16x16x32_bf16 v[52:55], a[104:107], v[232:235], v[52:55]
    ds_read_b64_tr_b16 a[66:67], v253 offset:4128
    v_cvt_pk_bf16_f32 v230, v220, v221
    v_mfma_f32_16x16x32_bf16 v[56:59], a[112:115], v[232:235], v[56:59]
    ds_read_b64_tr_b16 a[68:69], v253 offset:8256
    v_cvt_pk_bf16_f32 v231, v222, v223
    v_mfma_f32_16x16x32_bf16 v[56:59], a[116:119], v[236:239], v[56:59]
    buffer_load_dwordx4 v254, s[8:11], s20 offen offset:3072 nt lds
    v_mfma_f32_16x16x32_bf16 v[60:63], a[124:127], v[236:239], v[60:63]
    ds_read_b64_tr_b16 a[70:71], v253 offset:12384
    v_mfma_f32_16x16x32_bf16 v[60:63], a[120:123], v[232:235], v[60:63]
    ds_read_b64_tr_b16 a[76:77], v253 offset:8264
    v_mfma_f32_16x16x32_bf16 v[208:211], a[0:3], v[176:179], v[204:207]
    ds_read_b128 a[0:3], v252 offset:0
    v_mfma_f32_16x16x32_bf16 v[208:211], a[4:7], v[180:183], v[208:211]
    ds_read_b128 a[4:7], v252 offset:256
    v_mfma_f32_16x16x32_bf16 v[208:211], a[8:11], v[184:187], v[208:211]
    ds_read_b128 a[8:11], v252 offset:512
    v_mfma_f32_16x16x32_bf16 v[208:211], a[12:15], v[188:191], v[208:211]
    ds_read_b128 a[12:15], v252 offset:768
    v_mfma_f32_16x16x32_bf16 v[212:215], a[28:31], v[188:191], v[204:207]
    ds_read_b128 a[28:31], v252 offset:4992
    v_mfma_f32_16x16x32_bf16 v[212:215], a[24:27], v[184:187], v[212:215]
    v_exp_f32_e32 v208, v208
    v_mfma_f32_16x16x32_bf16 v[212:215], a[20:23], v[180:183], v[212:215]
    s_mov_b32 m0, s86
    v_exp_f32_e32 v209, v209
    v_mfma_f32_16x16x32_bf16 v[212:215], a[16:19], v[176:179], v[212:215]
    v_exp_f32_e32 v210, v210
    v_mfma_f32_16x16x32_bf16 v[216:219], a[32:35], v[176:179], v[204:207]
    v_exp_f32_e32 v211, v211
    v_mfma_f32_16x16x32_bf16 v[216:219], a[36:39], v[180:183], v[216:219]
    ds_read_b128 a[24:27], v252 offset:4736
    v_cvt_pk_bf16_f32 v232, v208, v209
    v_mfma_f32_16x16x32_bf16 v[216:219], a[40:43], v[184:187], v[216:219]
    ds_read_b128 a[20:23], v252 offset:4480
    v_cvt_pk_bf16_f32 v233, v210, v211
    v_mfma_f32_16x16x32_bf16 v[216:219], a[44:47], v[188:191], v[216:219]
    buffer_load_dwordx4 v254, s[12:15], s20 offen nt lds
    v_mfma_f32_16x16x32_bf16 v[220:223], a[60:63], v[188:191], v[204:207]
    v_exp_f32_e32 v212, v212
    v_mfma_f32_16x16x32_bf16 v[220:223], a[56:59], v[184:187], v[220:223]
    v_exp_f32_e32 v213, v213
    v_mfma_f32_16x16x32_bf16 v[220:223], a[52:55], v[180:183], v[220:223]
    v_exp_f32_e32 v214, v214
    v_mfma_f32_16x16x32_bf16 v[220:223], a[48:51], v[176:179], v[220:223]
    v_exp_f32_e32 v215, v215
    v_smfmac_f32_16x16x64_bf16 a[200:203], a[208:211], v[224:231], v245
    ds_read_b128 a[16:19], v252 offset:4224
    v_mfma_f32_16x16x32_bf16 v[64:67], a[224:227], v[224:227], v[64:67]
    ds_read_b128 a[32:35], v252 offset:8448
    v_cvt_pk_bf16_f32 v234, v212, v213
    v_mfma_f32_16x16x32_bf16 v[64:67], a[228:231], v[228:231], v[64:67]
    ds_read_b128 a[36:39], v252 offset:8704
    v_cvt_pk_bf16_f32 v235, v214, v215
    v_mfma_f32_16x16x32_bf16 v[68:71], a[236:239], v[228:231], v[68:71]
    v_exp_f32_e32 v216, v216
    v_mfma_f32_16x16x32_bf16 v[68:71], a[232:235], v[224:227], v[68:71]
    v_exp_f32_e32 v217, v217
    v_mfma_f32_16x16x32_bf16 v[72:75], a[240:243], v[224:227], v[72:75]
    ds_read_b128 a[40:43], v252 offset:8960
    v_cvt_pk_bf16_f32 v236, v216, v217
    v_mfma_f32_16x16x32_bf16 v[72:75], a[244:247], v[228:231], v[72:75]
    s_mov_b32 m0, s87
    v_exp_f32_e32 v218, v218
    v_mfma_f32_16x16x32_bf16 v[76:79], a[252:255], v[228:231], v[76:79]
    v_exp_f32_e32 v219, v219
    v_mfma_f32_16x16x32_bf16 v[76:79], a[248:251], v[224:227], v[76:79]
    s_waitcnt vmcnt(10)
    ds_read_b128 a[44:47], v252 offset:9216
    v_cvt_pk_bf16_f32 v237, v218, v219
    v_mfma_f32_16x16x32_bf16 v[80:83], a[96:99], v[224:227], v[80:83]
    v_exp_f32_e32 v220, v220
    v_mfma_f32_16x16x32_bf16 v[80:83], a[100:103], v[228:231], v[80:83]
    v_exp_f32_e32 v221, v221
    v_mfma_f32_16x16x32_bf16 v[84:87], a[108:111], v[228:231], v[84:87]
    ds_read_b128 a[60:63], v252 offset:13440
    v_cvt_pk_bf16_f32 v238, v220, v221
    v_mfma_f32_16x16x32_bf16 v[84:87], a[104:107], v[224:227], v[84:87]
    v_exp_f32_e32 v222, v222
    v_mfma_f32_16x16x32_bf16 v[88:91], a[112:115], v[224:227], v[88:91]
    v_exp_f32_e32 v223, v223
    v_mfma_f32_16x16x32_bf16 v[88:91], a[116:119], v[228:231], v[88:91]
    ds_read_b128 a[56:59], v252 offset:13184
    v_cvt_pk_bf16_f32 v239, v222, v223
    v_mfma_f32_16x16x32_bf16 v[92:95], a[124:127], v[228:231], v[92:95]
    buffer_load_dwordx4 v254, s[12:15], s20 offen offset:1024 nt lds
    v_mfma_f32_16x16x32_bf16 v[92:95], a[120:123], v[224:227], v[92:95]
    s_waitcnt lgkmcnt(4)
    ds_read_b128 a[52:55], v252 offset:12928
    v_mfma_f32_16x16x32_bf16 v[208:211], a[0:3], v[128:131], v[192:195]
    s_mov_b32 m0, s27
    ds_read_b128 a[48:51], v252 offset:12672
    v_mfma_f32_16x16x32_bf16 v[208:211], a[4:7], v[132:135], v[208:211]
    ds_read_b128 a[144:147], v246 offset:0
    v_mfma_f32_16x16x32_bf16 v[208:211], a[8:11], v[136:139], v[208:211]
    ds_read_b128 a[148:151], v246 offset:256
    v_mfma_f32_16x16x32_bf16 v[208:211], a[12:15], v[140:143], v[208:211]
    ds_read_b128 a[152:155], v246 offset:512
    v_mfma_f32_16x16x32_bf16 v[212:215], a[28:31], v[140:143], v[192:195]
    ds_read_b128 a[156:159], v246 offset:768
    v_mfma_f32_16x16x32_bf16 v[212:215], a[24:27], v[136:139], v[212:215]
    v_exp_f32_e32 v208, v208
    v_mfma_f32_16x16x32_bf16 v[212:215], a[20:23], v[132:135], v[212:215]
    v_exp_f32_e32 v209, v209
    v_mfma_f32_16x16x32_bf16 v[212:215], a[16:19], v[128:131], v[212:215]
    v_exp_f32_e32 v210, v210
    v_mfma_f32_16x16x32_bf16 v[216:219], a[32:35], v[128:131], v[192:195]
    v_exp_f32_e32 v211, v211
    v_mfma_f32_16x16x32_bf16 v[216:219], a[36:39], v[132:135], v[216:219]
    s_waitcnt lgkmcnt(7)
    v_exp_f32_e32 v212, v212
    v_mfma_f32_16x16x32_bf16 v[216:219], a[40:43], v[136:139], v[216:219]
    v_exp_f32_e32 v213, v213
    v_mfma_f32_16x16x32_bf16 v[216:219], a[44:47], v[140:143], v[216:219]
    v_exp_f32_e32 v214, v214
    v_mfma_f32_16x16x32_bf16 v[220:223], a[60:63], v[140:143], v[192:195]
    s_waitcnt lgkmcnt(5)
    s_waitcnt lgkmcnt(0)
    buffer_load_dwordx4 v254, s[4:7], s21 offen nt lds
    v_mfma_f32_16x16x32_bf16 v[220:223], a[56:59], v[136:139], v[220:223]
    s_mov_b32 m0, s88
    v_exp_f32_e32 v215, v215
    v_mfma_f32_16x16x32_bf16 v[220:223], a[52:55], v[132:135], v[220:223]
    buffer_load_dwordx4 v254, s[12:15], s20 offen offset:2048 nt lds
    v_mfma_f32_16x16x32_bf16 v[220:223], a[48:51], v[128:131], v[220:223]
    ds_read_b64_tr_b16 a[78:79], v253 offset:12392
    v_cvt_pk_bf16_f32 v224, v208, v209
    v_smfmac_f32_16x16x64_bf16 a[204:207], a[208:211], v[232:239], v245
    v_cvt_pk_bf16_f32 v225, v210, v211
    v_mfma_f32_16x16x32_bf16 v[96:99], a[224:227], v[232:235], v[96:99]
    v_exp_f32_e32 v216, v216
    v_mfma_f32_16x16x32_bf16 v[96:99], a[228:231], v[236:239], v[96:99]
    v_exp_f32_e32 v217, v217
    v_mfma_f32_16x16x32_bf16 v[100:103], a[236:239], v[236:239], v[100:103]
    v_exp_f32_e32 v218, v218
    v_mfma_f32_16x16x32_bf16 v[100:103], a[232:235], v[232:235], v[100:103]
    v_exp_f32_e32 v219, v219
    v_mfma_f32_16x16x32_bf16 v[104:107], a[240:243], v[232:235], v[104:107]
    ds_read_b64_tr_b16 a[72:73], v253 offset:8
    v_cvt_pk_bf16_f32 v226, v212, v213
    v_mfma_f32_16x16x32_bf16 v[104:107], a[244:247], v[236:239], v[104:107]
    s_mov_b32 m0, s71
    ds_read_b64_tr_b16 a[74:75], v253 offset:4136
    v_cvt_pk_bf16_f32 v227, v214, v215
    v_mfma_f32_16x16x32_bf16 v[108:111], a[252:255], v[236:239], v[108:111]
    v_exp_f32_e32 v220, v220
    v_mfma_f32_16x16x32_bf16 v[108:111], a[248:251], v[232:235], v[108:111]
    v_exp_f32_e32 v221, v221
    v_mfma_f32_16x16x32_bf16 v[112:115], a[96:99], v[232:235], v[112:115]
    v_exp_f32_e32 v222, v222
    v_mfma_f32_16x16x32_bf16 v[112:115], a[100:103], v[236:239], v[112:115]
    v_exp_f32_e32 v223, v223
    v_mfma_f32_16x16x32_bf16 v[116:119], a[108:111], v[236:239], v[116:119]
    ds_read_b64_tr_b16 a[80:81], v253 offset:256
    v_cvt_pk_bf16_f32 v228, v216, v217
    v_mfma_f32_16x16x32_bf16 v[116:119], a[104:107], v[232:235], v[116:119]
    ds_read_b64_tr_b16 a[82:83], v253 offset:4384
    v_cvt_pk_bf16_f32 v229, v218, v219
    v_mfma_f32_16x16x32_bf16 v[120:123], a[112:115], v[232:235], v[120:123]
    buffer_load_dwordx4 v254, s[4:7], s21 offen offset:1024 nt lds
    v_mfma_f32_16x16x32_bf16 v[120:123], a[116:119], v[236:239], v[120:123]
    s_mov_b32 m0, s89
    ds_read_b64_tr_b16 a[84:85], v253 offset:8512
    v_cvt_pk_bf16_f32 v230, v220, v221
    v_mfma_f32_16x16x32_bf16 v[124:127], a[124:127], v[236:239], v[124:127]
    ds_read_b64_tr_b16 a[86:87], v253 offset:12640
    v_cvt_pk_bf16_f32 v231, v222, v223
    v_mfma_f32_16x16x32_bf16 v[124:127], a[120:123], v[232:235], v[124:127]
    buffer_load_dwordx4 v254, s[12:15], s20 offen offset:3072 nt lds
    v_mfma_f32_16x16x32_bf16 v[208:211], a[0:3], v[144:147], v[196:199]
    s_xor_b32 s20, s20, 16384
    ds_read_b64_tr_b16 a[92:93], v253 offset:8520
    v_mfma_f32_16x16x32_bf16 v[208:211], a[4:7], v[148:151], v[208:211]
    s_add_u32 s44, s44, 1
    ds_read_b64_tr_b16 a[94:95], v253 offset:12648
    v_mfma_f32_16x16x32_bf16 v[208:211], a[8:11], v[152:155], v[208:211]
    ds_read_b64_tr_b16 a[88:89], v253 offset:264
    v_mfma_f32_16x16x32_bf16 v[208:211], a[12:15], v[156:159], v[208:211]
    ds_read_b64_tr_b16 a[90:91], v253 offset:4392
    v_mfma_f32_16x16x32_bf16 v[212:215], a[28:31], v[156:159], v[196:199]
    ds_read_b64_tr_b16 a[96:97], v253 offset:512
    v_mfma_f32_16x16x32_bf16 v[212:215], a[24:27], v[152:155], v[212:215]
    v_exp_f32_e32 v208, v208
    v_mfma_f32_16x16x32_bf16 v[212:215], a[20:23], v[148:151], v[212:215]
    s_mov_b32 m0, s67
    v_exp_f32_e32 v209, v209
    v_mfma_f32_16x16x32_bf16 v[212:215], a[16:19], v[144:147], v[212:215]
    ds_read_b64_tr_b16 a[98:99], v253 offset:4640
    v_cvt_pk_bf16_f32 v232, v208, v209
    v_mfma_f32_16x16x32_bf16 v[216:219], a[32:35], v[144:147], v[196:199]
    ds_read_b64_tr_b16 a[100:101], v253 offset:8768
    v_mov_b32_e32 v244, s44
    v_mfma_f32_16x16x32_bf16 v[216:219], a[36:39], v[148:151], v[216:219]
    buffer_load_dwordx4 v254, s[8:11], s20 offen nt lds
    v_mfma_f32_16x16x32_bf16 v[216:219], a[40:43], v[152:155], v[216:219]
    v_exp_f32_e32 v210, v210
    v_mfma_f32_16x16x32_bf16 v[216:219], a[44:47], v[156:159], v[216:219]
    v_exp_f32_e32 v211, v211
    v_mfma_f32_16x16x32_bf16 v[220:223], a[60:63], v[156:159], v[196:199]
    ds_read_b64_tr_b16 a[102:103], v253 offset:12896
    v_cvt_pk_bf16_f32 v233, v210, v211
    v_mfma_f32_16x16x32_bf16 v[220:223], a[56:59], v[152:155], v[220:223]
    s_waitcnt vmcnt(13)
    ds_read_b64_tr_b16 a[108:109], v253 offset:8776
    ds_read_b64_tr_b16 a[110:111], v253 offset:12904
    v_mfma_f32_16x16x32_bf16 v[220:223], a[52:55], v[148:151], v[220:223]
    s_mov_b32 m0, s45
    ds_read_b64_tr_b16 a[104:105], v253 offset:520
    ds_read_b64_tr_b16 a[106:107], v253 offset:4648
    v_mfma_f32_16x16x32_bf16 v[220:223], a[48:51], v[144:147], v[220:223]
    ds_read_b64_tr_b16 a[112:113], v253 offset:768
    ds_read_b64_tr_b16 a[114:115], v253 offset:4896
    v_smfmac_f32_16x16x64_bf16 a[192:195], a[208:211], v[224:231], v245
    ds_read_b64_tr_b16 a[116:117], v253 offset:9024
    v_mfma_f32_16x16x32_bf16 v[0:3], a[64:67], v[224:227], v[0:3]
    ds_read_b64_tr_b16 a[118:119], v253 offset:13152
    ds_read_b64_tr_b16 a[124:125], v253 offset:9032
    v_mfma_f32_16x16x32_bf16 v[0:3], a[68:71], v[228:231], v[0:3]
    s_waitcnt lgkmcnt(12)
    ds_read_b64_tr_b16 a[126:127], v253 offset:13160
    ds_write_addtid_b32 v244
    v_mfma_f32_16x16x32_bf16 v[4:7], a[76:79], v[228:231], v[4:7]
    ds_read_b64_tr_b16 a[120:121], v253 offset:776
    ds_read_b64_tr_b16 a[122:123], v253 offset:4904
    v_mfma_f32_16x16x32_bf16 v[4:7], a[72:75], v[224:227], v[4:7]
    v_exp_f32_e32 v212, v212
    v_mfma_f32_16x16x32_bf16 v[8:11], a[80:83], v[224:227], v[8:11]
    v_exp_f32_e32 v213, v213
    v_mfma_f32_16x16x32_bf16 v[8:11], a[84:87], v[228:231], v[8:11]
    v_exp_f32_e32 v214, v214
    v_mfma_f32_16x16x32_bf16 v[12:15], a[92:95], v[228:231], v[12:15]
    v_exp_f32_e32 v215, v215
    v_mfma_f32_16x16x32_bf16 v[12:15], a[88:91], v[224:227], v[12:15]
    s_waitcnt lgkmcnt(13)
    v_exp_f32_e32 v216, v216
    v_mfma_f32_16x16x32_bf16 v[16:19], a[96:99], v[224:227], v[16:19]
    v_exp_f32_e32 v217, v217
    v_mfma_f32_16x16x32_bf16 v[16:19], a[100:103], v[228:231], v[16:19]
    s_waitcnt lgkmcnt(9)
    v_exp_f32_e32 v218, v218
    v_mfma_f32_16x16x32_bf16 v[20:23], a[108:111], v[228:231], v[20:23]
    s_waitcnt lgkmcnt(2)
    v_exp_f32_e32 v219, v219
    v_mfma_f32_16x16x32_bf16 v[20:23], a[104:107], v[224:227], v[20:23]
    s_mov_b32 m0, s72
    v_cvt_pk_bf16_f32 v234, v212, v213
    v_cvt_pk_bf16_f32 v235, v214, v215
    v_mfma_f32_16x16x32_bf16 v[24:27], a[112:115], v[224:227], v[24:27]
    v_exp_f32_e32 v220, v220
    v_mfma_f32_16x16x32_bf16 v[24:27], a[116:119], v[228:231], v[24:27]
    v_exp_f32_e32 v221, v221
    v_mfma_f32_16x16x32_bf16 v[28:31], a[124:127], v[228:231], v[28:31]
    s_waitcnt lgkmcnt(0)
    v_exp_f32_e32 v222, v222
    v_mfma_f32_16x16x32_bf16 v[28:31], a[120:123], v[224:227], v[28:31]
    v_exp_f32_e32 v223, v223
    v_mfma_f32_16x16x32_bf16 v[208:211], a[0:3], v[160:163], v[200:203]
    v_cvt_pk_bf16_f32 v236, v216, v217
    v_cvt_pk_bf16_f32 v237, v218, v219
    v_mfma_f32_16x16x32_bf16 v[208:211], a[4:7], v[164:167], v[208:211]
    buffer_load_dwordx4 v254, s[4:7], s21 offen offset:2048 nt lds
    v_mfma_f32_16x16x32_bf16 v[208:211], a[8:11], v[168:171], v[208:211]
    s_mov_b32 m0, s68
    v_cvt_pk_bf16_f32 v238, v220, v221
    v_cvt_pk_bf16_f32 v239, v222, v223
    v_mfma_f32_16x16x32_bf16 v[208:211], a[12:15], v[172:175], v[208:211]
    buffer_load_dwordx4 v254, s[8:11], s20 offen offset:1024 nt lds
    v_mfma_f32_16x16x32_bf16 v[212:215], a[28:31], v[172:175], v[200:203]
    v_mfma_f32_16x16x32_bf16 v[212:215], a[24:27], v[168:171], v[212:215]
    v_exp_f32_e32 v208, v208
    v_mfma_f32_16x16x32_bf16 v[212:215], a[20:23], v[164:167], v[212:215]
    s_mov_b32 m0, s73
    v_exp_f32_e32 v209, v209
    v_mfma_f32_16x16x32_bf16 v[212:215], a[16:19], v[160:163], v[212:215]
    v_exp_f32_e32 v210, v210
    v_mfma_f32_16x16x32_bf16 v[216:219], a[32:35], v[160:163], v[200:203]
    v_exp_f32_e32 v211, v211
    v_mfma_f32_16x16x32_bf16 v[216:219], a[36:39], v[164:167], v[216:219]
    buffer_load_dwordx4 v254, s[4:7], s21 offen offset:3072 nt lds
    v_mfma_f32_16x16x32_bf16 v[216:219], a[40:43], v[168:171], v[216:219]
    s_mov_b32 m0, s69
    v_exp_f32_e32 v212, v212
    v_mfma_f32_16x16x32_bf16 v[216:219], a[44:47], v[172:175], v[216:219]
    s_xor_b32 s21, s21, 16384
    buffer_load_dwordx4 v254, s[8:11], s20 offen offset:2048 nt lds
    v_mfma_f32_16x16x32_bf16 v[220:223], a[60:63], v[172:175], v[200:203]
    v_exp_f32_e32 v213, v213
    v_mfma_f32_16x16x32_bf16 v[220:223], a[56:59], v[168:171], v[220:223]
    v_exp_f32_e32 v214, v214
    v_mfma_f32_16x16x32_bf16 v[220:223], a[52:55], v[164:167], v[220:223]
    v_exp_f32_e32 v215, v215
    v_mfma_f32_16x16x32_bf16 v[220:223], a[48:51], v[160:163], v[220:223]
    v_cvt_pk_bf16_f32 v224, v208, v209
    v_cvt_pk_bf16_f32 v225, v210, v211
    v_smfmac_f32_16x16x64_bf16 a[196:199], a[208:211], v[232:239], v245
    v_cvt_pk_bf16_f32 v226, v212, v213
    v_mfma_f32_16x16x32_bf16 v[32:35], a[64:67], v[232:235], v[32:35]
    v_exp_f32_e32 v216, v216
    v_mfma_f32_16x16x32_bf16 v[32:35], a[68:71], v[236:239], v[32:35]
    ds_read_b32 v244, v255
    v_cvt_pk_bf16_f32 v227, v214, v215
    v_mfma_f32_16x16x32_bf16 v[36:39], a[76:79], v[236:239], v[36:39]
    v_exp_f32_e32 v217, v217
    v_mfma_f32_16x16x32_bf16 v[36:39], a[72:75], v[232:235], v[36:39]
    v_exp_f32_e32 v218, v218
    v_mfma_f32_16x16x32_bf16 v[40:43], a[80:83], v[232:235], v[40:43]
    v_exp_f32_e32 v219, v219
    v_mfma_f32_16x16x32_bf16 v[40:43], a[84:87], v[236:239], v[40:43]
    s_mov_b32 m0, s70
    v_exp_f32_e32 v220, v220
    v_mfma_f32_16x16x32_bf16 v[44:47], a[92:95], v[236:239], v[44:47]
    v_exp_f32_e32 v221, v221
    v_mfma_f32_16x16x32_bf16 v[44:47], a[88:91], v[232:235], v[44:47]
    v_exp_f32_e32 v222, v222
    v_mfma_f32_16x16x32_bf16 v[48:51], a[96:99], v[232:235], v[48:51]
    v_exp_f32_e32 v223, v223
    v_mfma_f32_16x16x32_bf16 v[48:51], a[100:103], v[236:239], v[48:51]
    s_waitcnt lgkmcnt(0)
    v_cmp_gt_u32_e32 vcc, s44, v244
    v_cvt_pk_bf16_f32 v228, v216, v217
    v_mfma_f32_16x16x32_bf16 v[52:55], a[108:111], v[236:239], v[52:55]
    v_cvt_pk_bf16_f32 v229, v218, v219
    v_cvt_pk_bf16_f32 v230, v220, v221
    v_mfma_f32_16x16x32_bf16 v[52:55], a[104:107], v[232:235], v[52:55]
    s_cbranch_vccnz L_rt11
L_bk11:
    ds_read_b64_tr_b16 a[224:225], v253 offset:16512
    v_cvt_pk_bf16_f32 v231, v222, v223
    v_mfma_f32_16x16x32_bf16 v[56:59], a[112:115], v[232:235], v[56:59]
    buffer_load_dwordx4 v254, s[8:11], s20 offen offset:3072 nt lds
    v_mfma_f32_16x16x32_bf16 v[56:59], a[116:119], v[236:239], v[56:59]
    ds_read_b64_tr_b16 a[226:227], v253 offset:20640
    v_mfma_f32_16x16x32_bf16 v[60:63], a[124:127], v[236:239], v[60:63]
    ds_read_b64_tr_b16 a[228:229], v253 offset:24768
    v_mfma_f32_16x16x32_bf16 v[60:63], a[120:123], v[232:235], v[60:63]
    ds_read_b64_tr_b16 a[230:231], v253 offset:28896
    v_mfma_f32_16x16x32_bf16 v[208:211], a[0:3], v[176:179], v[204:207]
    ds_read_b128 a[0:3], v252 offset:16896
    v_mfma_f32_16x16x32_bf16 v[208:211], a[4:7], v[180:183], v[208:211]
    ds_read_b128 a[4:7], v252 offset:17152
    v_mfma_f32_16x16x32_bf16 v[208:211], a[8:11], v[184:187], v[208:211]
    ds_read_b128 a[8:11], v252 offset:17408
    v_mfma_f32_16x16x32_bf16 v[208:211], a[12:15], v[188:191], v[208:211]
    ds_read_b128 a[12:15], v252 offset:17664
    v_mfma_f32_16x16x32_bf16 v[212:215], a[28:31], v[188:191], v[204:207]
    ds_read_b128 a[28:31], v252 offset:21888
    v_mfma_f32_16x16x32_bf16 v[212:215], a[24:27], v[184:187], v[212:215]
    v_exp_f32_e32 v208, v208
    v_mfma_f32_16x16x32_bf16 v[212:215], a[20:23], v[180:183], v[212:215]
    s_mov_b32 m0, s90
    v_exp_f32_e32 v209, v209
    v_mfma_f32_16x16x32_bf16 v[212:215], a[16:19], v[176:179], v[212:215]
    v_exp_f32_e32 v210, v210
    v_mfma_f32_16x16x32_bf16 v[216:219], a[32:35], v[176:179], v[204:207]
    v_exp_f32_e32 v211, v211
    v_mfma_f32_16x16x32_bf16 v[216:219], a[36:39], v[180:183], v[216:219]
    ds_read_b128 a[24:27], v252 offset:21632
    v_cvt_pk_bf16_f32 v232, v208, v209
    v_mfma_f32_16x16x32_bf16 v[216:219], a[40:43], v[184:187], v[216:219]
    ds_read_b128 a[20:23], v252 offset:21376
    v_cvt_pk_bf16_f32 v233, v210, v211
    v_mfma_f32_16x16x32_bf16 v[216:219], a[44:47], v[188:191], v[216:219]
    buffer_load_dwordx4 v254, s[12:15], s20 offen nt lds
    v_mfma_f32_16x16x32_bf16 v[220:223], a[60:63], v[188:191], v[204:207]
    v_exp_f32_e32 v212, v212
    v_mfma_f32_16x16x32_bf16 v[220:223], a[56:59], v[184:187], v[220:223]
    v_exp_f32_e32 v213, v213
    v_mfma_f32_16x16x32_bf16 v[220:223], a[52:55], v[180:183], v[220:223]
    v_exp_f32_e32 v214, v214
    v_mfma_f32_16x16x32_bf16 v[220:223], a[48:51], v[176:179], v[220:223]
    v_exp_f32_e32 v215, v215
    v_smfmac_f32_16x16x64_bf16 a[200:203], a[208:211], v[224:231], v245
    ds_read_b128 a[16:19], v252 offset:21120
    v_mfma_f32_16x16x32_bf16 v[64:67], a[64:67], v[224:227], v[64:67]
    ds_read_b128 a[32:35], v252 offset:25344
    v_cvt_pk_bf16_f32 v234, v212, v213
    v_mfma_f32_16x16x32_bf16 v[64:67], a[68:71], v[228:231], v[64:67]
    ds_read_b128 a[36:39], v252 offset:25600
    v_cvt_pk_bf16_f32 v235, v214, v215
    v_mfma_f32_16x16x32_bf16 v[68:71], a[76:79], v[228:231], v[68:71]
    v_exp_f32_e32 v216, v216
    v_mfma_f32_16x16x32_bf16 v[68:71], a[72:75], v[224:227], v[68:71]
    v_exp_f32_e32 v217, v217
    v_mfma_f32_16x16x32_bf16 v[72:75], a[80:83], v[224:227], v[72:75]
    ds_read_b128 a[40:43], v252 offset:25856
    v_cvt_pk_bf16_f32 v236, v216, v217
    v_mfma_f32_16x16x32_bf16 v[72:75], a[84:87], v[228:231], v[72:75]
    s_mov_b32 m0, s91
    v_exp_f32_e32 v218, v218
    v_mfma_f32_16x16x32_bf16 v[76:79], a[92:95], v[228:231], v[76:79]
    v_exp_f32_e32 v219, v219
    v_mfma_f32_16x16x32_bf16 v[76:79], a[88:91], v[224:227], v[76:79]
    ds_read_b128 a[44:47], v252 offset:26112
    v_cvt_pk_bf16_f32 v237, v218, v219
    v_mfma_f32_16x16x32_bf16 v[80:83], a[96:99], v[224:227], v[80:83]
    buffer_store_dwordx4 a[176:179], v255, s[16:19], s22 offen sc0 sc1 nt
    v_mfma_f32_16x16x32_bf16 v[80:83], a[100:103], v[228:231], v[80:83]
    v_exp_f32_e32 v220, v220
    v_mfma_f32_16x16x32_bf16 v[84:87], a[108:111], v[228:231], v[84:87]
    v_exp_f32_e32 v221, v221
    v_mfma_f32_16x16x32_bf16 v[84:87], a[104:107], v[224:227], v[84:87]
    ds_read_b128 a[60:63], v252 offset:30336
    v_cvt_pk_bf16_f32 v238, v220, v221
    v_mfma_f32_16x16x32_bf16 v[88:91], a[112:115], v[224:227], v[88:91]
    v_exp_f32_e32 v222, v222
    v_mfma_f32_16x16x32_bf16 v[88:91], a[116:119], v[228:231], v[88:91]
    v_exp_f32_e32 v223, v223
    v_mfma_f32_16x16x32_bf16 v[92:95], a[124:127], v[228:231], v[92:95]
    ds_read_b128 a[56:59], v252 offset:30080
    v_cvt_pk_bf16_f32 v239, v222, v223
    v_mfma_f32_16x16x32_bf16 v[92:95], a[120:123], v[224:227], v[92:95]
    s_waitcnt lgkmcnt(4)
    buffer_load_dwordx4 v254, s[12:15], s20 offen offset:1024 nt lds
    v_mfma_f32_16x16x32_bf16 v[208:211], a[0:3], v[128:131], v[192:195]
    ds_read_b128 a[52:55], v252 offset:29824
    v_mfma_f32_16x16x32_bf16 v[208:211], a[4:7], v[132:135], v[208:211]
    ds_read_b128 a[48:51], v252 offset:29568
    v_mfma_f32_16x16x32_bf16 v[208:211], a[8:11], v[136:139], v[208:211]
    ds_read_b64_tr_b16 a[236:237], v253 offset:24776
    v_mfma_f32_16x16x32_bf16 v[208:211], a[12:15], v[140:143], v[208:211]
    ds_read_b64_tr_b16 a[238:239], v253 offset:28904
    v_mfma_f32_16x16x32_bf16 v[212:215], a[28:31], v[140:143], v[192:195]
    ds_read_b64_tr_b16 a[232:233], v253 offset:16520
    v_mfma_f32_16x16x32_bf16 v[212:215], a[24:27], v[136:139], v[212:215]
    v_exp_f32_e32 v208, v208
    v_mfma_f32_16x16x32_bf16 v[212:215], a[20:23], v[132:135], v[212:215]
    s_mov_b32 m0, s92
    v_exp_f32_e32 v209, v209
    v_mfma_f32_16x16x32_bf16 v[212:215], a[16:19], v[128:131], v[212:215]
    v_exp_f32_e32 v210, v210
    v_mfma_f32_16x16x32_bf16 v[216:219], a[32:35], v[128:131], v[192:195]
    v_exp_f32_e32 v211, v211
    v_mfma_f32_16x16x32_bf16 v[216:219], a[36:39], v[132:135], v[216:219]
    s_waitcnt lgkmcnt(6)
    buffer_load_dwordx4 v254, s[12:15], s20 offen offset:2048 nt lds
    v_mfma_f32_16x16x32_bf16 v[216:219], a[40:43], v[136:139], v[216:219]
    v_exp_f32_e32 v212, v212
    v_mfma_f32_16x16x32_bf16 v[216:219], a[44:47], v[140:143], v[216:219]
    v_exp_f32_e32 v213, v213
    v_mfma_f32_16x16x32_bf16 v[220:223], a[60:63], v[140:143], v[192:195]
    s_waitcnt lgkmcnt(5)
    v_exp_f32_e32 v214, v214
    v_mfma_f32_16x16x32_bf16 v[220:223], a[56:59], v[136:139], v[220:223]
    s_waitcnt lgkmcnt(4)
    v_exp_f32_e32 v215, v215
    v_mfma_f32_16x16x32_bf16 v[220:223], a[52:55], v[132:135], v[220:223]
    s_waitcnt lgkmcnt(3)
    ds_read_b64_tr_b16 a[234:235], v253 offset:20648
    v_cvt_pk_bf16_f32 v224, v208, v209
    v_mfma_f32_16x16x32_bf16 v[220:223], a[48:51], v[128:131], v[220:223]
    ds_read_b64_tr_b16 a[240:241], v253 offset:16768
    v_cvt_pk_bf16_f32 v225, v210, v211
    v_smfmac_f32_16x16x64_bf16 a[204:207], a[208:211], v[232:239], v245
    v_cvt_pk_bf16_f32 v226, v212, v213
    v_mfma_f32_16x16x32_bf16 v[96:99], a[64:67], v[232:235], v[96:99]
    v_exp_f32_e32 v216, v216
    v_mfma_f32_16x16x32_bf16 v[96:99], a[68:71], v[236:239], v[96:99]
    v_exp_f32_e32 v217, v217
    v_mfma_f32_16x16x32_bf16 v[100:103], a[76:79], v[236:239], v[100:103]
    v_exp_f32_e32 v218, v218
    v_mfma_f32_16x16x32_bf16 v[100:103], a[72:75], v[232:235], v[100:103]
    v_exp_f32_e32 v219, v219
    v_mfma_f32_16x16x32_bf16 v[104:107], a[80:83], v[232:235], v[104:107]
    ds_read_b64_tr_b16 a[242:243], v253 offset:20896
    v_cvt_pk_bf16_f32 v227, v214, v215
    v_mfma_f32_16x16x32_bf16 v[104:107], a[84:87], v[236:239], v[104:107]
    s_mov_b32 m0, s93
    v_exp_f32_e32 v220, v220
    v_mfma_f32_16x16x32_bf16 v[108:111], a[92:95], v[236:239], v[108:111]
    v_exp_f32_e32 v221, v221
    v_mfma_f32_16x16x32_bf16 v[108:111], a[88:91], v[232:235], v[108:111]
    v_exp_f32_e32 v222, v222
    v_mfma_f32_16x16x32_bf16 v[112:115], a[96:99], v[232:235], v[112:115]
    v_exp_f32_e32 v223, v223
    v_mfma_f32_16x16x32_bf16 v[112:115], a[100:103], v[236:239], v[112:115]
    ds_read_b64_tr_b16 a[244:245], v253 offset:25024
    v_cvt_pk_bf16_f32 v228, v216, v217
    v_mfma_f32_16x16x32_bf16 v[116:119], a[108:111], v[236:239], v[116:119]
    ds_read_b64_tr_b16 a[246:247], v253 offset:29152
    v_cvt_pk_bf16_f32 v229, v218, v219
    v_mfma_f32_16x16x32_bf16 v[116:119], a[104:107], v[232:235], v[116:119]
    ds_read_b64_tr_b16 a[252:253], v253 offset:25032
    v_cvt_pk_bf16_f32 v230, v220, v221
    v_mfma_f32_16x16x32_bf16 v[120:123], a[112:115], v[232:235], v[120:123]
    ds_read_b64_tr_b16 a[254:255], v253 offset:29160
    v_cvt_pk_bf16_f32 v231, v222, v223
    v_mfma_f32_16x16x32_bf16 v[120:123], a[116:119], v[236:239], v[120:123]
    buffer_load_dwordx4 v254, s[12:15], s20 offen offset:3072 nt lds
    v_mfma_f32_16x16x32_bf16 v[124:127], a[124:127], v[236:239], v[124:127]
    s_xor_b32 s20, s20, 114688
    ds_read_b64_tr_b16 a[248:249], v253 offset:16776
    v_mfma_f32_16x16x32_bf16 v[124:127], a[120:123], v[232:235], v[124:127]
    s_add_u32 s20, s20, 8388608
    ds_read_b64_tr_b16 a[250:251], v253 offset:20904
    v_mfma_f32_16x16x32_bf16 v[208:211], a[0:3], v[144:147], v[196:199]
    s_and_b32 s10, s10, s49
    ds_read_b64_tr_b16 a[96:97], v253 offset:17024
    v_mfma_f32_16x16x32_bf16 v[208:211], a[4:7], v[148:151], v[208:211]
    s_and_b32 s20, s20, s49
    ds_read_b64_tr_b16 a[98:99], v253 offset:21152
    v_mfma_f32_16x16x32_bf16 v[208:211], a[8:11], v[152:155], v[208:211]
    s_and_b32 s14, s14, s49
    ds_read_b64_tr_b16 a[100:101], v253 offset:25280
    v_mfma_f32_16x16x32_bf16 v[208:211], a[12:15], v[156:159], v[208:211]
    s_add_u32 s44, s44, 1
    ds_read_b64_tr_b16 a[102:103], v253 offset:29408
    v_mfma_f32_16x16x32_bf16 v[212:215], a[28:31], v[156:159], v[196:199]
    ds_read_b64_tr_b16 a[108:109], v253 offset:25288
    v_mfma_f32_16x16x32_bf16 v[212:215], a[24:27], v[152:155], v[212:215]
    v_exp_f32_e32 v208, v208
    v_mfma_f32_16x16x32_bf16 v[212:215], a[20:23], v[148:151], v[212:215]
    s_mov_b32 m0, s23
    v_exp_f32_e32 v209, v209
    v_mfma_f32_16x16x32_bf16 v[212:215], a[16:19], v[144:147], v[212:215]
    ds_read_b64_tr_b16 a[110:111], v253 offset:29416
    v_cvt_pk_bf16_f32 v232, v208, v209
    v_mfma_f32_16x16x32_bf16 v[216:219], a[32:35], v[144:147], v[196:199]
    ds_read_b64_tr_b16 a[104:105], v253 offset:17032
    v_mov_b32_e32 v244, s44
    v_mfma_f32_16x16x32_bf16 v[216:219], a[36:39], v[148:151], v[216:219]
    buffer_store_dwordx4 a[180:183], v255, s[16:19], s22 offen offset:1024 sc0 sc1 nt
    v_mfma_f32_16x16x32_bf16 v[216:219], a[40:43], v[152:155], v[216:219]
    buffer_load_dwordx4 v254, s[8:11], s20 offen nt lds
    v_mfma_f32_16x16x32_bf16 v[216:219], a[44:47], v[156:159], v[216:219]
    v_exp_f32_e32 v210, v210
    v_mfma_f32_16x16x32_bf16 v[220:223], a[60:63], v[156:159], v[196:199]
    v_exp_f32_e32 v211, v211
    v_mfma_f32_16x16x32_bf16 v[220:223], a[56:59], v[152:155], v[220:223]
    s_waitcnt vmcnt(13)
    ds_read_b64_tr_b16 a[106:107], v253 offset:21160
    v_cvt_pk_bf16_f32 v233, v210, v211
    v_mfma_f32_16x16x32_bf16 v[220:223], a[52:55], v[148:151], v[220:223]
    s_mov_b32 m0, s45
    v_exp_f32_e32 v212, v212
    v_mfma_f32_16x16x32_bf16 v[220:223], a[48:51], v[144:147], v[220:223]
    ds_read_b64_tr_b16 a[112:113], v253 offset:17280
    ds_read_b64_tr_b16 a[114:115], v253 offset:21408
    v_smfmac_f32_16x16x64_bf16 a[192:195], a[208:211], v[224:231], v245
    ds_read_b64_tr_b16 a[116:117], v253 offset:25536
    v_mfma_f32_16x16x32_bf16 v[0:3], a[224:227], v[224:227], v[0:3]
    ds_read_b64_tr_b16 a[118:119], v253 offset:29664
    ds_read_b64_tr_b16 a[124:125], v253 offset:25544
    v_mfma_f32_16x16x32_bf16 v[0:3], a[228:231], v[228:231], v[0:3]
    s_waitcnt lgkmcnt(7)
    ds_read_b64_tr_b16 a[126:127], v253 offset:29672
    ds_write_addtid_b32 v244
    v_mfma_f32_16x16x32_bf16 v[4:7], a[236:239], v[228:231], v[4:7]
    ds_read_b64_tr_b16 a[120:121], v253 offset:17288
    ds_read_b64_tr_b16 a[122:123], v253 offset:21416
    v_mfma_f32_16x16x32_bf16 v[4:7], a[232:235], v[224:227], v[4:7]
    v_exp_f32_e32 v213, v213
    v_mfma_f32_16x16x32_bf16 v[8:11], a[240:243], v[224:227], v[8:11]
    v_exp_f32_e32 v214, v214
    v_mfma_f32_16x16x32_bf16 v[8:11], a[244:247], v[228:231], v[8:11]
    v_exp_f32_e32 v215, v215
    v_mfma_f32_16x16x32_bf16 v[12:15], a[252:255], v[228:231], v[12:15]
    v_exp_f32_e32 v216, v216
    v_mfma_f32_16x16x32_bf16 v[12:15], a[248:251], v[224:227], v[12:15]
    v_exp_f32_e32 v217, v217
    v_mfma_f32_16x16x32_bf16 v[16:19], a[96:99], v[224:227], v[16:19]
    v_exp_f32_e32 v218, v218
    v_mfma_f32_16x16x32_bf16 v[16:19], a[100:103], v[228:231], v[16:19]
    s_waitcnt lgkmcnt(2)
    v_exp_f32_e32 v219, v219
    v_mfma_f32_16x16x32_bf16 v[20:23], a[108:111], v[228:231], v[20:23]
    s_mov_b32 m0, s94
    v_cvt_pk_bf16_f32 v234, v212, v213
    v_cvt_pk_bf16_f32 v235, v214, v215
    v_mfma_f32_16x16x32_bf16 v[20:23], a[104:107], v[224:227], v[20:23]
    v_exp_f32_e32 v220, v220
    v_mfma_f32_16x16x32_bf16 v[24:27], a[112:115], v[224:227], v[24:27]
    v_exp_f32_e32 v221, v221
    v_mfma_f32_16x16x32_bf16 v[24:27], a[116:119], v[228:231], v[24:27]
    v_exp_f32_e32 v222, v222
    v_mfma_f32_16x16x32_bf16 v[28:31], a[124:127], v[228:231], v[28:31]
    s_waitcnt lgkmcnt(0)
    v_exp_f32_e32 v223, v223
    v_mfma_f32_16x16x32_bf16 v[28:31], a[120:123], v[224:227], v[28:31]
    v_cvt_pk_bf16_f32 v236, v216, v217
    v_cvt_pk_bf16_f32 v237, v218, v219
    v_mfma_f32_16x16x32_bf16 v[208:211], a[0:3], v[160:163], v[200:203]
    v_cvt_pk_bf16_f32 v238, v220, v221
    v_cvt_pk_bf16_f32 v239, v222, v223
    v_mfma_f32_16x16x32_bf16 v[208:211], a[4:7], v[164:167], v[208:211]
    buffer_load_dwordx4 v254, s[8:11], s20 offen offset:1024 nt lds
    v_mfma_f32_16x16x32_bf16 v[208:211], a[8:11], v[168:171], v[208:211]
    v_mfma_f32_16x16x32_bf16 v[208:211], a[12:15], v[172:175], v[208:211]
    v_mfma_f32_16x16x32_bf16 v[212:215], a[28:31], v[172:175], v[200:203]
    v_mfma_f32_16x16x32_bf16 v[212:215], a[24:27], v[168:171], v[212:215]
    v_exp_f32_e32 v208, v208
    v_mfma_f32_16x16x32_bf16 v[212:215], a[20:23], v[164:167], v[212:215]
    s_mov_b32 m0, s95
    v_exp_f32_e32 v209, v209
    v_mfma_f32_16x16x32_bf16 v[212:215], a[16:19], v[160:163], v[212:215]
    v_exp_f32_e32 v210, v210
    v_mfma_f32_16x16x32_bf16 v[216:219], a[32:35], v[160:163], v[200:203]
    s_waitcnt vmcnt(10)
    ds_read_b128 a[160:163], v246 offset:0
    v_cvt_pk_bf16_f32 v224, v208, v209
    v_mfma_f32_16x16x32_bf16 v[216:219], a[36:39], v[164:167], v[216:219]
    ds_read_b128 a[164:167], v246 offset:256
    v_accvgpr_write_b32 a218, v251
    v_mfma_f32_16x16x32_bf16 v[216:219], a[40:43], v[168:171], v[216:219]
    ds_read_b128 a[168:171], v246 offset:512
    v_cmp_ngt_f32_e64 s[30:31], s26, v251
    v_mfma_f32_16x16x32_bf16 v[216:219], a[44:47], v[172:175], v[216:219]
    v_exp_f32_e32 v211, v211
    v_mfma_f32_16x16x32_bf16 v[220:223], a[60:63], v[172:175], v[200:203]
    s_or_b64 s[28:29], s[28:29], s[30:31]
    ds_read_b128 a[172:175], v246 offset:768
    v_cvt_pk_bf16_f32 v225, v210, v211
    v_mfma_f32_16x16x32_bf16 v[220:223], a[56:59], v[168:171], v[220:223]
    buffer_load_dwordx4 v254, s[8:11], s20 offen offset:2048 nt lds
    v_mfma_f32_16x16x32_bf16 v[220:223], a[52:55], v[164:167], v[220:223]
    s_mov_b32 m0, s27
    v_exp_f32_e32 v212, v212
    v_mfma_f32_16x16x32_bf16 v[220:223], a[48:51], v[160:163], v[220:223]
    v_exp_f32_e32 v213, v213
    v_smfmac_f32_16x16x64_bf16 a[196:199], a[208:211], v[232:239], v245
    v_cvt_pk_bf16_f32 v226, v212, v213
    v_mfma_f32_16x16x32_bf16 v[32:35], a[224:227], v[232:235], v[32:35]
    v_exp_f32_e32 v214, v214
    v_mfma_f32_16x16x32_bf16 v[32:35], a[228:231], v[236:239], v[32:35]
    ds_read_b32 v244, v255
    v_mfma_f32_16x16x32_bf16 v[36:39], a[236:239], v[236:239], v[36:39]
    v_exp_f32_e32 v215, v215
    v_mfma_f32_16x16x32_bf16 v[36:39], a[232:235], v[232:235], v[36:39]
    v_exp_f32_e32 v216, v216
    v_mfma_f32_16x16x32_bf16 v[40:43], a[240:243], v[232:235], v[40:43]
    v_exp_f32_e32 v217, v217
    v_mfma_f32_16x16x32_bf16 v[40:43], a[244:247], v[236:239], v[40:43]
    v_exp_f32_e32 v218, v218
    v_mfma_f32_16x16x32_bf16 v[44:47], a[252:255], v[236:239], v[44:47]
    v_exp_f32_e32 v219, v219
    v_mfma_f32_16x16x32_bf16 v[44:47], a[248:251], v[232:235], v[44:47]
    v_cvt_pk_bf16_f32 v227, v214, v215
    v_cvt_pk_bf16_f32 v228, v216, v217
    v_mfma_f32_16x16x32_bf16 v[48:51], a[96:99], v[232:235], v[48:51]
    v_exp_f32_e32 v220, v220
    v_mfma_f32_16x16x32_bf16 v[48:51], a[100:103], v[236:239], v[48:51]
    s_waitcnt lgkmcnt(0)
    v_cmp_gt_u32_e32 vcc, s44, v244
    v_cvt_pk_bf16_f32 v229, v218, v219
    v_mfma_f32_16x16x32_bf16 v[52:55], a[108:111], v[236:239], v[52:55]
    v_exp_f32_e32 v221, v221
    v_mfma_f32_16x16x32_bf16 v[52:55], a[104:107], v[232:235], v[52:55]
    s_cbranch_vccnz L_rt12
L_bk12:
    v_exp_f32_e32 v222, v222
    v_mfma_f32_16x16x32_bf16 v[56:59], a[112:115], v[232:235], v[56:59]
    v_exp_f32_e32 v223, v223
    v_mfma_f32_16x16x32_bf16 v[56:59], a[116:119], v[236:239], v[56:59]
    buffer_load_dwordx4 v254, s[4:7], s21 offen nt lds
    v_mfma_f32_16x16x32_bf16 v[60:63], a[124:127], v[236:239], v[60:63]
    s_mov_b32 m0, s96
    ds_read_b64_tr_b16 a[64:65], v253 offset:33024
    v_cvt_pk_bf16_f32 v230, v220, v221
    v_mfma_f32_16x16x32_bf16 v[60:63], a[120:123], v[232:235], v[60:63]
    ds_read_b64_tr_b16 a[66:67], v253 offset:37152
    v_cvt_pk_bf16_f32 v231, v222, v223
    s_branch L_mid
L_drain:
    v_mfma_f32_16x16x32_bf16 v[208:211], a[0:3], v[144:147], v[196:199]
    s_add_u32 s44, s44, 1
    ds_read_b64_tr_b16 a[94:95], v253 offset:45672
    v_mfma_f32_16x16x32_bf16 v[208:211], a[4:7], v[148:151], v[208:211]
    ds_read_b64_tr_b16 a[88:89], v253 offset:33288
    v_mfma_f32_16x16x32_bf16 v[208:211], a[8:11], v[152:155], v[208:211]
    ds_read_b64_tr_b16 a[90:91], v253 offset:37416
    v_mfma_f32_16x16x32_bf16 v[208:211], a[12:15], v[156:159], v[208:211]
    ds_read_b64_tr_b16 a[96:97], v253 offset:33536
    v_mfma_f32_16x16x32_bf16 v[212:215], a[28:31], v[156:159], v[196:199]
    ds_read_b64_tr_b16 a[98:99], v253 offset:37664
    v_mfma_f32_16x16x32_bf16 v[212:215], a[24:27], v[152:155], v[212:215]
    v_exp_f32_e32 v208, v208
    v_mfma_f32_16x16x32_bf16 v[212:215], a[20:23], v[148:151], v[212:215]
    s_mov_b32 m0, s74
    v_exp_f32_e32 v209, v209
    v_mfma_f32_16x16x32_bf16 v[212:215], a[16:19], v[144:147], v[212:215]
    ds_read_b64_tr_b16 a[100:101], v253 offset:41792
    v_cvt_pk_bf16_f32 v232, v208, v209
    v_mfma_f32_16x16x32_bf16 v[216:219], a[32:35], v[144:147], v[196:199]
    ds_read_b64_tr_b16 a[102:103], v253 offset:45920
    v_mov_b32_e32 v244, s44
    v_mfma_f32_16x16x32_bf16 v[216:219], a[36:39], v[148:151], v[216:219]
    buffer_load_dwordx4 v254, s[8:11], s20 offen nt lds
    v_mfma_f32_16x16x32_bf16 v[216:219], a[40:43], v[152:155], v[216:219]
    v_exp_f32_e32 v210, v210
    v_mfma_f32_16x16x32_bf16 v[216:219], a[44:47], v[156:159], v[216:219]
    v_exp_f32_e32 v211, v211
    v_mfma_f32_16x16x32_bf16 v[220:223], a[60:63], v[156:159], v[196:199]
    ds_read_b64_tr_b16 a[108:109], v253 offset:41800
    v_cvt_pk_bf16_f32 v233, v210, v211
    v_mfma_f32_16x16x32_bf16 v[220:223], a[56:59], v[152:155], v[220:223]
    s_waitcnt vmcnt(12)
    v_exp_f32_e32 v212, v212
    v_mfma_f32_16x16x32_bf16 v[220:223], a[52:55], v[148:151], v[220:223]
    s_mov_b32 m0, s45
    ds_read_b64_tr_b16 a[110:111], v253 offset:45928
    ds_read_b64_tr_b16 a[104:105], v253 offset:33544
    v_mfma_f32_16x16x32_bf16 v[220:223], a[48:51], v[144:147], v[220:223]
    ds_read_b64_tr_b16 a[106:107], v253 offset:37672
    ds_read_b64_tr_b16 a[112:113], v253 offset:33792
    v_smfmac_f32_16x16x64_bf16 a[192:195], a[208:211], v[224:231], v245
    ds_read_b64_tr_b16 a[114:115], v253 offset:37920
    v_mfma_f32_16x16x32_bf16 v[0:3], a[64:67], v[224:227], v[0:3]
    s_waitcnt lgkmcnt(8)
    ds_read_b64_tr_b16 a[116:117], v253 offset:42048
    ds_read_b64_tr_b16 a[118:119], v253 offset:46176
    v_mfma_f32_16x16x32_bf16 v[0:3], a[68:71], v[228:231], v[0:3]
    ds_read_b64_tr_b16 a[124:125], v253 offset:42056
    ds_read_b64_tr_b16 a[126:127], v253 offset:46184
    v_mfma_f32_16x16x32_bf16 v[4:7], a[76:79], v[228:231], v[4:7]
    ds_write_addtid_b32 v244
    ds_read_b64_tr_b16 a[120:121], v253 offset:33800
    v_mfma_f32_16x16x32_bf16 v[4:7], a[72:75], v[224:227], v[4:7]
    ds_read_b64_tr_b16 a[122:123], v253 offset:37928
    v_mfma_f32_16x16x32_bf16 v[8:11], a[80:83], v[224:227], v[8:11]
    buffer_store_dwordx4 a[168:171], v255, s[16:19], s22 offen offset:2048 sc0 sc1 nt
    v_mfma_f32_16x16x32_bf16 v[8:11], a[84:87], v[228:231], v[8:11]
    v_exp_f32_e32 v213, v213
    v_mfma_f32_16x16x32_bf16 v[12:15], a[92:95], v[228:231], v[12:15]
    v_exp_f32_e32 v214, v214
    v_mfma_f32_16x16x32_bf16 v[12:15], a[88:91], v[224:227], v[12:15]
    v_exp_f32_e32 v215, v215
    v_mfma_f32_16x16x32_bf16 v[16:19], a[96:99], v[224:227], v[16:19]
    s_waitcnt lgkmcnt(10)
    v_exp_f32_e32 v216, v216
    v_mfma_f32_16x16x32_bf16 v[16:19], a[100:103], v[228:231], v[16:19]
    s_waitcnt lgkmcnt(2)
    v_exp_f32_e32 v217, v217
    v_mfma_f32_16x16x32_bf16 v[20:23], a[108:111], v[228:231], v[20:23]
    s_mov_b32 m0, s75
    v_exp_f32_e32 v218, v218
    v_mfma_f32_16x16x32_bf16 v[20:23], a[104:107], v[224:227], v[20:23]
    v_exp_f32_e32 v219, v219
    v_mfma_f32_16x16x32_bf16 v[24:27], a[112:115], v[224:227], v[24:27]
    v_cvt_pk_bf16_f32 v234, v212, v213
    v_cvt_pk_bf16_f32 v235, v214, v215
    v_mfma_f32_16x16x32_bf16 v[24:27], a[116:119], v[228:231], v[24:27]
    v_exp_f32_e32 v220, v220
    v_mfma_f32_16x16x32_bf16 v[28:31], a[124:127], v[228:231], v[28:31]
    s_waitcnt lgkmcnt(0)
    v_exp_f32_e32 v221, v221
    v_mfma_f32_16x16x32_bf16 v[28:31], a[120:123], v[224:227], v[28:31]
    v_exp_f32_e32 v222, v222
    v_mfma_f32_16x16x32_bf16 v[208:211], a[0:3], v[160:163], v[200:203]
    v_exp_f32_e32 v223, v223
    v_mfma_f32_16x16x32_bf16 v[208:211], a[4:7], v[164:167], v[208:211]
    v_cvt_pk_bf16_f32 v236, v216, v217
    v_cvt_pk_bf16_f32 v237, v218, v219
    v_mfma_f32_16x16x32_bf16 v[208:211], a[8:11], v[168:171], v[208:211]
    v_cvt_pk_bf16_f32 v238, v220, v221
    v_cvt_pk_bf16_f32 v239, v222, v223
    v_mfma_f32_16x16x32_bf16 v[208:211], a[12:15], v[172:175], v[208:211]
    buffer_load_dwordx4 v254, s[8:11], s20 offen offset:1024 nt lds
    v_mfma_f32_16x16x32_bf16 v[212:215], a[28:31], v[172:175], v[200:203]
    v_mfma_f32_16x16x32_bf16 v[212:215], a[24:27], v[168:171], v[212:215]
    v_exp_f32_e32 v208, v208
    v_mfma_f32_16x16x32_bf16 v[212:215], a[20:23], v[164:167], v[212:215]
    s_mov_b32 m0, s76
    v_exp_f32_e32 v209, v209
    v_mfma_f32_16x16x32_bf16 v[212:215], a[16:19], v[160:163], v[212:215]
    v_exp_f32_e32 v210, v210
    v_mfma_f32_16x16x32_bf16 v[216:219], a[32:35], v[160:163], v[200:203]
    v_exp_f32_e32 v211, v211
    v_mfma_f32_16x16x32_bf16 v[216:219], a[36:39], v[164:167], v[216:219]
    buffer_load_dwordx4 v254, s[8:11], s20 offen offset:2048 nt lds
    v_mfma_f32_16x16x32_bf16 v[216:219], a[40:43], v[168:171], v[216:219]
    v_exp_f32_e32 v212, v212
    v_mfma_f32_16x16x32_bf16 v[216:219], a[44:47], v[172:175], v[216:219]
    v_exp_f32_e32 v213, v213
    v_mfma_f32_16x16x32_bf16 v[220:223], a[60:63], v[172:175], v[200:203]
    v_exp_f32_e32 v214, v214
    v_mfma_f32_16x16x32_bf16 v[220:223], a[56:59], v[168:171], v[220:223]
    v_exp_f32_e32 v215, v215
    v_mfma_f32_16x16x32_bf16 v[220:223], a[52:55], v[164:167], v[220:223]
    v_cvt_pk_bf16_f32 v224, v208, v209
    v_cvt_pk_bf16_f32 v225, v210, v211
    v_mfma_f32_16x16x32_bf16 v[220:223], a[48:51], v[160:163], v[220:223]
    v_exp_f32_e32 v216, v216
    v_smfmac_f32_16x16x64_bf16 a[196:199], a[208:211], v[232:239], v245
    v_cvt_pk_bf16_f32 v226, v212, v213
    v_mfma_f32_16x16x32_bf16 v[32:35], a[64:67], v[232:235], v[32:35]
    v_exp_f32_e32 v217, v217
    v_mfma_f32_16x16x32_bf16 v[32:35], a[68:71], v[236:239], v[32:35]
    ds_read_b32 v244, v255
    v_cvt_pk_bf16_f32 v227, v214, v215
    v_mfma_f32_16x16x32_bf16 v[36:39], a[76:79], v[236:239], v[36:39]
    v_exp_f32_e32 v218, v218
    v_mfma_f32_16x16x32_bf16 v[36:39], a[72:75], v[232:235], v[36:39]
    v_exp_f32_e32 v219, v219
    v_mfma_f32_16x16x32_bf16 v[40:43], a[80:83], v[232:235], v[40:43]
    v_exp_f32_e32 v220, v220
    v_mfma_f32_16x16x32_bf16 v[40:43], a[84:87], v[236:239], v[40:43]
    s_mov_b32 m0, s77
    v_exp_f32_e32 v221, v221
    v_mfma_f32_16x16x32_bf16 v[44:47], a[92:95], v[236:239], v[44:47]
    v_exp_f32_e32 v222, v222
    v_mfma_f32_16x16x32_bf16 v[44:47], a[88:91], v[232:235], v[44:47]
    buffer_store_dwordx4 a[172:175], v255, s[16:19], s22 offen offset:3072 sc0 sc1 nt
    v_mfma_f32_16x16x32_bf16 v[48:51], a[96:99], v[232:235], v[48:51]
    s_waitcnt lgkmcnt(0)
    v_cmp_gt_u32_e32 vcc, s44, v244
    v_cvt_pk_bf16_f32 v228, v216, v217
    v_mfma_f32_16x16x32_bf16 v[48:51], a[100:103], v[236:239], v[48:51]
    s_xor_b32 s22, s22, 16384
    v_exp_f32_e32 v223, v223
    v_mfma_f32_16x16x32_bf16 v[52:55], a[108:111], v[236:239], v[52:55]
    s_cbranch_vccnz L_rt13
L_bk13:
    ds_read_b64_tr_b16 a[224:225], v253 offset:49536
    v_cvt_pk_bf16_f32 v229, v218, v219
    v_mfma_f32_16x16x32_bf16 v[52:55], a[104:107], v[232:235], v[52:55]
    ds_read_b64_tr_b16 a[226:227], v253 offset:53664
    v_cvt_pk_bf16_f32 v230, v220, v221
    v_mfma_f32_16x16x32_bf16 v[56:59], a[112:115], v[232:235], v[56:59]
    ds_read_b64_tr_b16 a[228:229], v253 offset:57792
    v_cvt_pk_bf16_f32 v231, v222, v223
    v_mfma_f32_16x16x32_bf16 v[56:59], a[116:119], v[236:239], v[56:59]
    buffer_load_dwordx4 v254, s[8:11], s20 offen offset:3072 nt lds
    v_mfma_f32_16x16x32_bf16 v[60:63], a[124:127], v[236:239], v[60:63]
    ds_read_b64_tr_b16 a[230:231], v253 offset:61920
    v_mfma_f32_16x16x32_bf16 v[60:63], a[120:123], v[232:235], v[60:63]
    ds_read_b64_tr_b16 a[236:237], v253 offset:57800
    v_mfma_f32_16x16x32_bf16 v[208:211], a[0:3], v[176:179], v[204:207]
    ds_read_b128 a[0:3], v252 offset:50688
    v_mfma_f32_16x16x32_bf16 v[208:211], a[4:7], v[180:183], v[208:211]
    ds_read_b128 a[4:7], v252 offset:50944
    v_mfma_f32_16x16x32_bf16 v[208:211], a[8:11], v[184:187], v[208:211]
    ds_read_b128 a[8:11], v252 offset:51200
    v_mfma_f32_16x16x32_bf16 v[208:211], a[12:15], v[188:191], v[208:211]
    ds_read_b128 a[12:15], v252 offset:51456
    v_mfma_f32_16x16x32_bf16 v[212:215], a[28:31], v[188:191], v[204:207]
    ds_read_b128 a[28:31], v252 offset:55680
    v_mfma_f32_16x16x32_bf16 v[212:215], a[24:27], v[184:187], v[212:215]
    v_exp_f32_e32 v208, v208
    v_mfma_f32_16x16x32_bf16 v[212:215], a[20:23], v[180:183], v[212:215]
    s_mov_b32 m0, s78
    v_exp_f32_e32 v209, v209
    v_mfma_f32_16x16x32_bf16 v[212:215], a[16:19], v[176:179], v[212:215]
    v_exp_f32_e32 v210, v210
    v_mfma_f32_16x16x32_bf16 v[216:219], a[32:35], v[176:179], v[204:207]
    v_exp_f32_e32 v211, v211
    v_mfma_f32_16x16x32_bf16 v[216:219], a[36:39], v[180:183], v[216:219]
    ds_read_b128 a[24:27], v252 offset:55424
    v_cvt_pk_bf16_f32 v232, v208, v209
    v_mfma_f32_16x16x32_bf16 v[216:219], a[40:43], v[184:187], v[216:219]
    ds_read_b128 a[20:23], v252 offset:55168
    v_cvt_pk_bf16_f32 v233, v210, v211
    v_mfma_f32_16x16x32_bf16 v[216:219], a[44:47], v[188:191], v[216:219]
    buffer_load_dwordx4 v254, s[12:15], s20 offen nt lds
    v_mfma_f32_16x16x32_bf16 v[220:223], a[60:63], v[188:191], v[204:207]
    v_exp_f32_e32 v212, v212
    v_mfma_f32_16x16x32_bf16 v[220:223], a[56:59], v[184:187], v[220:223]
    v_exp_f32_e32 v213, v213
    v_mfma_f32_16x16x32_bf16 v[220:223], a[52:55], v[180:183], v[220:223]
    s_mov_b32 m0, s79
    v_exp_f32_e32 v214, v214
    v_mfma_f32_16x16x32_bf16 v[220:223], a[48:51], v[176:179], v[220:223]
    v_exp_f32_e32 v215, v215
    v_smfmac_f32_16x16x64_bf16 a[200:203], a[208:211], v[224:231], v245
    ds_read_b128 a[16:19], v252 offset:54912
    v_mfma_f32_16x16x32_bf16 v[64:67], a[64:67], v[224:227], v[64:67]
    ds_read_b128 a[32:35], v252 offset:59136
    v_cvt_pk_bf16_f32 v234, v212, v213
    v_mfma_f32_16x16x32_bf16 v[64:67], a[68:71], v[228:231], v[64:67]
    ds_read_b128 a[36:39], v252 offset:59392
    v_cvt_pk_bf16_f32 v235, v214, v215
    v_mfma_f32_16x16x32_bf16 v[68:71], a[76:79], v[228:231], v[68:71]
    v_exp_f32_e32 v216, v216
    v_mfma_f32_16x16x32_bf16 v[68:71], a[72:75], v[224:227], v[68:71]
    v_exp_f32_e32 v217, v217
    v_mfma_f32_16x16x32_bf16 v[72:75], a[80:83], v[224:227], v[72:75]
    ds_read_b128 a[40:43], v252 offset:59648
    v_cvt_pk_bf16_f32 v236, v216, v217
    v_mfma_f32_16x16x32_bf16 v[72:75], a[84:87], v[228:231], v[72:75]
    v_exp_f32_e32 v218, v218
    v_mfma_f32_16x16x32_bf16 v[76:79], a[92:95], v[228:231], v[76:79]
    v_exp_f32_e32 v219, v219
    v_mfma_f32_16x16x32_bf16 v[76:79], a[88:91], v[224:227], v[76:79]
    ds_read_b128 a[44:47], v252 offset:59904
    v_cvt_pk_bf16_f32 v237, v218, v219
    v_mfma_f32_16x16x32_bf16 v[80:83], a[96:99], v[224:227], v[80:83]
    buffer_load_dwordx4 v254, s[12:15], s20 offen offset:1024 nt lds
    v_mfma_f32_16x16x32_bf16 v[80:83], a[100:103], v[228:231], v[80:83]
    s_mov_b32 m0, s80
    v_exp_f32_e32 v220, v220
    v_mfma_f32_16x16x32_bf16 v[84:87], a[108:111], v[228:231], v[84:87]
    v_exp_f32_e32 v221, v221
    v_mfma_f32_16x16x32_bf16 v[84:87], a[104:107], v[224:227], v[84:87]
    ds_read_b128 a[60:63], v252 offset:64128
    v_cvt_pk_bf16_f32 v238, v220, v221
    v_mfma_f32_16x16x32_bf16 v[88:91], a[112:115], v[224:227], v[88:91]
    v_exp_f32_e32 v222, v222
    v_mfma_f32_16x16x32_bf16 v[88:91], a[116:119], v[228:231], v[88:91]
    v_exp_f32_e32 v223, v223
    v_mfma_f32_16x16x32_bf16 v[92:95], a[124:127], v[228:231], v[92:95]
    ds_read_b128 a[56:59], v252 offset:63872
    v_cvt_pk_bf16_f32 v239, v222, v223
    v_mfma_f32_16x16x32_bf16 v[92:95], a[120:123], v[224:227], v[92:95]
    s_waitcnt lgkmcnt(4)
    buffer_load_dwordx4 v254, s[12:15], s20 offen offset:2048 nt lds
    v_mfma_f32_16x16x32_bf16 v[208:211], a[0:3], v[128:131], v[192:195]
    s_mov_b32 m0, s81
    buffer_store_dwordx4 a[176:179], v255, s[16:19], s22 offen sc0 sc1 nt
    v_mfma_f32_16x16x32_bf16 v[208:211], a[4:7], v[132:135], v[208:211]
    buffer_load_dwordx4 v254, s[12:15], s20 offen offset:3072 nt lds
    v_mfma_f32_16x16x32_bf16 v[208:211], a[8:11], v[136:139], v[208:211]
    s_xor_b32 s20, s20, 49152
    ds_read_b128 a[52:55], v252 offset:63616
    v_mfma_f32_16x16x32_bf16 v[208:211], a[12:15], v[140:143], v[208:211]
    ds_read_b128 a[48:51], v252 offset:63360
    v_mfma_f32_16x16x32_bf16 v[212:215], a[28:31], v[140:143], v[192:195]
    ds_read_b64_tr_b16 a[238:239], v253 offset:61928
    v_mfma_f32_16x16x32_bf16 v[212:215], a[24:27], v[136:139], v[212:215]
    v_exp_f32_e32 v208, v208
    v_mfma_f32_16x16x32_bf16 v[212:215], a[20:23], v[132:135], v[212:215]
    v_exp_f32_e32 v209, v209
    v_mfma_f32_16x16x32_bf16 v[212:215], a[16:19], v[128:131], v[212:215]
    v_exp_f32_e32 v210, v210
    v_mfma_f32_16x16x32_bf16 v[216:219], a[32:35], v[128:131], v[192:195]
    v_exp_f32_e32 v211, v211
    v_mfma_f32_16x16x32_bf16 v[216:219], a[36:39], v[132:135], v[216:219]
    s_waitcnt lgkmcnt(4)
    v_exp_f32_e32 v212, v212
    v_mfma_f32_16x16x32_bf16 v[216:219], a[40:43], v[136:139], v[216:219]
    v_exp_f32_e32 v213, v213
    v_mfma_f32_16x16x32_bf16 v[216:219], a[44:47], v[140:143], v[216:219]
    v_exp_f32_e32 v214, v214
    v_mfma_f32_16x16x32_bf16 v[220:223], a[60:63], v[140:143], v[192:195]
    s_waitcnt lgkmcnt(3)
    v_exp_f32_e32 v215, v215
    v_mfma_f32_16x16x32_bf16 v[220:223], a[56:59], v[136:139], v[220:223]
    s_waitcnt lgkmcnt(2)
    ds_read_b64_tr_b16 a[232:233], v253 offset:49544
    v_cvt_pk_bf16_f32 v224, v208, v209
    v_mfma_f32_16x16x32_bf16 v[220:223], a[52:55], v[132:135], v[220:223]
    s_waitcnt lgkmcnt(2)
    ds_read_b64_tr_b16 a[234:235], v253 offset:53672
    v_cvt_pk_bf16_f32 v225, v210, v211
    v_mfma_f32_16x16x32_bf16 v[220:223], a[48:51], v[128:131], v[220:223]
    v_exp_f32_e32 v216, v216
    v_smfmac_f32_16x16x64_bf16 a[204:207], a[208:211], v[232:239], v245
    v_cvt_pk_bf16_f32 v226, v212, v213
    v_mfma_f32_16x16x32_bf16 v[96:99], a[64:67], v[232:235], v[96:99]
    v_exp_f32_e32 v217, v217
    v_mfma_f32_16x16x32_bf16 v[96:99], a[68:71], v[236:239], v[96:99]
    v_exp_f32_e32 v218, v218
    v_mfma_f32_16x16x32_bf16 v[100:103], a[76:79], v[236:239], v[100:103]
    v_exp_f32_e32 v219, v219
    v_mfma_f32_16x16x32_bf16 v[100:103], a[72:75], v[232:235], v[100:103]
    ds_read_b64_tr_b16 a[240:241], v253 offset:49792
    v_cvt_pk_bf16_f32 v227, v214, v215
    v_mfma_f32_16x16x32_bf16 v[104:107], a[80:83], v[232:235], v[104:107]
    v_exp_f32_e32 v220, v220
    v_mfma_f32_16x16x32_bf16 v[104:107], a[84:87], v[236:239], v[104:107]
    v_exp_f32_e32 v221, v221
    v_mfma_f32_16x16x32_bf16 v[108:111], a[92:95], v[236:239], v[108:111]
    v_exp_f32_e32 v222, v222
    v_mfma_f32_16x16x32_bf16 v[108:111], a[88:91], v[232:235], v[108:111]
    v_exp_f32_e32 v223, v223
    v_mfma_f32_16x16x32_bf16 v[112:115], a[96:99], v[232:235], v[112:115]
    ds_read_b64_tr_b16 a[242:243], v253 offset:53920
    v_cvt_pk_bf16_f32 v228, v216, v217
    v_mfma_f32_16x16x32_bf16 v[112:115], a[100:103], v[236:239], v[112:115]
    ds_read_b64_tr_b16 a[244:245], v253 offset:58048
    v_cvt_pk_bf16_f32 v229, v218, v219
    v_mfma_f32_16x16x32_bf16 v[116:119], a[108:111], v[236:239], v[116:119]
    ds_read_b64_tr_b16 a[246:247], v253 offset:62176
    v_cvt_pk_bf16_f32 v230, v220, v221
    v_mfma_f32_16x16x32_bf16 v[116:119], a[104:107], v[232:235], v[116:119]
    ds_read_b64_tr_b16 a[252:253], v253 offset:58056
    v_cvt_pk_bf16_f32 v231, v222, v223
    v_mfma_f32_16x16x32_bf16 v[120:123], a[112:115], v[232:235], v[120:123]
    ds_read_b64_tr_b16 a[254:255], v253 offset:62184
    v_mfma_f32_16x16x32_bf16 v[120:123], a[116:119], v[236:239], v[120:123]
    ds_read_b64_tr_b16 a[248:249], v253 offset:49800
    v_mfma_f32_16x16x32_bf16 v[124:127], a[124:127], v[236:239], v[124:127]
    ds_read_b64_tr_b16 a[250:251], v253 offset:53928
    v_mfma_f32_16x16x32_bf16 v[124:127], a[120:123], v[232:235], v[124:127]
    ds_read_b64_tr_b16 a[96:97], v253 offset:50048
    v_mfma_f32_16x16x32_bf16 v[208:211], a[0:3], v[144:147], v[196:199]
    s_add_u32 s44, s44, 1
    ds_read_b64_tr_b16 a[98:99], v253 offset:54176
    v_mfma_f32_16x16x32_bf16 v[208:211], a[4:7], v[148:151], v[208:211]
    ds_read_b64_tr_b16 a[100:101], v253 offset:58304
    v_mfma_f32_16x16x32_bf16 v[208:211], a[8:11], v[152:155], v[208:211]
    ds_read_b64_tr_b16 a[102:103], v253 offset:62432
    v_mfma_f32_16x16x32_bf16 v[208:211], a[12:15], v[156:159], v[208:211]
    ds_read_b64_tr_b16 a[108:109], v253 offset:58312
    v_mfma_f32_16x16x32_bf16 v[212:215], a[28:31], v[156:159], v[196:199]
    ds_read_b64_tr_b16 a[110:111], v253 offset:62440
    v_mfma_f32_16x16x32_bf16 v[212:215], a[24:27], v[152:155], v[212:215]
    v_exp_f32_e32 v208, v208
    v_mfma_f32_16x16x32_bf16 v[212:215], a[20:23], v[148:151], v[212:215]
    s_mov_b32 m0, s82
    v_exp_f32_e32 v209, v209
    v_mfma_f32_16x16x32_bf16 v[212:215], a[16:19], v[144:147], v[212:215]
    ds_read_b64_tr_b16 a[104:105], v253 offset:50056
    v_cvt_pk_bf16_f32 v232, v208, v209
    v_mfma_f32_16x16x32_bf16 v[216:219], a[32:35], v[144:147], v[196:199]
    ds_read_b64_tr_b16 a[106:107], v253 offset:54184
    v_mov_b32_e32 v244, s44
    v_mfma_f32_16x16x32_bf16 v[216:219], a[36:39], v[148:151], v[216:219]
    buffer_store_dwordx4 a[180:183], v255, s[16:19], s22 offen offset:1024 sc0 sc1 nt
    v_mfma_f32_16x16x32_bf16 v[216:219], a[40:43], v[152:155], v[216:219]
    buffer_load_dwordx4 v254, s[8:11], s20 offen nt lds
    v_mfma_f32_16x16x32_bf16 v[216:219], a[44:47], v[156:159], v[216:219]
    v_exp_f32_e32 v210, v210
    v_mfma_f32_16x16x32_bf16 v[220:223], a[60:63], v[156:159], v[196:199]
    v_exp_f32_e32 v211, v211
    v_mfma_f32_16x16x32_bf16 v[220:223], a[56:59], v[152:155], v[220:223]
    s_waitcnt vmcnt(13)
    ds_read_b64_tr_b16 a[112:113], v253 offset:50304
    v_cvt_pk_bf16_f32 v233, v210, v211
    v_mfma_f32_16x16x32_bf16 v[220:223], a[52:55], v[148:151], v[220:223]
    s_mov_b32 m0, s45
    v_exp_f32_e32 v212, v212
    v_mfma_f32_16x16x32_bf16 v[220:223], a[48:51], v[144:147], v[220:223]
    v_exp_f32_e32 v213, v213
    v_smfmac_f32_16x16x64_bf16 a[192:195], a[208:211], v[224:231], v245
    ds_read_b64_tr_b16 a[114:115], v253 offset:54432
    v_mfma_f32_16x16x32_bf16 v[0:3], a[224:227], v[224:227], v[0:3]
    ds_read_b64_tr_b16 a[116:117], v253 offset:58560
    ds_read_b64_tr_b16 a[118:119], v253 offset:62688
    v_mfma_f32_16x16x32_bf16 v[0:3], a[228:231], v[228:231], v[0:3]
    s_waitcnt lgkmcnt(6)
    ds_read_b64_tr_b16 a[124:125], v253 offset:58568
    ds_read_b64_tr_b16 a[126:127], v253 offset:62696
    v_mfma_f32_16x16x32_bf16 v[4:7], a[236:239], v[228:231], v[4:7]
    ds_write_addtid_b32 v244
    ds_read_b64_tr_b16 a[120:121], v253 offset:50312
    v_mfma_f32_16x16x32_bf16 v[4:7], a[232:235], v[224:227], v[4:7]
    ds_read_b64_tr_b16 a[122:123], v253 offset:54440
    v_cvt_pk_bf16_f32 v234, v212, v213
    v_mfma_f32_16x16x32_bf16 v[8:11], a[240:243], v[224:227], v[8:11]
    v_exp_f32_e32 v214, v214
    v_mfma_f32_16x16x32_bf16 v[8:11], a[244:247], v[228:231], v[8:11]
    v_exp_f32_e32 v215, v215
    v_mfma_f32_16x16x32_bf16 v[12:15], a[252:255], v[228:231], v[12:15]
    v_exp_f32_e32 v216, v216
    v_mfma_f32_16x16x32_bf16 v[12:15], a[248:251], v[224:227], v[12:15]
    v_exp_f32_e32 v217, v217
    v_mfma_f32_16x16x32_bf16 v[16:19], a[96:99], v[224:227], v[16:19]
    v_exp_f32_e32 v218, v218
    v_mfma_f32_16x16x32_bf16 v[16:19], a[100:103], v[228:231], v[16:19]
    v_exp_f32_e32 v219, v219
    v_mfma_f32_16x16x32_bf16 v[20:23], a[108:111], v[228:231], v[20:23]
    s_waitcnt lgkmcnt(8)
    v_cvt_pk_bf16_f32 v235, v214, v215
    v_cvt_pk_bf16_f32 v236, v216, v217
    v_mfma_f32_16x16x32_bf16 v[20:23], a[104:107], v[224:227], v[20:23]
    s_waitcnt lgkmcnt(7)
    v_exp_f32_e32 v220, v220
    v_mfma_f32_16x16x32_bf16 v[24:27], a[112:115], v[224:227], v[24:27]
    s_waitcnt lgkmcnt(5)
    v_exp_f32_e32 v221, v221
    v_mfma_f32_16x16x32_bf16 v[24:27], a[116:119], v[228:231], v[24:27]
    s_waitcnt lgkmcnt(3)
    v_exp_f32_e32 v222, v222
    v_mfma_f32_16x16x32_bf16 v[28:31], a[124:127], v[228:231], v[28:31]
    s_waitcnt lgkmcnt(0)
    v_exp_f32_e32 v223, v223
    v_mfma_f32_16x16x32_bf16 v[28:31], a[120:123], v[224:227], v[28:31]
    s_mov_b32 m0, s83
    v_cvt_pk_bf16_f32 v237, v218, v219
    v_cvt_pk_bf16_f32 v238, v220, v221
    v_mfma_f32_16x16x32_bf16 v[208:211], a[0:3], v[160:163], v[200:203]
    buffer_load_dwordx4 v254, s[8:11], s20 offen offset:1024 nt lds
    v_mfma_f32_16x16x32_bf16 v[208:211], a[4:7], v[164:167], v[208:211]
    v_cvt_pk_bf16_f32 v239, v222, v223
    v_mfma_f32_16x16x32_bf16 v[208:211], a[8:11], v[168:171], v[208:211]
    v_mfma_f32_16x16x32_bf16 v[208:211], a[12:15], v[172:175], v[208:211]
    v_mfma_f32_16x16x32_bf16 v[212:215], a[28:31], v[172:175], v[200:203]
    v_mfma_f32_16x16x32_bf16 v[212:215], a[24:27], v[168:171], v[212:215]
    v_exp_f32_e32 v208, v208
    v_mfma_f32_16x16x32_bf16 v[212:215], a[20:23], v[164:167], v[212:215]
    s_mov_b32 m0, s84
    v_exp_f32_e32 v209, v209
    v_mfma_f32_16x16x32_bf16 v[212:215], a[16:19], v[160:163], v[212:215]
    v_exp_f32_e32 v210, v210
    v_mfma_f32_16x16x32_bf16 v[216:219], a[32:35], v[160:163], v[200:203]
    v_exp_f32_e32 v211, v211
    v_mfma_f32_16x16x32_bf16 v[216:219], a[36:39], v[164:167], v[216:219]
    buffer_load_dwordx4 v254, s[8:11], s20 offen offset:2048 nt lds
    v_mfma_f32_16x16x32_bf16 v[216:219], a[40:43], v[168:171], v[216:219]
    v_exp_f32_e32 v212, v212
    v_mfma_f32_16x16x32_bf16 v[216:219], a[44:47], v[172:175], v[216:219]
    v_exp_f32_e32 v213, v213
    v_mfma_f32_16x16x32_bf16 v[220:223], a[60:63], v[172:175], v[200:203]
    v_exp_f32_e32 v214, v214
    v_mfma_f32_16x16x32_bf16 v[220:223], a[56:59], v[168:171], v[220:223]
    v_exp_f32_e32 v215, v215
    v_mfma_f32_16x16x32_bf16 v[220:223], a[52:55], v[164:167], v[220:223]
    v_cvt_pk_bf16_f32 v224, v208, v209
    v_cvt_pk_bf16_f32 v225, v210, v211
    v_mfma_f32_16x16x32_bf16 v[220:223], a[48:51], v[160:163], v[220:223]
    v_exp_f32_e32 v216, v216
    v_smfmac_f32_16x16x64_bf16 a[196:199], a[208:211], v[232:239], v245
    v_cvt_pk_bf16_f32 v226, v212, v213
    v_mfma_f32_16x16x32_bf16 v[32:35], a[224:227], v[232:235], v[32:35]
    buffer_store_dwordx4 a[184:187], v255, s[16:19], s22 offen offset:2048 sc0 sc1 nt
    v_mfma_f32_16x16x32_bf16 v[32:35], a[228:231], v[236:239], v[32:35]
    ds_read_b32 v244, v255
    v_cvt_pk_bf16_f32 v227, v214, v215
    v_mfma_f32_16x16x32_bf16 v[36:39], a[236:239], v[236:239], v[36:39]
    v_exp_f32_e32 v217, v217
    v_mfma_f32_16x16x32_bf16 v[36:39], a[232:235], v[232:235], v[36:39]
    v_exp_f32_e32 v218, v218
    v_mfma_f32_16x16x32_bf16 v[40:43], a[240:243], v[232:235], v[40:43]
    v_exp_f32_e32 v219, v219
    v_mfma_f32_16x16x32_bf16 v[40:43], a[244:247], v[236:239], v[40:43]
    s_mov_b32 m0, s85
    v_exp_f32_e32 v220, v220
    v_mfma_f32_16x16x32_bf16 v[44:47], a[252:255], v[236:239], v[44:47]
    v_exp_f32_e32 v221, v221
    v_mfma_f32_16x16x32_bf16 v[44:47], a[248:251], v[232:235], v[44:47]
    v_exp_f32_e32 v222, v222
    v_mfma_f32_16x16x32_bf16 v[48:51], a[96:99], v[232:235], v[48:51]
    v_exp_f32_e32 v223, v223
    v_mfma_f32_16x16x32_bf16 v[48:51], a[100:103], v[236:239], v[48:51]
    s_waitcnt lgkmcnt(0)
    v_cmp_gt_u32_e32 vcc, s44, v244
    v_cvt_pk_bf16_f32 v228, v216, v217
    v_mfma_f32_16x16x32_bf16 v[52:55], a[108:111], v[236:239], v[52:55]
    v_cvt_pk_bf16_f32 v229, v218, v219
    v_cvt_pk_bf16_f32 v230, v220, v221
    v_mfma_f32_16x16x32_bf16 v[52:55], a[104:107], v[232:235], v[52:55]
    s_cbranch_vccnz L_rt14
L_bk14:
    ds_read_b64_tr_b16 a[64:65], v253 offset:0
    v_cvt_pk_bf16_f32 v231, v222, v223
    v_mfma_f32_16x16x32_bf16 v[56:59], a[112:115], v[232:235], v[56:59]
    buffer_load_dwordx4 v254, s[8:11], s20 offen offset:3072 nt lds
    v_mfma_f32_16x16x32_bf16 v[56:59], a[116:119], v[236:239], v[56:59]
    ds_read_b64_tr_b16 a[66:67], v253 offset:4128
    v_mfma_f32_16x16x32_bf16 v[60:63], a[124:127], v[236:239], v[60:63]
    ds_read_b64_tr_b16 a[68:69], v253 offset:8256
    v_mfma_f32_16x16x32_bf16 v[60:63], a[120:123], v[232:235], v[60:63]
    ds_read_b64_tr_b16 a[70:71], v253 offset:12384
    v_mfma_f32_16x16x32_bf16 v[208:211], a[0:3], v[176:179], v[204:207]
    s_add_u32 s44, s44, 1
    ds_read_b128 a[0:3], v252 offset:0
    v_mfma_f32_16x16x32_bf16 v[208:211], a[4:7], v[180:183], v[208:211]
    ds_read_b128 a[4:7], v252 offset:256
    v_mfma_f32_16x16x32_bf16 v[208:211], a[8:11], v[184:187], v[208:211]
    ds_read_b128 a[8:11], v252 offset:512
    v_mfma_f32_16x16x32_bf16 v[208:211], a[12:15], v[188:191], v[208:211]
    ds_read_b128 a[12:15], v252 offset:768
    v_mfma_f32_16x16x32_bf16 v[212:215], a[28:31], v[188:191], v[204:207]
    ds_read_b128 a[28:31], v252 offset:4992
    v_mfma_f32_16x16x32_bf16 v[212:215], a[24:27], v[184:187], v[212:215]
    v_exp_f32_e32 v208, v208
    v_mfma_f32_16x16x32_bf16 v[212:215], a[20:23], v[180:183], v[212:215]
    s_mov_b32 m0, s86
    v_exp_f32_e32 v209, v209
    v_mfma_f32_16x16x32_bf16 v[212:215], a[16:19], v[176:179], v[212:215]
    v_exp_f32_e32 v210, v210
    v_mfma_f32_16x16x32_bf16 v[216:219], a[32:35], v[176:179], v[204:207]
    buffer_load_dwordx4 v254, s[12:15], s20 offen nt lds
    v_mfma_f32_16x16x32_bf16 v[216:219], a[36:39], v[180:183], v[216:219]
    ds_read_b128 a[24:27], v252 offset:4736
    v_mov_b32_e32 v244, s44
    v_mfma_f32_16x16x32_bf16 v[216:219], a[40:43], v[184:187], v[216:219]
    v_exp_f32_e32 v211, v211
    v_mfma_f32_16x16x32_bf16 v[216:219], a[44:47], v[188:191], v[216:219]
    ds_read_b128 a[20:23], v252 offset:4480
    v_cvt_pk_bf16_f32 v232, v208, v209
    v_mfma_f32_16x16x32_bf16 v[220:223], a[60:63], v[188:191], v[204:207]
    v_exp_f32_e32 v212, v212
    v_mfma_f32_16x16x32_bf16 v[220:223], a[56:59], v[184:187], v[220:223]
    s_waitcnt vmcnt(7)
    v_exp_f32_e32 v213, v213
    v_mfma_f32_16x16x32_bf16 v[220:223], a[52:55], v[180:183], v[220:223]
    s_mov_b32 m0, s45
    v_exp_f32_e32 v214, v214
    v_mfma_f32_16x16x32_bf16 v[220:223], a[48:51], v[176:179], v[220:223]
    v_exp_f32_e32 v215, v215
    v_smfmac_f32_16x16x64_bf16 a[200:203], a[208:211], v[224:231], v245
    ds_write_addtid_b32 v244
    v_mfma_f32_16x16x32_bf16 v[64:67], a[224:227], v[224:227], v[64:67]
    ds_read_b128 a[16:19], v252 offset:4224
    v_cvt_pk_bf16_f32 v233, v210, v211
    v_mfma_f32_16x16x32_bf16 v[64:67], a[228:231], v[228:231], v[64:67]
    ds_read_b128 a[32:35], v252 offset:8448
    v_cvt_pk_bf16_f32 v234, v212, v213
    v_mfma_f32_16x16x32_bf16 v[68:71], a[236:239], v[228:231], v[68:71]
    ds_read_b128 a[36:39], v252 offset:8704
    v_cvt_pk_bf16_f32 v235, v214, v215
    v_mfma_f32_16x16x32_bf16 v[68:71], a[232:235], v[224:227], v[68:71]
    v_exp_f32_e32 v216, v216
    v_mfma_f32_16x16x32_bf16 v[72:75], a[240:243], v[224:227], v[72:75]
    v_exp_f32_e32 v217, v217
    v_mfma_f32_16x16x32_bf16 v[72:75], a[244:247], v[228:231], v[72:75]
    ds_read_b128 a[40:43], v252 offset:8960
    v_cvt_pk_bf16_f32 v236, v216, v217
    v_mfma_f32_16x16x32_bf16 v[76:79], a[252:255], v[228:231], v[76:79]
    v_exp_f32_e32 v218, v218
    v_mfma_f32_16x16x32_bf16 v[76:79], a[248:251], v[224:227], v[76:79]
    s_waitcnt lgkmcnt(4)
    v_exp_f32_e32 v219, v219
    v_mfma_f32_16x16x32_bf16 v[80:83], a[96:99], v[224:227], v[80:83]
    s_mov_b32 m0, s87
    ds_read_b128 a[44:47], v252 offset:9216
    v_cvt_pk_bf16_f32 v237, v218, v219
    v_mfma_f32_16x16x32_bf16 v[80:83], a[100:103], v[228:231], v[80:83]
    buffer_store_dwordx4 a[188:191], v255, s[16:19], s22 offen offset:3072 sc0 sc1 nt
    v_mfma_f32_16x16x32_bf16 v[84:87], a[108:111], v[228:231], v[84:87]
    s_xor_b32 s22, s22, 49152
    buffer_load_dwordx4 v254, s[12:15], s20 offen offset:1024 nt lds
    v_mfma_f32_16x16x32_bf16 v[84:87], a[104:107], v[224:227], v[84:87]
    s_mov_b32 m0, s88
    v_exp_f32_e32 v220, v220
    v_mfma_f32_16x16x32_bf16 v[88:91], a[112:115], v[224:227], v[88:91]
    s_add_u32 s22, s22, s48
    v_exp_f32_e32 v221, v221
    v_mfma_f32_16x16x32_bf16 v[88:91], a[116:119], v[228:231], v[88:91]
    s_mov_b32 s18, 0x4000000
    ds_read_b128 a[60:63], v252 offset:13440
    v_cvt_pk_bf16_f32 v238, v220, v221
    v_mfma_f32_16x16x32_bf16 v[92:95], a[124:127], v[228:231], v[92:95]
    s_mov_b32 s48, 16777216
    v_exp_f32_e32 v222, v222
    v_mfma_f32_16x16x32_bf16 v[92:95], a[120:123], v[224:227], v[92:95]
    v_exp_f32_e32 v223, v223
    v_mfma_f32_16x16x32_bf16 v[208:211], a[0:3], v[128:131], v[192:195]
    ds_read_b128 a[56:59], v252 offset:13184
    v_cvt_pk_bf16_f32 v239, v222, v223
    v_mfma_f32_16x16x32_bf16 v[208:211], a[4:7], v[132:135], v[208:211]
    buffer_load_dwordx4 v254, s[12:15], s20 offen offset:2048 nt lds
    v_mfma_f32_16x16x32_bf16 v[208:211], a[8:11], v[136:139], v[208:211]
    s_mov_b32 m0, s89
    ds_read_b128 a[52:55], v252 offset:12928
    v_mfma_f32_16x16x32_bf16 v[208:211], a[12:15], v[140:143], v[208:211]
    ds_read_b128 a[48:51], v252 offset:12672
    v_mfma_f32_16x16x32_bf16 v[212:215], a[28:31], v[140:143], v[192:195]
    buffer_load_dwordx4 v254, s[12:15], s20 offen offset:3072 nt lds
    v_mfma_f32_16x16x32_bf16 v[212:215], a[24:27], v[136:139], v[212:215]
    s_xor_b32 s20, s20, 16384
    v_exp_f32_e32 v208, v208
    v_mfma_f32_16x16x32_bf16 v[212:215], a[20:23], v[132:135], v[212:215]
    s_waitcnt lgkmcnt(4)
    v_exp_f32_e32 v209, v209
    v_mfma_f32_16x16x32_bf16 v[212:215], a[16:19], v[128:131], v[212:215]
    s_mov_b32 m0, s67
    v_exp_f32_e32 v210, v210
    v_mfma_f32_16x16x32_bf16 v[216:219], a[32:35], v[128:131], v[192:195]
    v_exp_f32_e32 v211, v211
    v_mfma_f32_16x16x32_bf16 v[216:219], a[36:39], v[132:135], v[216:219]
    buffer_load_dwordx4 v254, s[8:11], s20 offen nt lds
    v_mfma_f32_16x16x32_bf16 v[216:219], a[40:43], v[136:139], v[216:219]
    v_exp_f32_e32 v212, v212
    v_mfma_f32_16x16x32_bf16 v[216:219], a[44:47], v[140:143], v[216:219]
    s_waitcnt lgkmcnt(3)
    v_exp_f32_e32 v213, v213
    v_mfma_f32_16x16x32_bf16 v[220:223], a[60:63], v[140:143], v[192:195]
    s_waitcnt lgkmcnt(2)
    v_exp_f32_e32 v214, v214
    v_mfma_f32_16x16x32_bf16 v[220:223], a[56:59], v[136:139], v[220:223]
    s_waitcnt lgkmcnt(1)
    v_exp_f32_e32 v215, v215
    v_mfma_f32_16x16x32_bf16 v[220:223], a[52:55], v[132:135], v[220:223]
    s_waitcnt lgkmcnt(0)
    ds_read_b64_tr_b16 a[76:77], v253 offset:8264
    v_cvt_pk_bf16_f32 v224, v208, v209
    v_mfma_f32_16x16x32_bf16 v[220:223], a[48:51], v[128:131], v[220:223]
    s_mov_b32 m0, s68
    ds_read_b64_tr_b16 a[78:79], v253 offset:12392
    v_cvt_pk_bf16_f32 v225, v210, v211
    v_smfmac_f32_16x16x64_bf16 a[204:207], a[208:211], v[232:239], v245
    v_cvt_pk_bf16_f32 v226, v212, v213
    v_mfma_f32_16x16x32_bf16 v[96:99], a[224:227], v[232:235], v[96:99]
    v_exp_f32_e32 v216, v216
    v_mfma_f32_16x16x32_bf16 v[96:99], a[228:231], v[236:239], v[96:99]
    ds_read_b32 v244, v255
    v_cvt_pk_bf16_f32 v227, v214, v215
    v_mfma_f32_16x16x32_bf16 v[100:103], a[236:239], v[236:239], v[100:103]
    v_exp_f32_e32 v217, v217
    v_mfma_f32_16x16x32_bf16 v[100:103], a[232:235], v[232:235], v[100:103]
    v_exp_f32_e32 v218, v218
    v_mfma_f32_16x16x32_bf16 v[104:107], a[240:243], v[232:235], v[104:107]
    v_exp_f32_e32 v219, v219
    v_mfma_f32_16x16x32_bf16 v[104:107], a[244:247], v[236:239], v[104:107]
    buffer_load_dwordx4 v254, s[8:11], s20 offen offset:1024 nt lds
    v_mfma_f32_16x16x32_bf16 v[108:111], a[252:255], v[236:239], v[108:111]
    s_mov_b32 m0, s69
    v_exp_f32_e32 v220, v220
    v_mfma_f32_16x16x32_bf16 v[108:111], a[248:251], v[232:235], v[108:111]
    v_exp_f32_e32 v221, v221
    v_mfma_f32_16x16x32_bf16 v[112:115], a[96:99], v[232:235], v[112:115]
    v_exp_f32_e32 v222, v222
    v_mfma_f32_16x16x32_bf16 v[112:115], a[100:103], v[236:239], v[112:115]
    s_waitcnt lgkmcnt(0)
    ds_read_b64_tr_b16 a[72:73], v253 offset:8
    v_cmp_gt_u32_e32 vcc, s44, v244
    v_mfma_f32_16x16x32_bf16 v[116:119], a[108:111], v[236:239], v[116:119]
    v_exp_f32_e32 v223, v223
    v_mfma_f32_16x16x32_bf16 v[116:119], a[104:107], v[232:235], v[116:119]
    s_cbranch_vccnz L_rt15
L_bk15:
    ds_read_b64_tr_b16 a[74:75], v253 offset:4136
    v_cvt_pk_bf16_f32 v228, v216, v217
    v_mfma_f32_16x16x32_bf16 v[120:123], a[112:115], v[232:235], v[120:123]
    ds_read_b64_tr_b16 a[80:81], v253 offset:256
    v_cvt_pk_bf16_f32 v229, v218, v219
    v_mfma_f32_16x16x32_bf16 v[120:123], a[116:119], v[236:239], v[120:123]
    ds_read_b64_tr_b16 a[82:83], v253 offset:4384
    v_cvt_pk_bf16_f32 v230, v220, v221
    v_mfma_f32_16x16x32_bf16 v[124:127], a[124:127], v[236:239], v[124:127]
    ds_read_b64_tr_b16 a[84:85], v253 offset:8512
    v_cvt_pk_bf16_f32 v231, v222, v223
    v_mfma_f32_16x16x32_bf16 v[124:127], a[120:123], v[232:235], v[124:127]
    buffer_load_dwordx4 v254, s[8:11], s20 offen offset:2048 nt lds
    v_mfma_f32_16x16x32_bf16 v[208:211], a[0:3], v[144:147], v[196:199]
    s_mov_b32 m0, s70
    ds_read_b64_tr_b16 a[86:87], v253 offset:12640
    v_mfma_f32_16x16x32_bf16 v[208:211], a[4:7], v[148:151], v[208:211]
    buffer_load_dwordx4 v254, s[8:11], s20 offen offset:3072 nt lds
    v_mfma_f32_16x16x32_bf16 v[208:211], a[8:11], v[152:155], v[208:211]
    ds_read_b64_tr_b16 a[92:93], v253 offset:8520
    v_mfma_f32_16x16x32_bf16 v[208:211], a[12:15], v[156:159], v[208:211]
    ds_read_b64_tr_b16 a[94:95], v253 offset:12648
    v_mfma_f32_16x16x32_bf16 v[212:215], a[28:31], v[156:159], v[196:199]
    ds_read_b64_tr_b16 a[88:89], v253 offset:264
    v_mfma_f32_16x16x32_bf16 v[212:215], a[24:27], v[152:155], v[212:215]
    v_exp_f32_e32 v208, v208
    v_mfma_f32_16x16x32_bf16 v[212:215], a[20:23], v[148:151], v[212:215]
    s_mov_b32 m0, s90
    v_exp_f32_e32 v209, v209
    v_mfma_f32_16x16x32_bf16 v[212:215], a[16:19], v[144:147], v[212:215]
    ds_read_b64_tr_b16 a[90:91], v253 offset:4392
    v_cvt_pk_bf16_f32 v232, v208, v209
    v_mfma_f32_16x16x32_bf16 v[216:219], a[32:35], v[144:147], v[196:199]
    v_exp_f32_e32 v210, v210
    v_mfma_f32_16x16x32_bf16 v[216:219], a[36:39], v[148:151], v[216:219]
    v_exp_f32_e32 v211, v211
    v_mfma_f32_16x16x32_bf16 v[216:219], a[40:43], v[152:155], v[216:219]
    ds_read_b64_tr_b16 a[96:97], v253 offset:512
    v_cvt_pk_bf16_f32 v233, v210, v211
    v_mfma_f32_16x16x32_bf16 v[216:219], a[44:47], v[156:159], v[216:219]
    buffer_load_dwordx4 v254, s[12:15], s20 offen nt lds
    v_mfma_f32_16x16x32_bf16 v[220:223], a[60:63], v[156:159], v[196:199]
    ds_read_b64_tr_b16 a[98:99], v253 offset:4640
    ds_read_b64_tr_b16 a[100:101], v253 offset:8768
    v_mfma_f32_16x16x32_bf16 v[220:223], a[56:59], v[152:155], v[220:223]
    ds_read_b64_tr_b16 a[102:103], v253 offset:12896
    ds_read_b64_tr_b16 a[108:109], v253 offset:8776
    v_mfma_f32_16x16x32_bf16 v[220:223], a[52:55], v[148:151], v[220:223]
    s_mov_b32 m0, s91
    ds_read_b64_tr_b16 a[110:111], v253 offset:12904
    ds_read_b64_tr_b16 a[104:105], v253 offset:520
    v_mfma_f32_16x16x32_bf16 v[220:223], a[48:51], v[144:147], v[220:223]
    ds_read_b64_tr_b16 a[106:107], v253 offset:4648
    ds_read_b64_tr_b16 a[112:113], v253 offset:768
    v_smfmac_f32_16x16x64_bf16 a[192:195], a[208:211], v[224:231], v245
    ds_read_b64_tr_b16 a[114:115], v253 offset:4896
    v_mfma_f32_16x16x32_bf16 v[0:3], a[64:67], v[224:227], v[0:3]
    ds_read_b64_tr_b16 a[116:117], v253 offset:9024
    ds_read_b64_tr_b16 a[118:119], v253 offset:13152
    v_mfma_f32_16x16x32_bf16 v[0:3], a[68:71], v[228:231], v[0:3]
    ds_read_b64_tr_b16 a[124:125], v253 offset:9032
    ds_read_b64_tr_b16 a[126:127], v253 offset:13160
    v_mfma_f32_16x16x32_bf16 v[4:7], a[76:79], v[228:231], v[4:7]
    s_waitcnt lgkmcnt(14)
    ds_read_b64_tr_b16 a[120:121], v253 offset:776
    ds_read_b64_tr_b16 a[122:123], v253 offset:4904
    v_mfma_f32_16x16x32_bf16 v[4:7], a[72:75], v[224:227], v[4:7]
    v_exp_f32_e32 v212, v212
    v_mfma_f32_16x16x32_bf16 v[8:11], a[80:83], v[224:227], v[8:11]
    v_exp_f32_e32 v213, v213
    v_mfma_f32_16x16x32_bf16 v[8:11], a[84:87], v[228:231], v[8:11]
    v_exp_f32_e32 v214, v214
    v_mfma_f32_16x16x32_bf16 v[12:15], a[92:95], v[228:231], v[12:15]
    v_exp_f32_e32 v215, v215
    v_mfma_f32_16x16x32_bf16 v[12:15], a[88:91], v[224:227], v[12:15]
    s_waitcnt lgkmcnt(13)
    v_exp_f32_e32 v216, v216
    v_mfma_f32_16x16x32_bf16 v[16:19], a[96:99], v[224:227], v[16:19]
    s_waitcnt lgkmcnt(11)
    v_exp_f32_e32 v217, v217
    v_mfma_f32_16x16x32_bf16 v[16:19], a[100:103], v[228:231], v[16:19]
    s_waitcnt lgkmcnt(9)
    v_exp_f32_e32 v218, v218
    v_mfma_f32_16x16x32_bf16 v[20:23], a[108:111], v[228:231], v[20:23]
    s_waitcnt lgkmcnt(7)
    v_exp_f32_e32 v219, v219
    v_mfma_f32_16x16x32_bf16 v[20:23], a[104:107], v[224:227], v[20:23]
    s_waitcnt lgkmcnt(6)
    ds_read_b64_tr_b16 a[224:225], v253 offset:16512
    v_cvt_pk_bf16_f32 v234, v212, v213
    v_mfma_f32_16x16x32_bf16 v[24:27], a[112:115], v[224:227], v[24:27]
    s_waitcnt lgkmcnt(5)
    ds_read_b64_tr_b16 a[226:227], v253 offset:20640
    v_cvt_pk_bf16_f32 v235, v214, v215
    v_mfma_f32_16x16x32_bf16 v[24:27], a[116:119], v[228:231], v[24:27]
    s_waitcnt lgkmcnt(4)
    buffer_load_dwordx4 v254, s[12:15], s20 offen offset:1024 nt lds
    v_mfma_f32_16x16x32_bf16 v[28:31], a[124:127], v[228:231], v[28:31]
    s_waitcnt lgkmcnt(2)
    v_exp_f32_e32 v220, v220
    v_mfma_f32_16x16x32_bf16 v[28:31], a[120:123], v[224:227], v[28:31]
    s_mov_b32 m0, s92
    v_exp_f32_e32 v221, v221
    v_mfma_f32_16x16x32_bf16 v[208:211], a[0:3], v[160:163], v[200:203]
    v_exp_f32_e32 v222, v222
    v_mfma_f32_16x16x32_bf16 v[208:211], a[4:7], v[164:167], v[208:211]
    v_exp_f32_e32 v223, v223
    v_mfma_f32_16x16x32_bf16 v[208:211], a[8:11], v[168:171], v[208:211]
    ds_read_b64_tr_b16 a[228:229], v253 offset:24768
    v_cvt_pk_bf16_f32 v236, v216, v217
    v_mfma_f32_16x16x32_bf16 v[208:211], a[12:15], v[172:175], v[208:211]
    ds_read_b64_tr_b16 a[230:231], v253 offset:28896
    v_cvt_pk_bf16_f32 v237, v218, v219
    v_mfma_f32_16x16x32_bf16 v[212:215], a[28:31], v[172:175], v[200:203]
    ds_read_b64_tr_b16 a[236:237], v253 offset:24776
    v_cvt_pk_bf16_f32 v238, v220, v221
    v_mfma_f32_16x16x32_bf16 v[212:215], a[24:27], v[168:171], v[212:215]
    ds_read_b64_tr_b16 a[238:239], v253 offset:28904
    v_cvt_pk_bf16_f32 v239, v222, v223
    v_mfma_f32_16x16x32_bf16 v[212:215], a[20:23], v[164:167], v[212:215]
    buffer_load_dwordx4 v254, s[12:15], s20 offen offset:2048 nt lds
    v_mfma_f32_16x16x32_bf16 v[212:215], a[16:19], v[160:163], v[212:215]
    s_mov_b32 m0, s93
    v_exp_f32_e32 v208, v208
    v_mfma_f32_16x16x32_bf16 v[216:219], a[32:35], v[160:163], v[200:203]
    buffer_load_dwordx4 v254, s[12:15], s20 offen offset:3072 nt lds
    v_mfma_f32_16x16x32_bf16 v[216:219], a[36:39], v[164:167], v[216:219]
    v_exp_f32_e32 v209, v209
    v_mfma_f32_16x16x32_bf16 v[216:219], a[40:43], v[168:171], v[216:219]
    v_exp_f32_e32 v210, v210
    v_mfma_f32_16x16x32_bf16 v[216:219], a[44:47], v[172:175], v[216:219]
    v_exp_f32_e32 v211, v211
    v_mfma_f32_16x16x32_bf16 v[220:223], a[60:63], v[172:175], v[200:203]
    v_exp_f32_e32 v212, v212
    v_mfma_f32_16x16x32_bf16 v[220:223], a[56:59], v[168:171], v[220:223]
    v_exp_f32_e32 v213, v213
    v_mfma_f32_16x16x32_bf16 v[220:223], a[52:55], v[164:167], v[220:223]
    v_exp_f32_e32 v214, v214
    v_mfma_f32_16x16x32_bf16 v[220:223], a[48:51], v[160:163], v[220:223]
    v_exp_f32_e32 v215, v215
    v_smfmac_f32_16x16x64_bf16 a[196:199], a[208:211], v[232:239], v245
    v_cvt_pk_bf16_f32 v224, v208, v209
    v_mfma_f32_16x16x32_bf16 v[32:35], a[64:67], v[232:235], v[32:35]
    ds_read_b64_tr_b16 a[232:233], v253 offset:16520
    v_cvt_pk_bf16_f32 v225, v210, v211
    v_mfma_f32_16x16x32_bf16 v[32:35], a[68:71], v[236:239], v[32:35]
    v_exp_f32_e32 v216, v216
    v_mfma_f32_16x16x32_bf16 v[36:39], a[76:79], v[236:239], v[36:39]
    v_exp_f32_e32 v217, v217
    v_mfma_f32_16x16x32_bf16 v[36:39], a[72:75], v[232:235], v[36:39]
    v_exp_f32_e32 v218, v218
    v_mfma_f32_16x16x32_bf16 v[40:43], a[80:83], v[232:235], v[40:43]
    v_exp_f32_e32 v219, v219
    v_mfma_f32_16x16x32_bf16 v[40:43], a[84:87], v[236:239], v[40:43]
    ds_read_b64_tr_b16 a[234:235], v253 offset:20648
    v_cvt_pk_bf16_f32 v226, v212, v213
    v_mfma_f32_16x16x32_bf16 v[44:47], a[92:95], v[236:239], v[44:47]
    ds_read_b64_tr_b16 a[240:241], v253 offset:16768
    v_cvt_pk_bf16_f32 v227, v214, v215
    v_mfma_f32_16x16x32_bf16 v[44:47], a[88:91], v[232:235], v[44:47]
    v_exp_f32_e32 v220, v220
    v_mfma_f32_16x16x32_bf16 v[48:51], a[96:99], v[232:235], v[48:51]
    v_exp_f32_e32 v221, v221
    v_mfma_f32_16x16x32_bf16 v[48:51], a[100:103], v[236:239], v[48:51]
    v_exp_f32_e32 v222, v222
    v_mfma_f32_16x16x32_bf16 v[52:55], a[108:111], v[236:239], v[52:55]
    v_exp_f32_e32 v223, v223
    v_mfma_f32_16x16x32_bf16 v[52:55], a[104:107], v[232:235], v[52:55]
    ds_read_b64_tr_b16 a[242:243], v253 offset:20896
    v_cvt_pk_bf16_f32 v228, v216, v217
    v_mfma_f32_16x16x32_bf16 v[56:59], a[112:115], v[232:235], v[56:59]
    ds_read_b64_tr_b16 a[244:245], v253 offset:25024
    v_cvt_pk_bf16_f32 v229, v218, v219
    v_mfma_f32_16x16x32_bf16 v[56:59], a[116:119], v[236:239], v[56:59]
    ds_read_b64_tr_b16 a[246:247], v253 offset:29152
    v_cvt_pk_bf16_f32 v230, v220, v221
    v_mfma_f32_16x16x32_bf16 v[60:63], a[124:127], v[236:239], v[60:63]
    ds_read_b64_tr_b16 a[252:253], v253 offset:25032
    v_cvt_pk_bf16_f32 v231, v222, v223
    v_mfma_f32_16x16x32_bf16 v[60:63], a[120:123], v[232:235], v[60:63]
    ds_read_b64_tr_b16 a[254:255], v253 offset:29160
    v_mfma_f32_16x16x32_bf16 v[208:211], a[0:3], v[176:179], v[204:207]
    ds_read_b128 a[0:3], v252 offset:16896
    v_mfma_f32_16x16x32_bf16 v[208:211], a[4:7], v[180:183], v[208:211]
    ds_read_b128 a[4:7], v252 offset:17152
    v_mfma_f32_16x16x32_bf16 v[208:211], a[8:11], v[184:187], v[208:211]
    ds_read_b128 a[8:11], v252 offset:17408
    v_mfma_f32_16x16x32_bf16 v[208:211], a[12:15], v[188:191], v[208:211]
    ds_read_b128 a[12:15], v252 offset:17664
    v_mfma_f32_16x16x32_bf16 v[212:215], a[28:31], v[188:191], v[204:207]
    ds_read_b128 a[28:31], v252 offset:21888
    v_mfma_f32_16x16x32_bf16 v[212:215], a[24:27], v[184:187], v[212:215]
    v_exp_f32_e32 v208, v208
    v_mfma_f32_16x16x32_bf16 v[212:215], a[20:23], v[180:183], v[212:215]
    v_exp_f32_e32 v209, v209
    v_mfma_f32_16x16x32_bf16 v[212:215], a[16:19], v[176:179], v[212:215]
    v_exp_f32_e32 v210, v210
    v_mfma_f32_16x16x32_bf16 v[216:219], a[32:35], v[176:179], v[204:207]
    v_exp_f32_e32 v211, v211
    v_mfma_f32_16x16x32_bf16 v[216:219], a[36:39], v[180:183], v[216:219]
    ds_read_b128 a[24:27], v252 offset:21632
    v_cvt_pk_bf16_f32 v232, v208, v209
    v_mfma_f32_16x16x32_bf16 v[216:219], a[40:43], v[184:187], v[216:219]
    ds_read_b128 a[20:23], v252 offset:21376
    v_cvt_pk_bf16_f32 v233, v210, v211
    v_mfma_f32_16x16x32_bf16 v[216:219], a[44:47], v[188:191], v[216:219]
    v_exp_f32_e32 v212, v212
    v_mfma_f32_16x16x32_bf16 v[220:223], a[60:63], v[188:191], v[204:207]
    v_exp_f32_e32 v213, v213
    v_mfma_f32_16x16x32_bf16 v[220:223], a[56:59], v[184:187], v[220:223]
    v_exp_f32_e32 v214, v214
    v_mfma_f32_16x16x32_bf16 v[220:223], a[52:55], v[180:183], v[220:223]
    v_exp_f32_e32 v215, v215
    v_mfma_f32_16x16x32_bf16 v[220:223], a[48:51], v[176:179], v[220:223]
    ds_read_b128 a[16:19], v252 offset:21120
    v_cvt_pk_bf16_f32 v234, v212, v213
    v_smfmac_f32_16x16x64_bf16 a[200:203], a[208:211], v[224:231], v245
    ds_read_b128 a[32:35], v252 offset:25344
    v_mfma_f32_16x16x32_bf16 v[64:67], a[64:67], v[224:227], v[64:67]
    ds_read_b128 a[36:39], v252 offset:25600
    v_cvt_pk_bf16_f32 v235, v214, v215
    v_mfma_f32_16x16x32_bf16 v[64:67], a[68:71], v[228:231], v[64:67]
    v_exp_f32_e32 v216, v216
    v_mfma_f32_16x16x32_bf16 v[68:71], a[76:79], v[228:231], v[68:71]
    v_exp_f32_e32 v217, v217
    v_mfma_f32_16x16x32_bf16 v[68:71], a[72:75], v[224:227], v[68:71]
    ds_read_b128 a[40:43], v252 offset:25856
    v_cvt_pk_bf16_f32 v236, v216, v217
    v_mfma_f32_16x16x32_bf16 v[72:75], a[80:83], v[224:227], v[72:75]
    v_exp_f32_e32 v218, v218
    v_mfma_f32_16x16x32_bf16 v[72:75], a[84:87], v[228:231], v[72:75]
    v_exp_f32_e32 v219, v219
    v_mfma_f32_16x16x32_bf16 v[76:79], a[92:95], v[228:231], v[76:79]
    ds_read_b128 a[44:47], v252 offset:26112
    v_cvt_pk_bf16_f32 v237, v218, v219
    v_mfma_f32_16x16x32_bf16 v[76:79], a[88:91], v[224:227], v[76:79]
    v_exp_f32_e32 v220, v220
    v_mfma_f32_16x16x32_bf16 v[80:83], a[96:99], v[224:227], v[80:83]
    v_exp_f32_e32 v221, v221
    v_mfma_f32_16x16x32_bf16 v[80:83], a[100:103], v[228:231], v[80:83]
    ds_read_b128 a[60:63], v252 offset:30336
    v_cvt_pk_bf16_f32 v238, v220, v221
    v_mfma_f32_16x16x32_bf16 v[84:87], a[108:111], v[228:231], v[84:87]
    v_exp_f32_e32 v222, v222
    v_mfma_f32_16x16x32_bf16 v[84:87], a[104:107], v[224:227], v[84:87]
    v_exp_f32_e32 v223, v223
    v_mfma_f32_16x16x32_bf16 v[88:91], a[112:115], v[224:227], v[88:91]
    ds_read_b128 a[56:59], v252 offset:30080
    v_cvt_pk_bf16_f32 v239, v222, v223
    v_mfma_f32_16x16x32_bf16 v[88:91], a[116:119], v[228:231], v[88:91]
    ds_read_b128 a[52:55], v252 offset:29824
    v_mfma_f32_16x16x32_bf16 v[92:95], a[124:127], v[228:231], v[92:95]
    ds_read_b128 a[48:51], v252 offset:29568
    v_mfma_f32_16x16x32_bf16 v[92:95], a[120:123], v[224:227], v[92:95]
    s_waitcnt lgkmcnt(6)
    ds_read_b64_tr_b16 a[248:249], v253 offset:16776
    v_mfma_f32_16x16x32_bf16 v[208:211], a[0:3], v[128:131], v[192:195]
    ds_read_b64_tr_b16 a[250:251], v253 offset:20904
    v_mfma_f32_16x16x32_bf16 v[208:211], a[4:7], v[132:135], v[208:211]
    v_mfma_f32_16x16x32_bf16 v[208:211], a[8:11], v[136:139], v[208:211]
    v_mfma_f32_16x16x32_bf16 v[208:211], a[12:15], v[140:143], v[208:211]
    v_mfma_f32_16x16x32_bf16 v[212:215], a[28:31], v[140:143], v[192:195]
    v_mfma_f32_16x16x32_bf16 v[212:215], a[24:27], v[136:139], v[212:215]
    v_exp_f32_e32 v208, v208
    v_mfma_f32_16x16x32_bf16 v[212:215], a[20:23], v[132:135], v[212:215]
    v_exp_f32_e32 v209, v209
    v_mfma_f32_16x16x32_bf16 v[212:215], a[16:19], v[128:131], v[212:215]
    v_exp_f32_e32 v210, v210
    v_mfma_f32_16x16x32_bf16 v[216:219], a[32:35], v[128:131], v[192:195]
    v_exp_f32_e32 v211, v211
    v_mfma_f32_16x16x32_bf16 v[216:219], a[36:39], v[132:135], v[216:219]
    s_waitcnt lgkmcnt(4)
    v_exp_f32_e32 v212, v212
    v_mfma_f32_16x16x32_bf16 v[216:219], a[40:43], v[136:139], v[216:219]
    v_exp_f32_e32 v213, v213
    v_mfma_f32_16x16x32_bf16 v[216:219], a[44:47], v[140:143], v[216:219]
    v_exp_f32_e32 v214, v214
    v_mfma_f32_16x16x32_bf16 v[220:223], a[60:63], v[140:143], v[192:195]
    v_exp_f32_e32 v215, v215
    v_mfma_f32_16x16x32_bf16 v[220:223], a[56:59], v[136:139], v[220:223]
    s_waitcnt lgkmcnt(0)
    v_cvt_pk_bf16_f32 v224, v208, v209
    v_cvt_pk_bf16_f32 v225, v210, v211
    v_mfma_f32_16x16x32_bf16 v[220:223], a[52:55], v[132:135], v[220:223]
    v_exp_f32_e32 v216, v216
    v_mfma_f32_16x16x32_bf16 v[220:223], a[48:51], v[128:131], v[220:223]
    v_exp_f32_e32 v217, v217
    v_smfmac_f32_16x16x64_bf16 a[204:207], a[208:211], v[232:239], v245
    v_cvt_pk_bf16_f32 v226, v212, v213
    v_mfma_f32_16x16x32_bf16 v[96:99], a[64:67], v[232:235], v[96:99]
    v_exp_f32_e32 v218, v218
    v_mfma_f32_16x16x32_bf16 v[96:99], a[68:71], v[236:239], v[96:99]
    v_exp_f32_e32 v219, v219
    v_mfma_f32_16x16x32_bf16 v[100:103], a[76:79], v[236:239], v[100:103]
    v_cvt_pk_bf16_f32 v227, v214, v215
    v_cvt_pk_bf16_f32 v228, v216, v217
    v_mfma_f32_16x16x32_bf16 v[100:103], a[72:75], v[232:235], v[100:103]
    v_exp_f32_e32 v220, v220
    v_mfma_f32_16x16x32_bf16 v[104:107], a[80:83], v[232:235], v[104:107]
    v_exp_f32_e32 v221, v221
    v_mfma_f32_16x16x32_bf16 v[104:107], a[84:87], v[236:239], v[104:107]
    v_exp_f32_e32 v222, v222
    v_mfma_f32_16x16x32_bf16 v[108:111], a[92:95], v[236:239], v[108:111]
    v_exp_f32_e32 v223, v223
    v_mfma_f32_16x16x32_bf16 v[108:111], a[88:91], v[232:235], v[108:111]
    v_cvt_pk_bf16_f32 v229, v218, v219
    v_cvt_pk_bf16_f32 v230, v220, v221
    v_mfma_f32_16x16x32_bf16 v[112:115], a[96:99], v[232:235], v[112:115]
    ds_read_b64_tr_b16 a[96:97], v253 offset:17024
    v_cvt_pk_bf16_f32 v231, v222, v223
    v_mfma_f32_16x16x32_bf16 v[112:115], a[100:103], v[236:239], v[112:115]
    ds_read_b64_tr_b16 a[98:99], v253 offset:21152
    v_mfma_f32_16x16x32_bf16 v[116:119], a[108:111], v[236:239], v[116:119]
    ds_read_b64_tr_b16 a[100:101], v253 offset:25280
    v_mfma_f32_16x16x32_bf16 v[116:119], a[104:107], v[232:235], v[116:119]
    ds_read_b64_tr_b16 a[102:103], v253 offset:29408
    v_mfma_f32_16x16x32_bf16 v[120:123], a[112:115], v[232:235], v[120:123]
    ds_read_b64_tr_b16 a[108:109], v253 offset:25288
    v_mfma_f32_16x16x32_bf16 v[120:123], a[116:119], v[236:239], v[120:123]
    ds_read_b64_tr_b16 a[110:111], v253 offset:29416
    v_mfma_f32_16x16x32_bf16 v[124:127], a[124:127], v[236:239], v[124:127]
    ds_read_b64_tr_b16 a[104:105], v253 offset:17032
    v_mfma_f32_16x16x32_bf16 v[124:127], a[120:123], v[232:235], v[124:127]
    ds_read_b64_tr_b16 a[106:107], v253 offset:21160
    v_mfma_f32_16x16x32_bf16 v[208:211], a[0:3], v[144:147], v[196:199]
    s_add_u32 s44, s44, 1
    ds_read_b64_tr_b16 a[112:113], v253 offset:17280
    v_mfma_f32_16x16x32_bf16 v[208:211], a[4:7], v[148:151], v[208:211]
    ds_read_b64_tr_b16 a[114:115], v253 offset:21408
    v_mfma_f32_16x16x32_bf16 v[208:211], a[8:11], v[152:155], v[208:211]
    ds_read_b64_tr_b16 a[116:117], v253 offset:25536
    v_mfma_f32_16x16x32_bf16 v[208:211], a[12:15], v[156:159], v[208:211]
    ds_read_b64_tr_b16 a[118:119], v253 offset:29664
    v_mfma_f32_16x16x32_bf16 v[212:215], a[28:31], v[156:159], v[196:199]
    ds_read_b64_tr_b16 a[124:125], v253 offset:25544
    v_mfma_f32_16x16x32_bf16 v[212:215], a[24:27], v[152:155], v[212:215]
    v_exp_f32_e32 v208, v208
    v_mfma_f32_16x16x32_bf16 v[212:215], a[20:23], v[148:151], v[212:215]
    v_exp_f32_e32 v209, v209
    v_mfma_f32_16x16x32_bf16 v[212:215], a[16:19], v[144:147], v[212:215]
    ds_read_b64_tr_b16 a[126:127], v253 offset:29672
    v_cvt_pk_bf16_f32 v232, v208, v209
    v_mfma_f32_16x16x32_bf16 v[216:219], a[32:35], v[144:147], v[196:199]
    ds_read_b64_tr_b16 a[120:121], v253 offset:17288
    v_mov_b32_e32 v244, s44
    v_mfma_f32_16x16x32_bf16 v[216:219], a[36:39], v[148:151], v[216:219]
    v_exp_f32_e32 v210, v210
    v_mfma_f32_16x16x32_bf16 v[216:219], a[40:43], v[152:155], v[216:219]
    v_exp_f32_e32 v211, v211
    v_mfma_f32_16x16x32_bf16 v[216:219], a[44:47], v[156:159], v[216:219]
    ds_read_b64_tr_b16 a[122:123], v253 offset:21416
    v_cvt_pk_bf16_f32 v233, v210, v211
    v_mfma_f32_16x16x32_bf16 v[220:223], a[60:63], v[156:159], v[196:199]
    v_exp_f32_e32 v212, v212
    v_mfma_f32_16x16x32_bf16 v[220:223], a[56:59], v[152:155], v[220:223]
    s_waitcnt vmcnt(8)
    v_exp_f32_e32 v213, v213
    v_mfma_f32_16x16x32_bf16 v[220:223], a[52:55], v[148:151], v[220:223]
    s_mov_b32 m0, s45
    v_exp_f32_e32 v214, v214
    v_mfma_f32_16x16x32_bf16 v[220:223], a[48:51], v[144:147], v[220:223]
    v_exp_f32_e32 v215, v215
    v_smfmac_f32_16x16x64_bf16 a[192:195], a[208:211], v[224:231], v245
    ds_write_addtid_b32 v244
    v_mfma_f32_16x16x32_bf16 v[0:3], a[224:227], v[224:227], v[0:3]
    v_exp_f32_e32 v216, v216
    v_mfma_f32_16x16x32_bf16 v[0:3], a[228:231], v[228:231], v[0:3]
    v_exp_f32_e32 v217, v217
    v_mfma_f32_16x16x32_bf16 v[4:7], a[236:239], v[228:231], v[4:7]
    v_exp_f32_e32 v218, v218
    v_mfma_f32_16x16x32_bf16 v[4:7], a[232:235], v[224:227], v[4:7]
    v_exp_f32_e32 v219, v219
    v_mfma_f32_16x16x32_bf16 v[8:11], a[240:243], v[224:227], v[8:11]
    v_cvt_pk_bf16_f32 v234, v212, v213
    v_cvt_pk_bf16_f32 v235, v214, v215
    v_mfma_f32_16x16x32_bf16 v[8:11], a[244:247], v[228:231], v[8:11]
    v_exp_f32_e32 v220, v220
    v_mfma_f32_16x16x32_bf16 v[12:15], a[252:255], v[228:231], v[12:15]
    v_exp_f32_e32 v221, v221
    v_mfma_f32_16x16x32_bf16 v[12:15], a[248:251], v[224:227], v[12:15]
    s_waitcnt lgkmcnt(1)
    v_exp_f32_e32 v222, v222
    v_mfma_f32_16x16x32_bf16 v[16:19], a[96:99], v[224:227], v[16:19]
    v_exp_f32_e32 v223, v223
    v_mfma_f32_16x16x32_bf16 v[16:19], a[100:103], v[228:231], v[16:19]
    v_cvt_pk_bf16_f32 v236, v216, v217
    v_cvt_pk_bf16_f32 v237, v218, v219
    v_mfma_f32_16x16x32_bf16 v[20:23], a[108:111], v[228:231], v[20:23]
    v_cvt_pk_bf16_f32 v238, v220, v221
    v_cvt_pk_bf16_f32 v239, v222, v223
    v_mfma_f32_16x16x32_bf16 v[20:23], a[104:107], v[224:227], v[20:23]
    v_mfma_f32_16x16x32_bf16 v[24:27], a[112:115], v[224:227], v[24:27]
    v_mfma_f32_16x16x32_bf16 v[24:27], a[116:119], v[228:231], v[24:27]
    v_mfma_f32_16x16x32_bf16 v[28:31], a[124:127], v[228:231], v[28:31]
    v_mfma_f32_16x16x32_bf16 v[28:31], a[120:123], v[224:227], v[28:31]
    v_mfma_f32_16x16x32_bf16 v[208:211], a[0:3], v[160:163], v[200:203]
    v_mfma_f32_16x16x32_bf16 v[208:211], a[4:7], v[164:167], v[208:211]
    v_mfma_f32_16x16x32_bf16 v[208:211], a[8:11], v[168:171], v[208:211]
    v_mfma_f32_16x16x32_bf16 v[208:211], a[12:15], v[172:175], v[208:211]
    v_mfma_f32_16x16x32_bf16 v[212:215], a[28:31], v[172:175], v[200:203]
    v_mfma_f32_16x16x32_bf16 v[212:215], a[24:27], v[168:171], v[212:215]
    v_exp_f32_e32 v208, v208
    v_mfma_f32_16x16x32_bf16 v[212:215], a[20:23], v[164:167], v[212:215]
    v_exp_f32_e32 v209, v209
    v_mfma_f32_16x16x32_bf16 v[212:215], a[16:19], v[160:163], v[212:215]
    v_exp_f32_e32 v210, v210
    v_mfma_f32_16x16x32_bf16 v[216:219], a[32:35], v[160:163], v[200:203]
    v_exp_f32_e32 v211, v211
    v_mfma_f32_16x16x32_bf16 v[216:219], a[36:39], v[164:167], v[216:219]
    v_exp_f32_e32 v212, v212
    v_mfma_f32_16x16x32_bf16 v[216:219], a[40:43], v[168:171], v[216:219]
    v_exp_f32_e32 v213, v213
    v_mfma_f32_16x16x32_bf16 v[216:219], a[44:47], v[172:175], v[216:219]
    v_exp_f32_e32 v214, v214
    v_mfma_f32_16x16x32_bf16 v[220:223], a[60:63], v[172:175], v[200:203]
    v_exp_f32_e32 v215, v215
    v_mfma_f32_16x16x32_bf16 v[220:223], a[56:59], v[168:171], v[220:223]
    v_cvt_pk_bf16_f32 v224, v208, v209
    v_cvt_pk_bf16_f32 v225, v210, v211
    v_mfma_f32_16x16x32_bf16 v[220:223], a[52:55], v[164:167], v[220:223]
    v_exp_f32_e32 v216, v216
    v_mfma_f32_16x16x32_bf16 v[220:223], a[48:51], v[160:163], v[220:223]
    v_exp_f32_e32 v217, v217
    v_smfmac_f32_16x16x64_bf16 a[196:199], a[208:211], v[232:239], v245
    v_cvt_pk_bf16_f32 v226, v212, v213
    v_mfma_f32_16x16x32_bf16 v[32:35], a[224:227], v[232:235], v[32:35]
    v_exp_f32_e32 v218, v218
    v_mfma_f32_16x16x32_bf16 v[32:35], a[228:231], v[236:239], v[32:35]
    ds_read_b32 v244, v255
    v_cvt_pk_bf16_f32 v227, v214, v215
    v_mfma_f32_16x16x32_bf16 v[36:39], a[236:239], v[236:239], v[36:39]
    v_exp_f32_e32 v219, v219
    v_mfma_f32_16x16x32_bf16 v[36:39], a[232:235], v[232:235], v[36:39]
    v_exp_f32_e32 v220, v220
    v_mfma_f32_16x16x32_bf16 v[40:43], a[240:243], v[232:235], v[40:43]
    v_exp_f32_e32 v221, v221
    v_mfma_f32_16x16x32_bf16 v[40:43], a[244:247], v[236:239], v[40:43]
    v_exp_f32_e32 v222, v222
    v_mfma_f32_16x16x32_bf16 v[44:47], a[252:255], v[236:239], v[44:47]
    v_exp_f32_e32 v223, v223
    v_mfma_f32_16x16x32_bf16 v[44:47], a[248:251], v[232:235], v[44:47]
    v_cvt_pk_bf16_f32 v228, v216, v217
    v_cvt_pk_bf16_f32 v229, v218, v219
    v_mfma_f32_16x16x32_bf16 v[48:51], a[96:99], v[232:235], v[48:51]
    v_accvgpr_write_b32 a218, v251
    v_cmp_ngt_f32_e64 s[30:31], s26, v251
    v_mfma_f32_16x16x32_bf16 v[48:51], a[100:103], v[236:239], v[48:51]
    s_waitcnt lgkmcnt(0)
    v_cmp_gt_u32_e32 vcc, s44, v244
    v_cvt_pk_bf16_f32 v230, v220, v221
    v_mfma_f32_16x16x32_bf16 v[52:55], a[108:111], v[236:239], v[52:55]
    s_or_b64 s[28:29], s[28:29], s[30:31]
    v_cvt_pk_bf16_f32 v231, v222, v223
    v_mfma_f32_16x16x32_bf16 v[52:55], a[104:107], v[232:235], v[52:55]
    s_cbranch_vccnz L_rt16
L_bk16:
    ds_read_b64_tr_b16 a[64:65], v253 offset:33024
    v_mfma_f32_16x16x32_bf16 v[56:59], a[112:115], v[232:235], v[56:59]
    ds_read_b64_tr_b16 a[66:67], v253 offset:37152
    v_mfma_f32_16x16x32_bf16 v[56:59], a[116:119], v[236:239], v[56:59]
    ds_read_b64_tr_b16 a[68:69], v253 offset:41280
    v_mfma_f32_16x16x32_bf16 v[60:63], a[124:127], v[236:239], v[60:63]
    ds_read_b64_tr_b16 a[70:71], v253 offset:45408
    v_mfma_f32_16x16x32_bf16 v[60:63], a[120:123], v[232:235], v[60:63]
    ds_read_b64_tr_b16 a[76:77], v253 offset:41288
    v_mfma_f32_16x16x32_bf16 v[208:211], a[0:3], v[176:179], v[204:207]
    ds_read_b128 a[0:3], v252 offset:33792
    v_mfma_f32_16x16x32_bf16 v[208:211], a[4:7], v[180:183], v[208:211]
    ds_read_b128 a[4:7], v252 offset:34048
    v_mfma_f32_16x16x32_bf16 v[208:211], a[8:11], v[184:187], v[208:211]
    ds_read_b128 a[8:11], v252 offset:34304
    v_mfma_f32_16x16x32_bf16 v[208:211], a[12:15], v[188:191], v[208:211]
    ds_read_b128 a[12:15], v252 offset:34560
    v_mfma_f32_16x16x32_bf16 v[212:215], a[28:31], v[188:191], v[204:207]
    ds_read_b128 a[28:31], v252 offset:38784
    v_mfma_f32_16x16x32_bf16 v[212:215], a[24:27], v[184:187], v[212:215]
    v_exp_f32_e32 v208, v208
    v_mfma_f32_16x16x32_bf16 v[212:215], a[20:23], v[180:183], v[212:215]
    v_exp_f32_e32 v209, v209
    v_mfma_f32_16x16x32_bf16 v[212:215], a[16:19], v[176:179], v[212:215]
    v_exp_f32_e32 v210, v210
    v_mfma_f32_16x16x32_bf16 v[216:219], a[32:35], v[176:179], v[204:207]
    v_exp_f32_e32 v211, v211
    v_mfma_f32_16x16x32_bf16 v[216:219], a[36:39], v[180:183], v[216:219]
    ds_read_b128 a[24:27], v252 offset:38528
    v_cvt_pk_bf16_f32 v232, v208, v209
    v_mfma_f32_16x16x32_bf16 v[216:219], a[40:43], v[184:187], v[216:219]
    ds_read_b128 a[20:23], v252 offset:38272
    v_cvt_pk_bf16_f32 v233, v210, v211
    v_mfma_f32_16x16x32_bf16 v[216:219], a[44:47], v[188:191], v[216:219]
    v_exp_f32_e32 v212, v212
    v_mfma_f32_16x16x32_bf16 v[220:223], a[60:63], v[188:191], v[204:207]
    v_exp_f32_e32 v213, v213
    v_mfma_f32_16x16x32_bf16 v[220:223], a[56:59], v[184:187], v[220:223]
    v_exp_f32_e32 v214, v214
    v_mfma_f32_16x16x32_bf16 v[220:223], a[52:55], v[180:183], v[220:223]
    v_exp_f32_e32 v215, v215
    v_mfma_f32_16x16x32_bf16 v[220:223], a[48:51], v[176:179], v[220:223]
    ds_read_b128 a[16:19], v252 offset:38016
    v_cvt_pk_bf16_f32 v234, v212, v213
    v_smfmac_f32_16x16x64_bf16 a[200:203], a[208:211], v[224:231], v245
    ds_read_b128 a[32:35], v252 offset:42240
    v_mfma_f32_16x16x32_bf16 v[64:67], a[224:227], v[224:227], v[64:67]
    ds_read_b128 a[36:39], v252 offset:42496
    v_cvt_pk_bf16_f32 v235, v214, v215
    v_mfma_f32_16x16x32_bf16 v[64:67], a[228:231], v[228:231], v[64:67]
    v_exp_f32_e32 v216, v216
    v_mfma_f32_16x16x32_bf16 v[68:71], a[236:239], v[228:231], v[68:71]
    v_exp_f32_e32 v217, v217
    v_mfma_f32_16x16x32_bf16 v[68:71], a[232:235], v[224:227], v[68:71]
    ds_read_b128 a[40:43], v252 offset:42752
    v_cvt_pk_bf16_f32 v236, v216, v217
    v_mfma_f32_16x16x32_bf16 v[72:75], a[240:243], v[224:227], v[72:75]
    v_exp_f32_e32 v218, v218
    v_mfma_f32_16x16x32_bf16 v[72:75], a[244:247], v[228:231], v[72:75]
    v_exp_f32_e32 v219, v219
    v_mfma_f32_16x16x32_bf16 v[76:79], a[252:255], v[228:231], v[76:79]
    ds_read_b128 a[44:47], v252 offset:43008
    v_cvt_pk_bf16_f32 v237, v218, v219
    v_mfma_f32_16x16x32_bf16 v[76:79], a[248:251], v[224:227], v[76:79]
    v_exp_f32_e32 v220, v220
    v_mfma_f32_16x16x32_bf16 v[80:83], a[96:99], v[224:227], v[80:83]
    v_exp_f32_e32 v221, v221
    v_mfma_f32_16x16x32_bf16 v[80:83], a[100:103], v[228:231], v[80:83]
    ds_read_b128 a[60:63], v252 offset:47232
    v_cvt_pk_bf16_f32 v238, v220, v221
    v_mfma_f32_16x16x32_bf16 v[84:87], a[108:111], v[228:231], v[84:87]
    v_exp_f32_e32 v222, v222
    v_mfma_f32_16x16x32_bf16 v[84:87], a[104:107], v[224:227], v[84:87]
    v_exp_f32_e32 v223, v223
    v_mfma_f32_16x16x32_bf16 v[88:91], a[112:115], v[224:227], v[88:91]
    ds_read_b128 a[56:59], v252 offset:46976
    v_cvt_pk_bf16_f32 v239, v222, v223
    v_mfma_f32_16x16x32_bf16 v[88:91], a[116:119], v[228:231], v[88:91]
    ds_read_b128 a[52:55], v252 offset:46720
    v_mfma_f32_16x16x32_bf16 v[92:95], a[124:127], v[228:231], v[92:95]
    ds_read_b128 a[48:51], v252 offset:46464
    v_mfma_f32_16x16x32_bf16 v[92:95], a[120:123], v[224:227], v[92:95]
    s_waitcnt lgkmcnt(6)
    ds_read_b64_tr_b16 a[78:79], v253 offset:45416
    v_mfma_f32_16x16x32_bf16 v[208:211], a[0:3], v[128:131], v[192:195]
    s_add_u32 s44, s44, 1
    ds_read_b64_tr_b16 a[72:73], v253 offset:33032
    v_mfma_f32_16x16x32_bf16 v[208:211], a[4:7], v[132:135], v[208:211]
    ds_read_b64_tr_b16 a[74:75], v253 offset:37160
    v_mfma_f32_16x16x32_bf16 v[208:211], a[8:11], v[136:139], v[208:211]
    ds_read_b64_tr_b16 a[80:81], v253 offset:33280
    v_mfma_f32_16x16x32_bf16 v[208:211], a[12:15], v[140:143], v[208:211]
    ds_read_b64_tr_b16 a[82:83], v253 offset:37408
    v_mfma_f32_16x16x32_bf16 v[212:215], a[28:31], v[140:143], v[192:195]
    ds_read_b64_tr_b16 a[84:85], v253 offset:41536
    v_mfma_f32_16x16x32_bf16 v[212:215], a[24:27], v[136:139], v[212:215]
    v_exp_f32_e32 v208, v208
    v_mfma_f32_16x16x32_bf16 v[212:215], a[20:23], v[132:135], v[212:215]
    v_exp_f32_e32 v209, v209
    v_mfma_f32_16x16x32_bf16 v[212:215], a[16:19], v[128:131], v[212:215]
    v_exp_f32_e32 v210, v210
    v_mfma_f32_16x16x32_bf16 v[216:219], a[32:35], v[128:131], v[192:195]
    ds_read_b64_tr_b16 a[86:87], v253 offset:45664
    v_mov_b32_e32 v244, s44
    v_mfma_f32_16x16x32_bf16 v[216:219], a[36:39], v[132:135], v[216:219]
    s_waitcnt lgkmcnt(9)
    v_exp_f32_e32 v211, v211
    v_mfma_f32_16x16x32_bf16 v[216:219], a[40:43], v[136:139], v[216:219]
    v_exp_f32_e32 v212, v212
    v_mfma_f32_16x16x32_bf16 v[216:219], a[44:47], v[140:143], v[216:219]
    v_exp_f32_e32 v213, v213
    v_mfma_f32_16x16x32_bf16 v[220:223], a[60:63], v[140:143], v[192:195]
    v_exp_f32_e32 v214, v214
    v_mfma_f32_16x16x32_bf16 v[220:223], a[56:59], v[136:139], v[220:223]
    s_waitcnt lgkmcnt(5)
    v_exp_f32_e32 v215, v215
    v_mfma_f32_16x16x32_bf16 v[220:223], a[52:55], v[132:135], v[220:223]
    s_waitcnt vmcnt(4)
    ds_read_b64_tr_b16 a[92:93], v253 offset:41544
    v_cvt_pk_bf16_f32 v224, v208, v209
    v_mfma_f32_16x16x32_bf16 v[220:223], a[48:51], v[128:131], v[220:223]
    s_mov_b32 m0, s45
    ds_read_b64_tr_b16 a[94:95], v253 offset:45672
    v_cvt_pk_bf16_f32 v225, v210, v211
    v_smfmac_f32_16x16x64_bf16 a[204:207], a[208:211], v[232:239], v245
    ds_write_addtid_b32 v244
    v_mfma_f32_16x16x32_bf16 v[96:99], a[224:227], v[232:235], v[96:99]
    v_exp_f32_e32 v216, v216
    v_mfma_f32_16x16x32_bf16 v[96:99], a[228:231], v[236:239], v[96:99]
    v_exp_f32_e32 v217, v217
    v_mfma_f32_16x16x32_bf16 v[100:103], a[236:239], v[236:239], v[100:103]
    v_exp_f32_e32 v218, v218
    v_mfma_f32_16x16x32_bf16 v[100:103], a[232:235], v[232:235], v[100:103]
    v_exp_f32_e32 v219, v219
    v_mfma_f32_16x16x32_bf16 v[104:107], a[240:243], v[232:235], v[104:107]
    ds_read_b64_tr_b16 a[88:89], v253 offset:33288
    v_cvt_pk_bf16_f32 v226, v212, v213
    v_mfma_f32_16x16x32_bf16 v[104:107], a[244:247], v[236:239], v[104:107]
    ds_read_b64_tr_b16 a[90:91], v253 offset:37416
    v_cvt_pk_bf16_f32 v227, v214, v215
    v_mfma_f32_16x16x32_bf16 v[108:111], a[252:255], v[236:239], v[108:111]
    v_exp_f32_e32 v220, v220
    v_mfma_f32_16x16x32_bf16 v[108:111], a[248:251], v[232:235], v[108:111]
    v_exp_f32_e32 v221, v221
    v_mfma_f32_16x16x32_bf16 v[112:115], a[96:99], v[232:235], v[112:115]
    v_exp_f32_e32 v222, v222
    v_mfma_f32_16x16x32_bf16 v[112:115], a[100:103], v[236:239], v[112:115]
    v_exp_f32_e32 v223, v223
    v_mfma_f32_16x16x32_bf16 v[116:119], a[108:111], v[236:239], v[116:119]
    ds_read_b64_tr_b16 a[96:97], v253 offset:33536
    v_cvt_pk_bf16_f32 v228, v216, v217
    v_mfma_f32_16x16x32_bf16 v[116:119], a[104:107], v[232:235], v[116:119]
    ds_read_b64_tr_b16 a[98:99], v253 offset:37664
    v_cvt_pk_bf16_f32 v229, v218, v219
    v_mfma_f32_16x16x32_bf16 v[120:123], a[112:115], v[232:235], v[120:123]
    ds_read_b64_tr_b16 a[100:101], v253 offset:41792
    v_cvt_pk_bf16_f32 v230, v220, v221
    v_mfma_f32_16x16x32_bf16 v[120:123], a[116:119], v[236:239], v[120:123]
    ds_read_b64_tr_b16 a[102:103], v253 offset:45920
    v_cvt_pk_bf16_f32 v231, v222, v223
    v_mfma_f32_16x16x32_bf16 v[124:127], a[124:127], v[236:239], v[124:127]
    ds_read_b64_tr_b16 a[108:109], v253 offset:41800
    v_mfma_f32_16x16x32_bf16 v[124:127], a[120:123], v[232:235], v[124:127]
    ds_read_b64_tr_b16 a[110:111], v253 offset:45928
    v_mfma_f32_16x16x32_bf16 v[208:211], a[0:3], v[144:147], v[196:199]
    ds_read_b64_tr_b16 a[104:105], v253 offset:33544
    v_mfma_f32_16x16x32_bf16 v[208:211], a[4:7], v[148:151], v[208:211]
    ds_read_b64_tr_b16 a[106:107], v253 offset:37672
    v_mfma_f32_16x16x32_bf16 v[208:211], a[8:11], v[152:155], v[208:211]
    ds_read_b64_tr_b16 a[112:113], v253 offset:33792
    v_mfma_f32_16x16x32_bf16 v[208:211], a[12:15], v[156:159], v[208:211]
    ds_read_b64_tr_b16 a[114:115], v253 offset:37920
    v_mfma_f32_16x16x32_bf16 v[212:215], a[28:31], v[156:159], v[196:199]
    ds_read_b64_tr_b16 a[116:117], v253 offset:42048
    v_mfma_f32_16x16x32_bf16 v[212:215], a[24:27], v[152:155], v[212:215]
    v_exp_f32_e32 v208, v208
    v_mfma_f32_16x16x32_bf16 v[212:215], a[20:23], v[148:151], v[212:215]
    v_exp_f32_e32 v209, v209
    v_mfma_f32_16x16x32_bf16 v[212:215], a[16:19], v[144:147], v[212:215]
    ds_read_b64_tr_b16 a[118:119], v253 offset:46176
    v_cvt_pk_bf16_f32 v232, v208, v209
    v_mfma_f32_16x16x32_bf16 v[216:219], a[32:35], v[144:147], v[196:199]
    v_exp_f32_e32 v210, v210
    v_mfma_f32_16x16x32_bf16 v[216:219], a[36:39], v[148:151], v[216:219]
    v_exp_f32_e32 v211, v211
    v_mfma_f32_16x16x32_bf16 v[216:219], a[40:43], v[152:155], v[216:219]
    ds_read_b64_tr_b16 a[124:125], v253 offset:42056
    v_cvt_pk_bf16_f32 v233, v210, v211
    v_mfma_f32_16x16x32_bf16 v[216:219], a[44:47], v[156:159], v[216:219]
    v_exp_f32_e32 v212, v212
    v_mfma_f32_16x16x32_bf16 v[220:223], a[60:63], v[156:159], v[196:199]
    v_exp_f32_e32 v213, v213
    v_mfma_f32_16x16x32_bf16 v[220:223], a[56:59], v[152:155], v[220:223]
    ds_read_b64_tr_b16 a[126:127], v253 offset:46184
    v_cvt_pk_bf16_f32 v234, v212, v213
    v_mfma_f32_16x16x32_bf16 v[220:223], a[52:55], v[148:151], v[220:223]
    v_exp_f32_e32 v214, v214
    v_mfma_f32_16x16x32_bf16 v[220:223], a[48:51], v[144:147], v[220:223]
    v_exp_f32_e32 v215, v215
    v_smfmac_f32_16x16x64_bf16 a[192:195], a[208:211], v[224:231], v245
    ds_read_b64_tr_b16 a[120:121], v253 offset:33800
    v_mfma_f32_16x16x32_bf16 v[0:3], a[64:67], v[224:227], v[0:3]
    ds_read_b64_tr_b16 a[122:123], v253 offset:37928
    v_cvt_pk_bf16_f32 v235, v214, v215
    v_mfma_f32_16x16x32_bf16 v[0:3], a[68:71], v[228:231], v[0:3]
    ds_read_b32 v244, v255
    v_mfma_f32_16x16x32_bf16 v[4:7], a[76:79], v[228:231], v[4:7]
    s_waitcnt lgkmcnt(6)
    v_exp_f32_e32 v216, v216
    v_mfma_f32_16x16x32_bf16 v[4:7], a[72:75], v[224:227], v[4:7]
    v_exp_f32_e32 v217, v217
    v_mfma_f32_16x16x32_bf16 v[8:11], a[80:83], v[224:227], v[8:11]
    v_exp_f32_e32 v218, v218
    v_mfma_f32_16x16x32_bf16 v[8:11], a[84:87], v[228:231], v[8:11]
    v_exp_f32_e32 v219, v219
    v_mfma_f32_16x16x32_bf16 v[12:15], a[92:95], v[228:231], v[12:15]
    v_exp_f32_e32 v220, v220
    v_mfma_f32_16x16x32_bf16 v[12:15], a[88:91], v[224:227], v[12:15]
    v_exp_f32_e32 v221, v221
    v_mfma_f32_16x16x32_bf16 v[16:19], a[96:99], v[224:227], v[16:19]
    v_exp_f32_e32 v222, v222
    v_mfma_f32_16x16x32_bf16 v[16:19], a[100:103], v[228:231], v[16:19]
    s_waitcnt lgkmcnt(0)
    v_cmp_gt_u32_e32 vcc, s44, v244
    v_cvt_pk_bf16_f32 v236, v216, v217
    v_mfma_f32_16x16x32_bf16 v[20:23], a[108:111], v[228:231], v[20:23]
    v_exp_f32_e32 v223, v223
    v_mfma_f32_16x16x32_bf16 v[20:23], a[104:107], v[224:227], v[20:23]
    s_cbranch_vccnz L_rt17
L_bk17:
    ds_read_b128 a[144:147], v252 offset:50688
    v_cvt_pk_bf16_f32 v237, v218, v219
    v_mfma_f32_16x16x32_bf16 v[24:27], a[112:115], v[224:227], v[24:27]
    s_add_u32 s44, s44, 1
    ds_read_b128 a[148:151], v252 offset:50944
    v_mov_b32_e32 v244, s44
    v_mfma_f32_16x16x32_bf16 v[24:27], a[116:119], v[228:231], v[24:27]
    s_waitcnt vmcnt(0)
    ds_read_b128 a[152:155], v252 offset:51200
    v_cvt_pk_bf16_f32 v238, v220, v221
    v_mfma_f32_16x16x32_bf16 v[28:31], a[124:127], v[228:231], v[28:31]
    s_mov_b32 m0, s45
    ds_read_b128 a[156:159], v252 offset:51456
    v_cvt_pk_bf16_f32 v239, v222, v223
    v_mfma_f32_16x16x32_bf16 v[28:31], a[120:123], v[224:227], v[28:31]
    ds_read_b128 a[172:175], v252 offset:55680
    v_mfma_f32_16x16x32_bf16 v[208:211], a[0:3], v[160:163], v[200:203]
    ds_write_addtid_b32 v244
    v_mfma_f32_16x16x32_bf16 v[208:211], a[4:7], v[164:167], v[208:211]
    ds_read_b128 a[168:171], v252 offset:55424
    v_mfma_f32_16x16x32_bf16 v[208:211], a[8:11], v[168:171], v[208:211]
    ds_read_b128 a[164:167], v252 offset:55168
    v_mfma_f32_16x16x32_bf16 v[208:211], a[12:15], v[172:175], v[208:211]
    ds_read_b128 a[160:163], v252 offset:54912
    v_mfma_f32_16x16x32_bf16 v[212:215], a[28:31], v[172:175], v[200:203]
    ds_read_b128 a[176:179], v252 offset:59136
    v_mfma_f32_16x16x32_bf16 v[212:215], a[24:27], v[168:171], v[212:215]
    v_exp_f32_e32 v208, v208
    v_mfma_f32_16x16x32_bf16 v[212:215], a[20:23], v[164:167], v[212:215]
    v_exp_f32_e32 v209, v209
    v_mfma_f32_16x16x32_bf16 v[212:215], a[16:19], v[160:163], v[212:215]
    v_exp_f32_e32 v210, v210
    v_mfma_f32_16x16x32_bf16 v[216:219], a[32:35], v[160:163], v[200:203]
    v_exp_f32_e32 v211, v211
    v_mfma_f32_16x16x32_bf16 v[216:219], a[36:39], v[164:167], v[216:219]
    v_exp_f32_e32 v212, v212
    v_mfma_f32_16x16x32_bf16 v[216:219], a[40:43], v[168:171], v[216:219]
    v_exp_f32_e32 v213, v213
    v_mfma_f32_16x16x32_bf16 v[216:219], a[44:47], v[172:175], v[216:219]
    v_exp_f32_e32 v214, v214
    v_mfma_f32_16x16x32_bf16 v[220:223], a[60:63], v[172:175], v[200:203]
    v_exp_f32_e32 v215, v215
    v_mfma_f32_16x16x32_bf16 v[220:223], a[56:59], v[168:171], v[220:223]
    ds_read_b128 a[180:183], v252 offset:59392
    v_cvt_pk_bf16_f32 v224, v208, v209
    v_mfma_f32_16x16x32_bf16 v[220:223], a[52:55], v[164:167], v[220:223]
    ds_read_b128 a[184:187], v252 offset:59648
    v_cvt_pk_bf16_f32 v225, v210, v211
    v_mfma_f32_16x16x32_bf16 v[220:223], a[48:51], v[160:163], v[220:223]
    v_exp_f32_e32 v216, v216
    v_smfmac_f32_16x16x64_bf16 a[196:199], a[208:211], v[232:239], v245
    ds_read_b128 a[188:191], v252 offset:59904
    v_mfma_f32_16x16x32_bf16 v[32:35], a[64:67], v[232:235], v[32:35]
    v_exp_f32_e32 v217, v217
    v_mfma_f32_16x16x32_bf16 v[32:35], a[68:71], v[236:239], v[32:35]
    ds_read_b32 v244, v255
    v_cvt_pk_bf16_f32 v226, v212, v213
    v_mfma_f32_16x16x32_bf16 v[36:39], a[76:79], v[236:239], v[36:39]
    v_exp_f32_e32 v218, v218
    v_mfma_f32_16x16x32_bf16 v[36:39], a[72:75], v[232:235], v[36:39]
    v_exp_f32_e32 v219, v219
    v_mfma_f32_16x16x32_bf16 v[40:43], a[80:83], v[232:235], v[40:43]
    ds_read_b128 a[60:63], v252 offset:64128
    v_cvt_pk_bf16_f32 v227, v214, v215
    v_mfma_f32_16x16x32_bf16 v[40:43], a[84:87], v[236:239], v[40:43]
    ds_read_b128 a[56:59], v252 offset:63872
    v_cvt_pk_bf16_f32 v228, v216, v217
    v_mfma_f32_16x16x32_bf16 v[44:47], a[92:95], v[236:239], v[44:47]
    ds_read_b128 a[52:55], v252 offset:63616
    v_cvt_pk_bf16_f32 v229, v218, v219
    v_mfma_f32_16x16x32_bf16 v[44:47], a[88:91], v[232:235], v[44:47]
    v_exp_f32_e32 v220, v220
    v_mfma_f32_16x16x32_bf16 v[48:51], a[96:99], v[232:235], v[48:51]
    v_exp_f32_e32 v221, v221
    v_mfma_f32_16x16x32_bf16 v[48:51], a[100:103], v[236:239], v[48:51]
    s_waitcnt lgkmcnt(3)
    ds_read_b128 a[48:51], v252 offset:63360
    v_cmp_gt_u32_e32 vcc, s44, v244
    v_mfma_f32_16x16x32_bf16 v[52:55], a[108:111], v[236:239], v[52:55]
    v_exp_f32_e32 v222, v222
    v_mfma_f32_16x16x32_bf16 v[52:55], a[104:107], v[232:235], v[52:55]
    s_cbranch_vccnz L_rt18
L_bk18:
    v_exp_f32_e32 v223, v223
    v_mfma_f32_16x16x32_bf16 v[56:59], a[112:115], v[232:235], v[56:59]
    ds_read_b64_tr_b16 a[224:225], v253 offset:49536
    v_cvt_pk_bf16_f32 v230, v220, v221
    v_mfma_f32_16x16x32_bf16 v[56:59], a[116:119], v[236:239], v[56:59]
    ds_read_b64_tr_b16 a[226:227], v253 offset:53664
    v_cvt_pk_bf16_f32 v231, v222, v223
    v_mfma_f32_16x16x32_bf16 v[60:63], a[124:127], v[236:239], v[60:63]
    ds_read_b64_tr_b16 a[228:229], v253 offset:57792
    v_mfma_f32_16x16x32_bf16 v[60:63], a[120:123], v[232:235], v[60:63]
    ds_read_b64_tr_b16 a[230:231], v253 offset:61920
    v_mfma_f32_16x16x32_bf16 v[208:211], a[144:147], v[128:131], v[192:195]
    s_add_u32 s25, s25, 1
    ds_read_b64_tr_b16 a[236:237], v253 offset:57800
    v_mfma_f32_16x16x32_bf16 v[208:211], a[148:151], v[132:135], v[208:211]
    ds_read_b64_tr_b16 a[238:239], v253 offset:61928
    v_mfma_f32_16x16x32_bf16 v[208:211], a[152:155], v[136:139], v[208:211]
    ds_read_b64_tr_b16 a[232:233], v253 offset:49544
    v_mfma_f32_16x16x32_bf16 v[208:211], a[156:159], v[140:143], v[208:211]
    ds_read_b64_tr_b16 a[234:235], v253 offset:53672
    v_mfma_f32_16x16x32_bf16 v[212:215], a[172:175], v[140:143], v[192:195]
    ds_read_b64_tr_b16 a[240:241], v253 offset:49792
    v_mfma_f32_16x16x32_bf16 v[212:215], a[168:171], v[136:139], v[212:215]
    v_exp_f32_e32 v208, v208
    v_mfma_f32_16x16x32_bf16 v[212:215], a[164:167], v[132:135], v[212:215]
    v_exp_f32_e32 v209, v209
    v_mfma_f32_16x16x32_bf16 v[212:215], a[160:163], v[128:131], v[212:215]
    v_exp_f32_e32 v210, v210
    v_mfma_f32_16x16x32_bf16 v[216:219], a[176:179], v[128:131], v[192:195]
    v_exp_f32_e32 v211, v211
    v_mfma_f32_16x16x32_bf16 v[216:219], a[180:183], v[132:135], v[216:219]
    v_exp_f32_e32 v212, v212
    v_mfma_f32_16x16x32_bf16 v[216:219], a[184:187], v[136:139], v[216:219]
    v_exp_f32_e32 v213, v213
    v_mfma_f32_16x16x32_bf16 v[216:219], a[188:191], v[140:143], v[216:219]
    s_waitcnt lgkmcnt(6)
    v_exp_f32_e32 v214, v214
    v_mfma_f32_16x16x32_bf16 v[220:223], a[60:63], v[140:143], v[192:195]
    v_exp_f32_e32 v215, v215
    v_mfma_f32_16x16x32_bf16 v[220:223], a[56:59], v[136:139], v[220:223]
    ds_read_b64_tr_b16 a[242:243], v253 offset:53920
    v_cvt_pk_bf16_f32 v232, v208, v209
    v_mfma_f32_16x16x32_bf16 v[220:223], a[52:55], v[132:135], v[220:223]
    ds_read_b64_tr_b16 a[244:245], v253 offset:58048
    v_cvt_pk_bf16_f32 v233, v210, v211
    v_mfma_f32_16x16x32_bf16 v[220:223], a[48:51], v[128:131], v[220:223]
    v_exp_f32_e32 v216, v216
    v_smfmac_f32_16x16x64_bf16 a[200:203], a[208:211], v[224:231], v245
    v_cvt_pk_bf16_f32 v234, v212, v213
    v_mfma_f32_16x16x32_bf16 v[64:67], a[64:67], v[224:227], v[64:67]
    v_exp_f32_e32 v217, v217
    v_mfma_f32_16x16x32_bf16 v[64:67], a[68:71], v[228:231], v[64:67]
    v_exp_f32_e32 v218, v218
    v_mfma_f32_16x16x32_bf16 v[68:71], a[76:79], v[228:231], v[68:71]
    v_exp_f32_e32 v219, v219
    v_mfma_f32_16x16x32_bf16 v[68:71], a[72:75], v[224:227], v[68:71]
    ds_read_b64_tr_b16 a[246:247], v253 offset:62176
    v_cvt_pk_bf16_f32 v235, v214, v215
    v_mfma_f32_16x16x32_bf16 v[72:75], a[80:83], v[224:227], v[72:75]
    v_exp_f32_e32 v220, v220
    v_mfma_f32_16x16x32_bf16 v[72:75], a[84:87], v[228:231], v[72:75]
    v_exp_f32_e32 v221, v221
    v_mfma_f32_16x16x32_bf16 v[76:79], a[92:95], v[228:231], v[76:79]
    v_exp_f32_e32 v222, v222
    v_mfma_f32_16x16x32_bf16 v[76:79], a[88:91], v[224:227], v[76:79]
    v_exp_f32_e32 v223, v223
    v_mfma_f32_16x16x32_bf16 v[80:83], a[96:99], v[224:227], v[80:83]
    ds_read_b64_tr_b16 a[252:253], v253 offset:58056
    v_cvt_pk_bf16_f32 v236, v216, v217
    v_mfma_f32_16x16x32_bf16 v[80:83], a[100:103], v[228:231], v[80:83]
    ds_read_b64_tr_b16 a[254:255], v253 offset:62184
    v_cvt_pk_bf16_f32 v237, v218, v219
    v_mfma_f32_16x16x32_bf16 v[84:87], a[108:111], v[228:231], v[84:87]
    ds_read_b64_tr_b16 a[248:249], v253 offset:49800
    v_cvt_pk_bf16_f32 v238, v220, v221
    v_mfma_f32_16x16x32_bf16 v[84:87], a[104:107], v[224:227], v[84:87]
    ds_read_b64_tr_b16 a[250:251], v253 offset:53928
    v_cvt_pk_bf16_f32 v239, v222, v223
    v_mfma_f32_16x16x32_bf16 v[88:91], a[112:115], v[224:227], v[88:91]
    ds_read_b64_tr_b16 a[96:97], v253 offset:50048
    v_mfma_f32_16x16x32_bf16 v[88:91], a[116:119], v[228:231], v[88:91]
    ds_read_b64_tr_b16 a[98:99], v253 offset:54176
    v_mfma_f32_16x16x32_bf16 v[92:95], a[124:127], v[228:231], v[92:95]
    ds_read_b64_tr_b16 a[100:101], v253 offset:58304
    v_mfma_f32_16x16x32_bf16 v[92:95], a[120:123], v[224:227], v[92:95]
    ds_read_b64_tr_b16 a[102:103], v253 offset:62432
    v_mfma_f32_16x16x32_bf16 v[208:211], a[144:147], v[144:147], v[196:199]
    ds_read_b64_tr_b16 a[108:109], v253 offset:58312
    v_mfma_f32_16x16x32_bf16 v[208:211], a[148:151], v[148:151], v[208:211]
    ds_read_b64_tr_b16 a[110:111], v253 offset:62440
    v_mfma_f32_16x16x32_bf16 v[208:211], a[152:155], v[152:155], v[208:211]
    ds_read_b64_tr_b16 a[104:105], v253 offset:50056
    v_mfma_f32_16x16x32_bf16 v[208:211], a[156:159], v[156:159], v[208:211]
    ds_read_b64_tr_b16 a[106:107], v253 offset:54184
    v_mfma_f32_16x16x32_bf16 v[212:215], a[172:175], v[156:159], v[196:199]
    ds_read_b64_tr_b16 a[112:113], v253 offset:50304
    v_mfma_f32_16x16x32_bf16 v[212:215], a[168:171], v[152:155], v[212:215]
    v_exp_f32_e32 v208, v208
    v_mfma_f32_16x16x32_bf16 v[212:215], a[164:167], v[148:151], v[212:215]
    v_exp_f32_e32 v209, v209
    v_mfma_f32_16x16x32_bf16 v[212:215], a[160:163], v[144:147], v[212:215]
    ds_read_b64_tr_b16 a[114:115], v253 offset:54432
    v_cvt_pk_bf16_f32 v224, v208, v209
    v_mfma_f32_16x16x32_bf16 v[216:219], a[176:179], v[144:147], v[196:199]
    v_exp_f32_e32 v210, v210
    v_mfma_f32_16x16x32_bf16 v[216:219], a[180:183], v[148:151], v[216:219]
    v_exp_f32_e32 v211, v211
    v_mfma_f32_16x16x32_bf16 v[216:219], a[184:187], v[152:155], v[216:219]
    ds_read_b64_tr_b16 a[116:117], v253 offset:58560
    v_cvt_pk_bf16_f32 v225, v210, v211
    v_mfma_f32_16x16x32_bf16 v[216:219], a[188:191], v[156:159], v[216:219]
    v_exp_f32_e32 v212, v212
    v_mfma_f32_16x16x32_bf16 v[220:223], a[60:63], v[156:159], v[196:199]
    v_exp_f32_e32 v213, v213
    v_mfma_f32_16x16x32_bf16 v[220:223], a[56:59], v[152:155], v[220:223]
    ds_read_b64_tr_b16 a[118:119], v253 offset:62688
    v_cvt_pk_bf16_f32 v226, v212, v213
    v_mfma_f32_16x16x32_bf16 v[220:223], a[52:55], v[148:151], v[220:223]
    v_exp_f32_e32 v214, v214
    v_mfma_f32_16x16x32_bf16 v[220:223], a[48:51], v[144:147], v[220:223]
    v_exp_f32_e64 v215, v215
    v_smfmac_f32_16x16x64_bf16 a[192:195], a[208:211], v[232:239], v245
    ds_read_b64_tr_b16 a[124:125], v253 offset:58568
    v_mfma_f32_16x16x32_bf16 v[0:3], a[224:227], v[232:235], v[0:3]
    s_waitcnt lgkmcnt(4)
    ds_read_b64_tr_b16 a[126:127], v253 offset:62696
    v_cvt_pk_bf16_f32 v227, v214, v215
    v_mfma_f32_16x16x32_bf16 v[0:3], a[228:231], v[236:239], v[0:3]
    ds_read_b64_tr_b16 a[120:121], v253 offset:50312
    ds_read_b64_tr_b16 a[122:123], v253 offset:54440
    v_mfma_f32_16x16x32_bf16 v[4:7], a[236:239], v[236:239], v[4:7]
    v_exp_f32_e32 v216, v216
    v_mfma_f32_16x16x32_bf16 v[4:7], a[232:235], v[232:235], v[4:7]
    v_exp_f32_e64 v217, v217
    v_mfma_f32_16x16x32_bf16 v[8:11], a[240:243], v[232:235], v[8:11]
    v_exp_f32_e64 v218, v218
    v_mfma_f32_16x16x32_bf16 v[8:11], a[244:247], v[236:239], v[8:11]
    v_accvgpr_read_b32 v240, a192
    v_accvgpr_read_b32 v241, a193
    v_add_f32_e32 v241, v241, v240
    v_rcp_f32_e32 v240, v241
    v_cmp_ngt_f32_e64 s[30:31], s26, v241
    v_accvgpr_read_b32 v241, a218
    v_mul_f32_e64 v241, -v241, v240
    v_pk_fma_f32 v[0:1], v[0:1], v[240:241], v[240:241] op_sel:[0,0,1] op_sel_hi:[1,0,1]
    v_pk_fma_f32 v[2:3], v[2:3], v[240:241], v[240:241] op_sel:[0,0,1] op_sel_hi:[1,0,1]
    v_pk_fma_f32 v[4:5], v[4:5], v[240:241], v[240:241] op_sel:[0,0,1] op_sel_hi:[1,0,1]
    v_pk_fma_f32 v[6:7], v[6:7], v[240:241], v[240:241] op_sel:[0,0,1] op_sel_hi:[1,0,1]
    v_cvt_pk_bf16_f32 v0, v0, v1
    v_cvt_pk_bf16_f32 v1, v2, v3
    v_cvt_pk_bf16_f32 v2, v4, v5
    v_cvt_pk_bf16_f32 v3, v6, v7
    v_mfma_f32_16x16x32_bf16 v[12:15], a[252:255], v[236:239], v[12:15]
    s_or_b64 s[28:29], s[28:29], s[30:31]
    v_exp_f32_e32 v219, v219
    v_mfma_f32_16x16x32_bf16 v[12:15], a[248:251], v[232:235], v[12:15]
    v_exp_f32_e64 v220, v220
    v_mfma_f32_16x16x32_bf16 v[16:19], a[96:99], v[232:235], v[16:19]
    v_exp_f32_e64 v221, v221
    v_mfma_f32_16x16x32_bf16 v[16:19], a[100:103], v[236:239], v[16:19]
    ds_write_b128 v242, v[0:3] offset:0
    v_pk_fma_f32 v[8:9], v[8:9], v[240:241], v[240:241] op_sel:[0,0,1] op_sel_hi:[1,0,1]
    v_pk_fma_f32 v[10:11], v[10:11], v[240:241], v[240:241] op_sel:[0,0,1] op_sel_hi:[1,0,1]
    v_pk_fma_f32 v[12:13], v[12:13], v[240:241], v[240:241] op_sel:[0,0,1] op_sel_hi:[1,0,1]
    v_pk_fma_f32 v[14:15], v[14:15], v[240:241], v[240:241] op_sel:[0,0,1] op_sel_hi:[1,0,1]
    v_cvt_pk_bf16_f32 v8, v8, v9
    v_cvt_pk_bf16_f32 v9, v10, v11
    v_cvt_pk_bf16_f32 v10, v12, v13
    v_cvt_pk_bf16_f32 v11, v14, v15
    v_mfma_f32_16x16x32_bf16 v[20:23], a[108:111], v[236:239], v[20:23]
    v_exp_f32_e64 v222, v222
    v_mfma_f32_16x16x32_bf16 v[20:23], a[104:107], v[232:235], v[20:23]
    s_waitcnt lgkmcnt(1)
    v_exp_f32_e32 v223, v223
    v_mfma_f32_16x16x32_bf16 v[24:27], a[112:115], v[232:235], v[24:27]
    v_cvt_pk_bf16_f32 v228, v216, v217
    v_cvt_pk_bf16_f32 v229, v218, v219
    v_mfma_f32_16x16x32_bf16 v[24:27], a[116:119], v[236:239], v[24:27]
    ds_write_b128 v242, v[8:11] offset:64
    v_pk_fma_f32 v[16:17], v[16:17], v[240:241], v[240:241] op_sel:[0,0,1] op_sel_hi:[1,0,1]
    v_pk_fma_f32 v[18:19], v[18:19], v[240:241], v[240:241] op_sel:[0,0,1] op_sel_hi:[1,0,1]
    v_pk_fma_f32 v[20:21], v[20:21], v[240:241], v[240:241] op_sel:[0,0,1] op_sel_hi:[1,0,1]
    v_pk_fma_f32 v[22:23], v[22:23], v[240:241], v[240:241] op_sel:[0,0,1] op_sel_hi:[1,0,1]
    v_cvt_pk_bf16_f32 v16, v16, v17
    v_cvt_pk_bf16_f32 v17, v18, v19
    v_cvt_pk_bf16_f32 v18, v20, v21
    v_cvt_pk_bf16_f32 v19, v22, v23
    v_mfma_f32_16x16x32_bf16 v[28:31], a[124:127], v[236:239], v[28:31]
    v_cvt_pk_bf16_f32 v230, v220, v221
    v_cvt_pk_bf16_f32 v231, v222, v223
    v_mfma_f32_16x16x32_bf16 v[28:31], a[120:123], v[232:235], v[28:31]
    v_mfma_f32_16x16x32_bf16 v[208:211], a[144:147], v[160:163], v[200:203]
    v_mfma_f32_16x16x32_bf16 v[208:211], a[148:151], v[164:167], v[208:211]
    ds_write_b128 v242, v[16:19] offset:128
    v_pk_fma_f32 v[24:25], v[24:25], v[240:241], v[240:241] op_sel:[0,0,1] op_sel_hi:[1,0,1]
    v_pk_fma_f32 v[26:27], v[26:27], v[240:241], v[240:241] op_sel:[0,0,1] op_sel_hi:[1,0,1]
    v_pk_fma_f32 v[28:29], v[28:29], v[240:241], v[240:241] op_sel:[0,0,1] op_sel_hi:[1,0,1]
    v_pk_fma_f32 v[30:31], v[30:31], v[240:241], v[240:241] op_sel:[0,0,1] op_sel_hi:[1,0,1]
    v_cvt_pk_bf16_f32 v24, v24, v25
    v_cvt_pk_bf16_f32 v25, v26, v27
    v_mfma_f32_16x16x32_bf16 v[208:211], a[152:155], v[168:171], v[208:211]
    v_cvt_pk_bf16_f32 v26, v28, v29
    v_cvt_pk_bf16_f32 v27, v30, v31
    v_mfma_f32_16x16x32_bf16 v[208:211], a[156:159], v[172:175], v[208:211]
    ds_write_b128 v242, v[24:27] offset:192
    v_mfma_f32_16x16x32_bf16 v[212:215], a[172:175], v[172:175], v[200:203]
    ds_read_b128 a[128:131], v247 offset:0
    v_mfma_f32_16x16x32_bf16 v[212:215], a[168:171], v[168:171], v[212:215]
    v_exp_f32_e32 v208, v208
    v_mfma_f32_16x16x32_bf16 v[212:215], a[164:167], v[164:167], v[212:215]
    v_exp_f32_e32 v209, v209
    v_mfma_f32_16x16x32_bf16 v[212:215], a[160:163], v[160:163], v[212:215]
    ds_read_b128 a[132:135], v247 offset:1088
    v_cvt_pk_bf16_f32 v232, v208, v209
    v_mfma_f32_16x16x32_bf16 v[216:219], a[176:179], v[160:163], v[200:203]
    v_exp_f32_e32 v210, v210
    v_mfma_f32_16x16x32_bf16 v[216:219], a[180:183], v[164:167], v[216:219]
    v_exp_f32_e32 v211, v211
    v_mfma_f32_16x16x32_bf16 v[216:219], a[184:187], v[168:171], v[216:219]
    ds_read_b128 a[136:139], v247 offset:2176
    v_cvt_pk_bf16_f32 v233, v210, v211
    v_mfma_f32_16x16x32_bf16 v[216:219], a[188:191], v[172:175], v[216:219]
    v_exp_f32_e32 v212, v212
    v_mfma_f32_16x16x32_bf16 v[220:223], a[60:63], v[172:175], v[200:203]
    s_waitcnt lgkmcnt(2)
    buffer_store_dwordx4 a[128:131], v255, s[16:19], s22 offen sc0 sc1
    v_mfma_f32_16x16x32_bf16 v[220:223], a[56:59], v[168:171], v[220:223]
    v_exp_f32_e64 v213, v213
    v_mfma_f32_16x16x32_bf16 v[220:223], a[52:55], v[164:167], v[220:223]
    ds_read_b128 a[140:143], v247 offset:3264
    v_cvt_pk_bf16_f32 v234, v212, v213
    v_mfma_f32_16x16x32_bf16 v[220:223], a[48:51], v[160:163], v[220:223]
    v_exp_f32_e64 v214, v214
    v_smfmac_f32_16x16x64_bf16 a[196:199], a[208:211], v[224:231], v245
    v_mfma_f32_16x16x32_bf16 v[32:35], a[224:227], v[224:227], v[32:35]
    v_exp_f32_e64 v215, v215
    v_mfma_f32_16x16x32_bf16 v[32:35], a[228:231], v[228:231], v[32:35]
    v_exp_f32_e64 v216, v216
    v_mfma_f32_16x16x32_bf16 v[36:39], a[236:239], v[228:231], v[36:39]
    s_waitcnt lgkmcnt(2)
    buffer_store_dwordx4 a[132:135], v255, s[16:19], s22 offen offset:1024 sc0 sc1
    v_mfma_f32_16x16x32_bf16 v[36:39], a[232:235], v[224:227], v[36:39]
    v_exp_f32_e32 v217, v217
    v_mfma_f32_16x16x32_bf16 v[40:43], a[240:243], v[224:227], v[40:43]
    v_exp_f32_e64 v218, v218
    v_mfma_f32_16x16x32_bf16 v[40:43], a[244:247], v[228:231], v[40:43]
    v_accvgpr_read_b32 v240, a196
    v_accvgpr_read_b32 v241, a197
    v_add_f32_e32 v241, v241, v240
    v_rcp_f32_e32 v240, v241
    v_cmp_ngt_f32_e64 s[32:33], s26, v241
    v_accvgpr_read_b32 v241, a218
    v_mul_f32_e64 v241, -v241, v240
    v_pk_fma_f32 v[32:33], v[32:33], v[240:241], v[240:241] op_sel:[0,0,1] op_sel_hi:[1,0,1]
    v_pk_fma_f32 v[34:35], v[34:35], v[240:241], v[240:241] op_sel:[0,0,1] op_sel_hi:[1,0,1]
    v_pk_fma_f32 v[36:37], v[36:37], v[240:241], v[240:241] op_sel:[0,0,1] op_sel_hi:[1,0,1]
    v_pk_fma_f32 v[38:39], v[38:39], v[240:241], v[240:241] op_sel:[0,0,1] op_sel_hi:[1,0,1]
    v_cvt_pk_bf16_f32 v32, v32, v33
    v_cvt_pk_bf16_f32 v33, v34, v35
    v_cvt_pk_bf16_f32 v34, v36, v37
    v_cvt_pk_bf16_f32 v35, v38, v39
    v_mfma_f32_16x16x32_bf16 v[44:47], a[252:255], v[228:231], v[44:47]
    s_or_b64 s[28:29], s[28:29], s[32:33]
    s_waitcnt lgkmcnt(0)
    buffer_store_dwordx4 a[136:139], v255, s[16:19], s22 offen offset:2048 sc0 sc1
    v_mfma_f32_16x16x32_bf16 v[44:47], a[248:251], v[224:227], v[44:47]
    v_exp_f32_e64 v219, v219
    v_mfma_f32_16x16x32_bf16 v[48:51], a[96:99], v[224:227], v[48:51]
    v_cvt_pk_bf16_f32 v235, v214, v215
    v_cvt_pk_bf16_f32 v236, v216, v217
    v_mfma_f32_16x16x32_bf16 v[48:51], a[100:103], v[228:231], v[48:51]
    ds_write_b128 v242, v[32:35] offset:0
    v_pk_fma_f32 v[40:41], v[40:41], v[240:241], v[240:241] op_sel:[0,0,1] op_sel_hi:[1,0,1]
    v_pk_fma_f32 v[42:43], v[42:43], v[240:241], v[240:241] op_sel:[0,0,1] op_sel_hi:[1,0,1]
    v_pk_fma_f32 v[44:45], v[44:45], v[240:241], v[240:241] op_sel:[0,0,1] op_sel_hi:[1,0,1]
    v_pk_fma_f32 v[46:47], v[46:47], v[240:241], v[240:241] op_sel:[0,0,1] op_sel_hi:[1,0,1]
    v_cvt_pk_bf16_f32 v40, v40, v41
    v_cvt_pk_bf16_f32 v41, v42, v43
    v_cvt_pk_bf16_f32 v42, v44, v45
    v_cvt_pk_bf16_f32 v43, v46, v47
    v_mfma_f32_16x16x32_bf16 v[52:55], a[108:111], v[228:231], v[52:55]
    buffer_store_dwordx4 a[140:143], v255, s[16:19], s22 offen offset:3072 sc0 sc1
    v_mfma_f32_16x16x32_bf16 v[52:55], a[104:107], v[224:227], v[52:55]
    s_xor_b32 s22, s22, 16384
    v_exp_f32_e64 v220, v220
    v_mfma_f32_16x16x32_bf16 v[56:59], a[112:115], v[224:227], v[56:59]
    v_exp_f32_e64 v221, v221
    v_mfma_f32_16x16x32_bf16 v[56:59], a[116:119], v[228:231], v[56:59]
    ds_write_b128 v242, v[40:43] offset:64
    v_pk_fma_f32 v[48:49], v[48:49], v[240:241], v[240:241] op_sel:[0,0,1] op_sel_hi:[1,0,1]
    v_pk_fma_f32 v[50:51], v[50:51], v[240:241], v[240:241] op_sel:[0,0,1] op_sel_hi:[1,0,1]
    v_pk_fma_f32 v[52:53], v[52:53], v[240:241], v[240:241] op_sel:[0,0,1] op_sel_hi:[1,0,1]
    v_pk_fma_f32 v[54:55], v[54:55], v[240:241], v[240:241] op_sel:[0,0,1] op_sel_hi:[1,0,1]
    v_cvt_pk_bf16_f32 v48, v48, v49
    v_cvt_pk_bf16_f32 v49, v50, v51
    v_cvt_pk_bf16_f32 v50, v52, v53
    v_cvt_pk_bf16_f32 v51, v54, v55
    v_mfma_f32_16x16x32_bf16 v[60:63], a[124:127], v[228:231], v[60:63]
    v_exp_f32_e64 v222, v222
    v_mfma_f32_16x16x32_bf16 v[60:63], a[120:123], v[224:227], v[60:63]
    v_exp_f32_e64 v223, v223
    v_mfma_f32_16x16x32_bf16 v[208:211], a[144:147], v[176:179], v[204:207]
    v_cvt_pk_bf16_f32 v237, v218, v219
    v_cvt_pk_bf16_f32 v238, v220, v221
    v_mfma_f32_16x16x32_bf16 v[208:211], a[148:151], v[180:183], v[208:211]
    ds_write_b128 v242, v[48:51] offset:128
    v_pk_fma_f32 v[56:57], v[56:57], v[240:241], v[240:241] op_sel:[0,0,1] op_sel_hi:[1,0,1]
    v_pk_fma_f32 v[58:59], v[58:59], v[240:241], v[240:241] op_sel:[0,0,1] op_sel_hi:[1,0,1]
    v_pk_fma_f32 v[60:61], v[60:61], v[240:241], v[240:241] op_sel:[0,0,1] op_sel_hi:[1,0,1]
    v_pk_fma_f32 v[62:63], v[62:63], v[240:241], v[240:241] op_sel:[0,0,1] op_sel_hi:[1,0,1]
    v_cvt_pk_bf16_f32 v56, v56, v57
    v_cvt_pk_bf16_f32 v57, v58, v59
    v_mfma_f32_16x16x32_bf16 v[208:211], a[152:155], v[184:187], v[208:211]
    v_cvt_pk_bf16_f32 v58, v60, v61
    v_cvt_pk_bf16_f32 v59, v62, v63
    v_mfma_f32_16x16x32_bf16 v[208:211], a[156:159], v[188:191], v[208:211]
    ds_write_b128 v242, v[56:59] offset:192
    v_mfma_f32_16x16x32_bf16 v[212:215], a[172:175], v[188:191], v[204:207]
    ds_read_b128 a[128:131], v247 offset:0
    v_cvt_pk_bf16_f32 v239, v222, v223
    v_mfma_f32_16x16x32_bf16 v[212:215], a[168:171], v[184:187], v[212:215]
    v_exp_f32_e32 v208, v208
    v_mfma_f32_16x16x32_bf16 v[212:215], a[164:167], v[180:183], v[212:215]
    v_exp_f32_e32 v209, v209
    v_mfma_f32_16x16x32_bf16 v[212:215], a[160:163], v[176:179], v[212:215]
    ds_read_b128 a[132:135], v247 offset:1088
    v_cvt_pk_bf16_f32 v224, v208, v209
    v_mfma_f32_16x16x32_bf16 v[216:219], a[176:179], v[176:179], v[204:207]
    v_exp_f32_e32 v210, v210
    v_mfma_f32_16x16x32_bf16 v[216:219], a[180:183], v[180:183], v[216:219]
    v_exp_f32_e32 v211, v211
    v_mfma_f32_16x16x32_bf16 v[216:219], a[184:187], v[184:187], v[216:219]
    ds_read_b128 a[136:139], v247 offset:2176
    v_cvt_pk_bf16_f32 v225, v210, v211
    v_mfma_f32_16x16x32_bf16 v[216:219], a[188:191], v[188:191], v[216:219]
    v_exp_f32_e32 v212, v212
    v_mfma_f32_16x16x32_bf16 v[220:223], a[60:63], v[188:191], v[204:207]
    s_waitcnt lgkmcnt(2)
    buffer_store_dwordx4 a[128:131], v255, s[16:19], s22 offen sc0 sc1
    v_mfma_f32_16x16x32_bf16 v[220:223], a[56:59], v[184:187], v[220:223]
    v_exp_f32_e64 v213, v213
    v_mfma_f32_16x16x32_bf16 v[220:223], a[52:55], v[180:183], v[220:223]
    ds_read_b128 a[140:143], v247 offset:3264
    v_cvt_pk_bf16_f32 v226, v212, v213
    v_mfma_f32_16x16x32_bf16 v[220:223], a[48:51], v[176:179], v[220:223]
    v_exp_f32_e64 v214, v214
    v_smfmac_f32_16x16x64_bf16 a[200:203], a[208:211], v[232:239], v245
    ds_read_b128 a[60:63], v252 offset:47232
    v_mfma_f32_16x16x32_bf16 v[64:67], a[224:227], v[232:235], v[64:67]
    v_exp_f32_e64 v215, v215
    v_mfma_f32_16x16x32_bf16 v[64:67], a[228:231], v[236:239], v[64:67]
    v_exp_f32_e64 v216, v216
    v_mfma_f32_16x16x32_bf16 v[68:71], a[236:239], v[236:239], v[68:71]
    s_waitcnt lgkmcnt(3)
    buffer_store_dwordx4 a[132:135], v255, s[16:19], s22 offen offset:1024 sc0 sc1
    v_mfma_f32_16x16x32_bf16 v[68:71], a[232:235], v[232:235], v[68:71]
    v_exp_f32_e32 v217, v217
    v_mfma_f32_16x16x32_bf16 v[72:75], a[240:243], v[232:235], v[72:75]
    v_exp_f32_e64 v218, v218
    v_mfma_f32_16x16x32_bf16 v[72:75], a[244:247], v[236:239], v[72:75]
    v_accvgpr_read_b32 v240, a200
    v_accvgpr_read_b32 v241, a201
    v_add_f32_e32 v241, v241, v240
    v_rcp_f32_e32 v240, v241
    v_cmp_ngt_f32_e64 s[30:31], s26, v241
    v_accvgpr_read_b32 v241, a218
    v_mul_f32_e64 v241, -v241, v240
    v_pk_fma_f32 v[64:65], v[64:65], v[240:241], v[240:241] op_sel:[0,0,1] op_sel_hi:[1,0,1]
    v_pk_fma_f32 v[66:67], v[66:67], v[240:241], v[240:241] op_sel:[0,0,1] op_sel_hi:[1,0,1]
    v_pk_fma_f32 v[68:69], v[68:69], v[240:241], v[240:241] op_sel:[0,0,1] op_sel_hi:[1,0,1]
    v_pk_fma_f32 v[70:71], v[70:71], v[240:241], v[240:241] op_sel:[0,0,1] op_sel_hi:[1,0,1]
    v_cvt_pk_bf16_f32 v64, v64, v65
    v_cvt_pk_bf16_f32 v65, v66, v67
    v_cvt_pk_bf16_f32 v66, v68, v69
    v_cvt_pk_bf16_f32 v67, v70, v71
    v_mfma_f32_16x16x32_bf16 v[76:79], a[252:255], v[236:239], v[76:79]
    s_or_b64 s[28:29], s[28:29], s[30:31]
    s_waitcnt lgkmcnt(1)
    buffer_store_dwordx4 a[136:139], v255, s[16:19], s22 offen offset:2048 sc0 sc1
    v_mfma_f32_16x16x32_bf16 v[76:79], a[248:251], v[232:235], v[76:79]
    v_exp_f32_e64 v219, v219
    v_mfma_f32_16x16x32_bf16 v[80:83], a[96:99], v[232:235], v[80:83]
    ds_read_b128 a[56:59], v252 offset:46976
    v_cvt_pk_bf16_f32 v227, v214, v215
    v_mfma_f32_16x16x32_bf16 v[80:83], a[100:103], v[236:239], v[80:83]
    ds_write_b128 v242, v[64:67] offset:0
    v_pk_fma_f32 v[72:73], v[72:73], v[240:241], v[240:241] op_sel:[0,0,1] op_sel_hi:[1,0,1]
    v_pk_fma_f32 v[74:75], v[74:75], v[240:241], v[240:241] op_sel:[0,0,1] op_sel_hi:[1,0,1]
    v_pk_fma_f32 v[76:77], v[76:77], v[240:241], v[240:241] op_sel:[0,0,1] op_sel_hi:[1,0,1]
    v_pk_fma_f32 v[78:79], v[78:79], v[240:241], v[240:241] op_sel:[0,0,1] op_sel_hi:[1,0,1]
    v_cvt_pk_bf16_f32 v72, v72, v73
    v_cvt_pk_bf16_f32 v73, v74, v75
    v_cvt_pk_bf16_f32 v74, v76, v77
    v_cvt_pk_bf16_f32 v75, v78, v79
    v_mfma_f32_16x16x32_bf16 v[84:87], a[108:111], v[236:239], v[84:87]
    buffer_store_dwordx4 a[140:143], v255, s[16:19], s22 offen offset:3072 sc0 sc1
    v_mfma_f32_16x16x32_bf16 v[84:87], a[104:107], v[232:235], v[84:87]
    s_xor_b32 s22, s22, 49152
    ds_read_b128 a[52:55], v252 offset:46720
    v_cvt_pk_bf16_f32 v228, v216, v217
    v_mfma_f32_16x16x32_bf16 v[88:91], a[112:115], v[232:235], v[88:91]
    v_exp_f32_e64 v220, v220
    v_mfma_f32_16x16x32_bf16 v[88:91], a[116:119], v[236:239], v[88:91]
    ds_write_b128 v242, v[72:75] offset:64
    v_pk_fma_f32 v[80:81], v[80:81], v[240:241], v[240:241] op_sel:[0,0,1] op_sel_hi:[1,0,1]
    v_pk_fma_f32 v[82:83], v[82:83], v[240:241], v[240:241] op_sel:[0,0,1] op_sel_hi:[1,0,1]
    v_pk_fma_f32 v[84:85], v[84:85], v[240:241], v[240:241] op_sel:[0,0,1] op_sel_hi:[1,0,1]
    v_pk_fma_f32 v[86:87], v[86:87], v[240:241], v[240:241] op_sel:[0,0,1] op_sel_hi:[1,0,1]
    v_cvt_pk_bf16_f32 v80, v80, v81
    v_cvt_pk_bf16_f32 v81, v82, v83
    v_cvt_pk_bf16_f32 v82, v84, v85
    v_cvt_pk_bf16_f32 v83, v86, v87
    v_mfma_f32_16x16x32_bf16 v[92:95], a[124:127], v[236:239], v[92:95]
    v_exp_f32_e64 v221, v221
    v_mfma_f32_16x16x32_bf16 v[92:95], a[120:123], v[232:235], v[92:95]
    v_exp_f32_e64 v222, v222
    v_mfma_f32_16x16x32_bf16 v[208:211], a[0:3], v[176:179], v[204:207]
    v_exp_f32_e64 v223, v223
    v_mfma_f32_16x16x32_bf16 v[208:211], a[4:7], v[180:183], v[208:211]
    ds_write_b128 v242, v[80:83] offset:128
    v_pk_fma_f32 v[88:89], v[88:89], v[240:241], v[240:241] op_sel:[0,0,1] op_sel_hi:[1,0,1]
    v_pk_fma_f32 v[90:91], v[90:91], v[240:241], v[240:241] op_sel:[0,0,1] op_sel_hi:[1,0,1]
    v_pk_fma_f32 v[92:93], v[92:93], v[240:241], v[240:241] op_sel:[0,0,1] op_sel_hi:[1,0,1]
    v_pk_fma_f32 v[94:95], v[94:95], v[240:241], v[240:241] op_sel:[0,0,1] op_sel_hi:[1,0,1]
    v_cvt_pk_bf16_f32 v88, v88, v89
    v_cvt_pk_bf16_f32 v89, v90, v91
    v_mfma_f32_16x16x32_bf16 v[208:211], a[8:11], v[184:187], v[208:211]
    v_cvt_pk_bf16_f32 v90, v92, v93
    v_cvt_pk_bf16_f32 v91, v94, v95
    v_mfma_f32_16x16x32_bf16 v[208:211], a[12:15], v[188:191], v[208:211]
    ds_write_b128 v242, v[88:91] offset:192
    v_mfma_f32_16x16x32_bf16 v[212:215], a[28:31], v[188:191], v[204:207]
    ds_read_b128 a[128:131], v247 offset:0
    ds_read_b128 a[48:51], v252 offset:46464
    v_mfma_f32_16x16x32_bf16 v[212:215], a[24:27], v[184:187], v[212:215]
    v_cvt_pk_bf16_f32 v229, v218, v219
    v_cvt_pk_bf16_f32 v230, v220, v221
    v_mfma_f32_16x16x32_bf16 v[212:215], a[20:23], v[180:183], v[212:215]
    ds_read_b128 a[132:135], v247 offset:1088
    v_cvt_pk_bf16_f32 v231, v222, v223
    v_mfma_f32_16x16x32_bf16 v[212:215], a[16:19], v[176:179], v[212:215]
    v_exp_f32_e32 v208, v208
    v_mfma_f32_16x16x32_bf16 v[216:219], a[32:35], v[176:179], v[204:207]
    v_exp_f32_e32 v209, v209
    v_mfma_f32_16x16x32_bf16 v[216:219], a[36:39], v[180:183], v[216:219]
    ds_read_b128 a[136:139], v247 offset:2176
    v_cvt_pk_bf16_f32 v232, v208, v209
    v_mfma_f32_16x16x32_bf16 v[216:219], a[40:43], v[184:187], v[216:219]
    v_exp_f32_e32 v210, v210
    v_mfma_f32_16x16x32_bf16 v[216:219], a[44:47], v[188:191], v[216:219]
    s_waitcnt lgkmcnt(5)
    s_waitcnt lgkmcnt(3)
    buffer_store_dwordx4 a[128:131], v255, s[16:19], s22 offen sc0 sc1
    v_mfma_f32_16x16x32_bf16 v[220:223], a[60:63], v[188:191], v[204:207]
    v_exp_f32_e32 v211, v211
    v_mfma_f32_16x16x32_bf16 v[220:223], a[56:59], v[184:187], v[220:223]
    ds_read_b128 a[140:143], v247 offset:3264
    v_cvt_pk_bf16_f32 v233, v210, v211
    v_mfma_f32_16x16x32_bf16 v[220:223], a[52:55], v[180:183], v[220:223]
    s_waitcnt lgkmcnt(3)
    v_exp_f32_e32 v212, v212
    v_mfma_f32_16x16x32_bf16 v[220:223], a[48:51], v[176:179], v[220:223]
    v_exp_f32_e32 v213, v213
    v_smfmac_f32_16x16x64_bf16 a[204:207], a[208:211], v[224:231], v245
    v_cvt_pk_bf16_f32 v234, v212, v213
    v_mfma_f32_16x16x32_bf16 v[96:99], a[224:227], v[224:227], v[96:99]
    v_exp_f32_e32 v214, v214
    v_mfma_f32_16x16x32_bf16 v[96:99], a[228:231], v[228:231], v[96:99]
    s_waitcnt lgkmcnt(2)
    buffer_store_dwordx4 a[132:135], v255, s[16:19], s22 offen offset:1024 sc0 sc1
    v_mfma_f32_16x16x32_bf16 v[100:103], a[236:239], v[228:231], v[100:103]
    v_exp_f32_e32 v215, v215
    v_mfma_f32_16x16x32_bf16 v[100:103], a[232:235], v[224:227], v[100:103]
    v_exp_f32_e32 v216, v216
    v_mfma_f32_16x16x32_bf16 v[104:107], a[240:243], v[224:227], v[104:107]
    v_exp_f32_e32 v217, v217
    v_mfma_f32_16x16x32_bf16 v[104:107], a[244:247], v[228:231], v[104:107]
    v_exp_f32_e32 v218, v218
    v_mfma_f32_16x16x32_bf16 v[108:111], a[252:255], v[228:231], v[108:111]
    v_exp_f32_e32 v219, v219
    v_mfma_f32_16x16x32_bf16 v[108:111], a[248:251], v[224:227], v[108:111]
    s_waitcnt lgkmcnt(1)
    buffer_store_dwordx4 a[136:139], v255, s[16:19], s22 offen offset:2048 sc0 sc1
    v_mfma_f32_16x16x32_bf16 v[112:115], a[96:99], v[224:227], v[112:115]
    v_exp_f32_e32 v220, v220
    v_mfma_f32_16x16x32_bf16 v[112:115], a[100:103], v[228:231], v[112:115]
    v_exp_f32_e32 v221, v221
    v_mfma_f32_16x16x32_bf16 v[116:119], a[108:111], v[228:231], v[116:119]
    v_exp_f32_e32 v222, v222
    v_mfma_f32_16x16x32_bf16 v[116:119], a[104:107], v[224:227], v[116:119]
    v_exp_f32_e32 v223, v223
    v_mfma_f32_16x16x32_bf16 v[120:123], a[112:115], v[224:227], v[120:123]
    s_waitcnt lgkmcnt(0)
    buffer_store_dwordx4 a[140:143], v255, s[16:19], s22 offen offset:3072 sc0 sc1
    v_mfma_f32_16x16x32_bf16 v[120:123], a[116:119], v[228:231], v[120:123]
    s_xor_b32 s22, s22, 16384
    ds_read_b64_tr_b16 a[96:97], v253 offset:33536
    ds_read_b64_tr_b16 a[98:99], v253 offset:37664
    v_cvt_pk_bf16_f32 v235, v214, v215
    v_mfma_f32_16x16x32_bf16 v[124:127], a[124:127], v[228:231], v[124:127]
    v_cvt_pk_bf16_f32 v236, v216, v217
    v_cvt_pk_bf16_f32 v237, v218, v219
    v_cvt_pk_bf16_f32 v238, v220, v221
    v_cvt_pk_bf16_f32 v239, v222, v223
    v_mfma_f32_16x16x32_bf16 v[124:127], a[120:123], v[224:227], v[124:127]
    ds_read_b64_tr_b16 a[100:101], v253 offset:41792
    ds_read_b64_tr_b16 a[102:103], v253 offset:45920
    v_smfmac_f32_16x16x64_bf16 a[204:207], a[208:211], v[232:239], v245
    ds_read_b64_tr_b16 a[108:109], v253 offset:41800
    ds_read_b64_tr_b16 a[110:111], v253 offset:45928
    v_mfma_f32_16x16x32_bf16 v[96:99], a[64:67], v[232:235], v[96:99]
    ds_read_b64_tr_b16 a[104:105], v253 offset:33544
    ds_read_b64_tr_b16 a[106:107], v253 offset:37672
    v_mfma_f32_16x16x32_bf16 v[96:99], a[68:71], v[236:239], v[96:99]
    ds_read_b64_tr_b16 a[112:113], v253 offset:33792
    ds_read_b64_tr_b16 a[114:115], v253 offset:37920
    v_mfma_f32_16x16x32_bf16 v[100:103], a[76:79], v[236:239], v[100:103]
    ds_read_b64_tr_b16 a[116:117], v253 offset:42048
    ds_read_b64_tr_b16 a[118:119], v253 offset:46176
    v_mfma_f32_16x16x32_bf16 v[100:103], a[72:75], v[232:235], v[100:103]
    ds_read_b64_tr_b16 a[124:125], v253 offset:42056
    ds_read_b64_tr_b16 a[126:127], v253 offset:46184
    v_mfma_f32_16x16x32_bf16 v[104:107], a[80:83], v[232:235], v[104:107]
    ds_read_b64_tr_b16 a[120:121], v253 offset:33800
    ds_read_b64_tr_b16 a[122:123], v253 offset:37928
    v_mfma_f32_16x16x32_bf16 v[104:107], a[84:87], v[236:239], v[104:107]
    v_accvgpr_read_b32 v240, a204
    v_accvgpr_read_b32 v241, a205
    v_add_f32_e32 v241, v241, v240
    v_rcp_f32_e32 v240, v241
    v_cmp_ngt_f32_e64 s[32:33], s26, v241
    v_accvgpr_read_b32 v241, a218
    v_mul_f32_e64 v241, -v241, v240
    v_pk_fma_f32 v[96:97], v[96:97], v[240:241], v[240:241] op_sel:[0,0,1] op_sel_hi:[1,0,1]
    v_pk_fma_f32 v[98:99], v[98:99], v[240:241], v[240:241] op_sel:[0,0,1] op_sel_hi:[1,0,1]
    v_pk_fma_f32 v[100:101], v[100:101], v[240:241], v[240:241] op_sel:[0,0,1] op_sel_hi:[1,0,1]
    v_pk_fma_f32 v[102:103], v[102:103], v[240:241], v[240:241] op_sel:[0,0,1] op_sel_hi:[1,0,1]
    v_cvt_pk_bf16_f32 v96, v96, v97
    v_cvt_pk_bf16_f32 v97, v98, v99
    v_cvt_pk_bf16_f32 v98, v100, v101
    v_cvt_pk_bf16_f32 v99, v102, v103
    v_mfma_f32_16x16x32_bf16 v[108:111], a[92:95], v[236:239], v[108:111]
    s_or_b64 s[28:29], s[28:29], s[32:33]
    v_mfma_f32_16x16x32_bf16 v[108:111], a[88:91], v[232:235], v[108:111]
    s_waitcnt lgkmcnt(11)
    v_mfma_f32_16x16x32_bf16 v[112:115], a[96:99], v[232:235], v[112:115]
    v_mfma_f32_16x16x32_bf16 v[112:115], a[100:103], v[236:239], v[112:115]
    s_waitcnt lgkmcnt(8)
    ds_write_b128 v242, v[96:99] offset:0
    v_pk_fma_f32 v[104:105], v[104:105], v[240:241], v[240:241] op_sel:[0,0,1] op_sel_hi:[1,0,1]
    v_pk_fma_f32 v[106:107], v[106:107], v[240:241], v[240:241] op_sel:[0,0,1] op_sel_hi:[1,0,1]
    v_pk_fma_f32 v[108:109], v[108:109], v[240:241], v[240:241] op_sel:[0,0,1] op_sel_hi:[1,0,1]
    v_pk_fma_f32 v[110:111], v[110:111], v[240:241], v[240:241] op_sel:[0,0,1] op_sel_hi:[1,0,1]
    v_cvt_pk_bf16_f32 v104, v104, v105
    v_cvt_pk_bf16_f32 v105, v106, v107
    v_cvt_pk_bf16_f32 v106, v108, v109
    v_cvt_pk_bf16_f32 v107, v110, v111
    v_mfma_f32_16x16x32_bf16 v[116:119], a[108:111], v[236:239], v[116:119]
    v_mfma_f32_16x16x32_bf16 v[116:119], a[104:107], v[232:235], v[116:119]
    s_waitcnt lgkmcnt(1)
    v_mfma_f32_16x16x32_bf16 v[120:123], a[112:115], v[232:235], v[120:123]
    v_mfma_f32_16x16x32_bf16 v[120:123], a[116:119], v[236:239], v[120:123]
    ds_write_b128 v242, v[104:107] offset:64
    v_pk_fma_f32 v[112:113], v[112:113], v[240:241], v[240:241] op_sel:[0,0,1] op_sel_hi:[1,0,1]
    v_pk_fma_f32 v[114:115], v[114:115], v[240:241], v[240:241] op_sel:[0,0,1] op_sel_hi:[1,0,1]
    v_pk_fma_f32 v[116:117], v[116:117], v[240:241], v[240:241] op_sel:[0,0,1] op_sel_hi:[1,0,1]
    v_pk_fma_f32 v[118:119], v[118:119], v[240:241], v[240:241] op_sel:[0,0,1] op_sel_hi:[1,0,1]
    v_cvt_pk_bf16_f32 v112, v112, v113
    v_cvt_pk_bf16_f32 v113, v114, v115
    v_cvt_pk_bf16_f32 v114, v116, v117
    v_cvt_pk_bf16_f32 v115, v118, v119
    v_mfma_f32_16x16x32_bf16 v[124:127], a[124:127], v[236:239], v[124:127]
    v_mfma_f32_16x16x32_bf16 v[124:127], a[120:123], v[232:235], v[124:127]
    s_nop 7
    ds_write_b128 v242, v[112:115] offset:128
    v_pk_fma_f32 v[120:121], v[120:121], v[240:241], v[240:241] op_sel:[0,0,1] op_sel_hi:[1,0,1]
    v_pk_fma_f32 v[122:123], v[122:123], v[240:241], v[240:241] op_sel:[0,0,1] op_sel_hi:[1,0,1]
    v_pk_fma_f32 v[124:125], v[124:125], v[240:241], v[240:241] op_sel:[0,0,1] op_sel_hi:[1,0,1]
    v_pk_fma_f32 v[126:127], v[126:127], v[240:241], v[240:241] op_sel:[0,0,1] op_sel_hi:[1,0,1]
    v_cvt_pk_bf16_f32 v120, v120, v121
    v_cvt_pk_bf16_f32 v121, v122, v123
    v_cvt_pk_bf16_f32 v122, v124, v125
    v_cvt_pk_bf16_f32 v123, v126, v127
    ds_write_b128 v242, v[120:123] offset:192
    ds_read_b128 a[176:179], v247 offset:0
    ds_read_b128 a[180:183], v247 offset:1088
    ds_read_b128 a[184:187], v247 offset:2176
    ds_read_b128 a[188:191], v247 offset:3264
    s_waitcnt lgkmcnt(3)
    buffer_store_dwordx4 a[176:179], v255, s[16:19], s22 offen sc0 sc1
    s_waitcnt lgkmcnt(2)
    buffer_store_dwordx4 a[180:183], v255, s[16:19], s22 offen offset:1024 sc0 sc1
    s_waitcnt lgkmcnt(1)
    buffer_store_dwordx4 a[184:187], v255, s[16:19], s22 offen offset:2048 sc0 sc1
    s_waitcnt lgkmcnt(0)
    buffer_store_dwordx4 a[188:191], v255, s[16:19], s22 offen offset:3072 sc0 sc1
    s_cmp_eq_u64 s[28:29], 0
    s_cbranch_scc0 L_slow
L_end:
    s_endpgm
L_rt0:
    ds_read_b32 v244, v255
    s_waitcnt lgkmcnt(0)
    v_cmp_gt_u32_e32 vcc, s44, v244
    s_nop 1
    s_cbranch_vccnz L_rt0
    s_branch L_bk0
L_rt1:
    ds_read_b32 v244, v255
    s_waitcnt lgkmcnt(0)
    v_cmp_gt_u32_e32 vcc, s44, v244
    s_nop 1
    s_cbranch_vccnz L_rt1
    s_branch L_bk1
L_rt2:
    ds_read_b32 v244, v255
    s_waitcnt lgkmcnt(0)
    v_cmp_gt_u32_e32 vcc, s44, v244
    s_nop 1
    s_cbranch_vccnz L_rt2
    s_branch L_bk2
L_rt3:
    ds_read_b32 v244, v255
    s_waitcnt lgkmcnt(0)
    v_cmp_gt_u32_e32 vcc, s44, v244
    s_nop 1
    s_cbranch_vccnz L_rt3
    s_branch L_bk3
L_rt4:
    ds_read_b32 v244, v255
    s_waitcnt lgkmcnt(0)
    v_cmp_gt_u32_e32 vcc, s44, v244
    s_nop 1
    s_cbranch_vccnz L_rt4
    s_branch L_bk4
L_rt5:
    ds_read_b32 v244, v255
    s_waitcnt lgkmcnt(0)
    v_cmp_gt_u32_e32 vcc, s44, v244
    s_nop 1
    s_cbranch_vccnz L_rt5
    s_branch L_bk5
L_rt6:
    ds_read_b32 v244, v255
    s_waitcnt lgkmcnt(0)
    v_cmp_gt_u32_e32 vcc, s44, v244
    s_nop 1
    s_cbranch_vccnz L_rt6
    s_branch L_bk6
L_rt7:
    ds_read_b32 v244, v255
    s_waitcnt lgkmcnt(0)
    v_cmp_gt_u32_e32 vcc, s44, v244
    s_nop 1
    s_cbranch_vccnz L_rt7
    s_branch L_bk7
L_rt8:
    ds_read_b32 v244, v255
    s_waitcnt lgkmcnt(0)
    v_cmp_gt_u32_e32 vcc, s44, v244
    s_nop 1
    s_cbranch_vccnz L_rt8
    s_branch L_bk8
L_rt9:
    ds_read_b32 v244, v255
    s_waitcnt lgkmcnt(0)
    v_cmp_gt_u32_e32 vcc, s44, v244
    s_nop 1
    s_cbranch_vccnz L_rt9
    s_branch L_bk9
L_rt10:
    ds_read_b32 v244, v255
    s_waitcnt lgkmcnt(0)
    v_cmp_gt_u32_e32 vcc, s44, v244
    s_nop 1
    s_cbranch_vccnz L_rt10
    s_branch L_bk10
L_rt11:
    ds_read_b32 v244, v255
    s_waitcnt lgkmcnt(0)
    v_cmp_gt_u32_e32 vcc, s44, v244
    s_nop 1
    s_cbranch_vccnz L_rt11
    s_branch L_bk11
L_rt12:
    ds_read_b32 v244, v255
    s_waitcnt lgkmcnt(0)
    v_cmp_gt_u32_e32 vcc, s44, v244
    s_nop 1
    s_cbranch_vccnz L_rt12
    s_branch L_bk12
L_rt13:
    ds_read_b32 v244, v255
    s_waitcnt lgkmcnt(0)
    v_cmp_gt_u32_e32 vcc, s44, v244
    s_nop 1
    s_cbranch_vccnz L_rt13
    s_branch L_bk13
L_rt14:
    ds_read_b32 v244, v255
    s_waitcnt lgkmcnt(0)
    v_cmp_gt_u32_e32 vcc, s44, v244
    s_nop 1
    s_cbranch_vccnz L_rt14
    s_branch L_bk14
L_rt15:
    ds_read_b32 v244, v255
    s_waitcnt lgkmcnt(0)
    v_cmp_gt_u32_e32 vcc, s44, v244
    s_nop 1
    s_cbranch_vccnz L_rt15
    s_branch L_bk15
L_rt16:
    ds_read_b32 v244, v255
    s_waitcnt lgkmcnt(0)
    v_cmp_gt_u32_e32 vcc, s44, v244
    s_nop 1
    s_cbranch_vccnz L_rt16
    s_branch L_bk16
L_rt17:
    ds_read_b32 v244, v255
    s_waitcnt lgkmcnt(0)
    v_cmp_gt_u32_e32 vcc, s44, v244
    s_nop 1
    s_cbranch_vccnz L_rt17
    s_branch L_bk17
L_rt18:
    ds_read_b32 v244, v255
    s_waitcnt lgkmcnt(0)
    v_cmp_gt_u32_e32 vcc, s44, v244
    s_nop 1
    s_cbranch_vccnz L_rt18
    s_branch L_bk18
L_slow:
    s_waitcnt vmcnt(0) lgkmcnt(0)
    s_mov_b32 s6, 0x4000000
    s_mov_b32 s10, 0x2000000
    s_mov_b32 s14, 0x2000000
    v_mbcnt_lo_u32_b32 v200, -1, 0
    v_mbcnt_hi_u32_b32 v200, -1, v200
    v_lshrrev_b32_e32 v201, 4, v200
    v_bfe_u32 v202, v200, 2, 2
    v_and_b32_e32 v203, 3, v200
    v_lshlrev_b32_e32 v204, 10, v201
    v_lshl_add_u32 v204, v202, 4, v204
    v_lshl_add_u32 v204, v203, 1, v204
    v_and_b32_e32 v255, 15, v200
    v_lshlrev_b32_e32 v255, 8, v255
    v_lshl_add_u32 v255, v201, 4, v255
    s_mov_b32 s40, 0
L_sl_item:
    s_lshr_b32 s41, s40, 2
    s_and_b32 s42, s40, 3
    s_lshl_b32 s43, s41, 24
    s_add_u32 s43, s43, s38
    s_lshl_b32 s42, s42, 14
    s_add_u32 s43, s43, s42
    s_lshl_b32 s44, s41, 23
    s_add_u32 s44, s44, s39
    buffer_load_dwordx4 v[64:67], v255, s[4:7], s43 offen offset:0
    buffer_load_dwordx4 v[68:71], v255, s[4:7], s43 offen offset:64
    buffer_load_dwordx4 v[72:75], v255, s[4:7], s43 offen offset:128
    buffer_load_dwordx4 v[76:79], v255, s[4:7], s43 offen offset:192
    s_waitcnt vmcnt(0)
    v_mfma_f32_4x4x4_16b_bf16 v[80:83], a[212:213], v[64:65], 0
    s_nop 3
    v_mfma_f32_4x4x4_16b_bf16 v[80:83], a[214:215], v[64:65], v[80:83]
    s_nop 7
    v_cvt_pk_bf16_f32 v128, v80, v81
    v_cvt_pk_bf16_f32 v129, v82, v83
    v_mfma_f32_4x4x4_16b_bf16 v[80:83], a[212:213], v[66:67], 0
    s_nop 3
    v_mfma_f32_4x4x4_16b_bf16 v[80:83], a[214:215], v[66:67], v[80:83]
    s_nop 7
    v_cvt_pk_bf16_f32 v130, v80, v81
    v_cvt_pk_bf16_f32 v131, v82, v83
    v_mfma_f32_4x4x4_16b_bf16 v[80:83], a[212:213], v[68:69], 0
    s_nop 3
    v_mfma_f32_4x4x4_16b_bf16 v[80:83], a[214:215], v[68:69], v[80:83]
    s_nop 7
    v_cvt_pk_bf16_f32 v132, v80, v81
    v_cvt_pk_bf16_f32 v133, v82, v83
    v_mfma_f32_4x4x4_16b_bf16 v[80:83], a[212:213], v[70:71], 0
    s_nop 3
    v_mfma_f32_4x4x4_16b_bf16 v[80:83], a[214:215], v[70:71], v[80:83]
    s_nop 7
    v_cvt_pk_bf16_f32 v134, v80, v81
    v_cvt_pk_bf16_f32 v135, v82, v83
    v_mfma_f32_4x4x4_16b_bf16 v[80:83], a[212:213], v[72:73], 0
    s_nop 3
    v_mfma_f32_4x4x4_16b_bf16 v[80:83], a[214:215], v[72:73], v[80:83]
    s_nop 7
    v_cvt_pk_bf16_f32 v136, v80, v81
    v_cvt_pk_bf16_f32 v137, v82, v83
    v_mfma_f32_4x4x4_16b_bf16 v[80:83], a[212:213], v[74:75], 0
    s_nop 3
    v_mfma_f32_4x4x4_16b_bf16 v[80:83], a[214:215], v[74:75], v[80:83]
    s_nop 7
    v_cvt_pk_bf16_f32 v138, v80, v81
    v_cvt_pk_bf16_f32 v139, v82, v83
    v_mfma_f32_4x4x4_16b_bf16 v[80:83], a[212:213], v[76:77], 0
    s_nop 3
    v_mfma_f32_4x4x4_16b_bf16 v[80:83], a[214:215], v[76:77], v[80:83]
    s_nop 7
    v_cvt_pk_bf16_f32 v140, v80, v81
    v_cvt_pk_bf16_f32 v141, v82, v83
    v_mfma_f32_4x4x4_16b_bf16 v[80:83], a[212:213], v[78:79], 0
    s_nop 3
    v_mfma_f32_4x4x4_16b_bf16 v[80:83], a[214:215], v[78:79], v[80:83]
    s_nop 7
    v_cvt_pk_bf16_f32 v142, v80, v81
    v_cvt_pk_bf16_f32 v143, v82, v83
    v_mov_b32_e32 v96, 0xff800000
    s_mov_b32 s45, s44
    s_mov_b32 s46, 32
L_sl_max:
    buffer_load_dwordx4 v[64:67], v255, s[8:11], s45 offen offset:0
    buffer_load_dwordx4 v[68:71], v255, s[8:11], s45 offen offset:64
    buffer_load_dwordx4 v[72:75], v255, s[8:11], s45 offen offset:128
    buffer_load_dwordx4 v[76:79], v255, s[8:11], s45 offen offset:192
    s_waitcnt vmcnt(0)
    v_mfma_f32_16x16x32_bf16 v[80:83], v[64:67], v[128:131], 0
    v_mfma_f32_16x16x32_bf16 v[80:83], v[68:71], v[132:135], v[80:83]
    v_mfma_f32_16x16x32_bf16 v[80:83], v[72:75], v[136:139], v[80:83]
    v_mfma_f32_16x16x32_bf16 v[80:83], v[76:79], v[140:143], v[80:83]
    s_nop 9
    v_max3_f32 v96, v96, v80, v81
    v_max3_f32 v96, v96, v82, v83
    s_add_u32 s45, s45, 4096
    s_sub_u32 s46, s46, 1
    s_cmp_lg_u32 s46, 0
    s_cbranch_scc1 L_sl_max
    v_mov_b32_e32 v97, v96
    s_nop 1
    v_permlane32_swap_b32_e32 v96, v97
    s_nop 1
    v_max_f32_e32 v96, v96, v97
    v_mov_b32_e32 v97, v96
    s_nop 1
    v_permlane16_swap_b32_e32 v96, v97
    s_nop 1
    v_max_f32_e32 v100, v96, v97
    v_mov_b32_e32 v0, 0
    v_mov_b32_e32 v1, 0
    v_mov_b32_e32 v2, 0
    v_mov_b32_e32 v3, 0
    v_mov_b32_e32 v4, 0
    v_mov_b32_e32 v5, 0
    v_mov_b32_e32 v6, 0
    v_mov_b32_e32 v7, 0
    v_mov_b32_e32 v8, 0
    v_mov_b32_e32 v9, 0
    v_mov_b32_e32 v10, 0
    v_mov_b32_e32 v11, 0
    v_mov_b32_e32 v12, 0
    v_mov_b32_e32 v13, 0
    v_mov_b32_e32 v14, 0
    v_mov_b32_e32 v15, 0
    v_mov_b32_e32 v16, 0
    v_mov_b32_e32 v17, 0
    v_mov_b32_e32 v18, 0
    v_mov_b32_e32 v19, 0
    v_mov_b32_e32 v20, 0
    v_mov_b32_e32 v21, 0
    v_mov_b32_e32 v22, 0
    v_mov_b32_e32 v23, 0
    v_mov_b32_e32 v24, 0
    v_mov_b32_e32 v25, 0
    v_mov_b32_e32 v26, 0
    v_mov_b32_e32 v27, 0
    v_mov_b32_e32 v28, 0
    v_mov_b32_e32 v29, 0
    v_mov_b32_e32 v30, 0
    v_mov_b32_e32 v31, 0
    v_mov_b32_e32 v32, 0
    v_mov_b32_e32 v33, 0
    v_mov_b32_e32 v34, 0
    v_mov_b32_e32 v35, 0
    s_mov_b32 s45, s44
    s_mov_b32 s46, 16
L_sl_acc:
    s_add_u32 s47, s45, 4096
    buffer_load_dwordx4 v[64:67], v255, s[8:11], s45 offen offset:0
    buffer_load_dwordx4 v[68:71], v255, s[8:11], s45 offen offset:64
    buffer_load_dwordx4 v[72:75], v255, s[8:11], s45 offen offset:128
    buffer_load_dwordx4 v[76:79], v255, s[8:11], s45 offen offset:192
    s_waitcnt vmcnt(0)
    v_mfma_f32_16x16x32_bf16 v[80:83], v[64:67], v[128:131], 0
    v_mfma_f32_16x16x32_bf16 v[80:83], v[68:71], v[132:135], v[80:83]
    v_mfma_f32_16x16x32_bf16 v[80:83], v[72:75], v[136:139], v[80:83]
    v_mfma_f32_16x16x32_bf16 v[80:83], v[76:79], v[140:143], v[80:83]
    s_nop 9
    v_sub_f32_e32 v80, v80, v100
    v_sub_f32_e32 v81, v81, v100
    v_sub_f32_e32 v82, v82, v100
    v_sub_f32_e32 v83, v83, v100
    v_exp_f32_e32 v80, v80
    v_exp_f32_e32 v81, v81
    v_exp_f32_e32 v82, v82
    v_exp_f32_e32 v83, v83
    s_nop 1
    v_cvt_pk_bf16_f32 v88, v80, v81
    v_cvt_pk_bf16_f32 v89, v82, v83
    buffer_load_dwordx4 v[64:67], v255, s[8:11], s47 offen offset:0
    buffer_load_dwordx4 v[68:71], v255, s[8:11], s47 offen offset:64
    buffer_load_dwordx4 v[72:75], v255, s[8:11], s47 offen offset:128
    buffer_load_dwordx4 v[76:79], v255, s[8:11], s47 offen offset:192
    s_waitcnt vmcnt(0)
    v_mfma_f32_16x16x32_bf16 v[80:83], v[64:67], v[128:131], 0
    v_mfma_f32_16x16x32_bf16 v[80:83], v[68:71], v[132:135], v[80:83]
    v_mfma_f32_16x16x32_bf16 v[80:83], v[72:75], v[136:139], v[80:83]
    v_mfma_f32_16x16x32_bf16 v[80:83], v[76:79], v[140:143], v[80:83]
    s_nop 9
    v_sub_f32_e32 v80, v80, v100
    v_sub_f32_e32 v81, v81, v100
    v_sub_f32_e32 v82, v82, v100
    v_sub_f32_e32 v83, v83, v100
    v_exp_f32_e32 v80, v80
    v_exp_f32_e32 v81, v81
    v_exp_f32_e32 v82, v82
    v_exp_f32_e32 v83, v83
    s_nop 1
    v_cvt_pk_bf16_f32 v90, v80, v81
    v_cvt_pk_bf16_f32 v91, v82, v83
    s_nop 1
    v_mfma_f32_16x16x32_bf16 v[32:35], a[208:211], v[88:91], v[32:35]
    buffer_load_ushort v64, v204, s[12:15], s45 offen offset:0
    buffer_load_ushort v65, v204, s[12:15], s45 offen offset:256
    buffer_load_ushort v66, v204, s[12:15], s45 offen offset:512
    buffer_load_ushort v67, v204, s[12:15], s45 offen offset:768
    buffer_load_ushort v68, v204, s[12:15], s47 offen offset:0
    buffer_load_ushort v69, v204, s[12:15], s47 offen offset:256
    buffer_load_ushort v70, v204, s[12:15], s47 offen offset:512
    buffer_load_ushort v71, v204, s[12:15], s47 offen offset:768
    s_waitcnt vmcnt(0)
    v_lshl_or_b32 v72, v65, 16, v64
    v_lshl_or_b32 v73, v67, 16, v66
    v_lshl_or_b32 v74, v69, 16, v68
    v_lshl_or_b32 v75, v71, 16, v70
    s_nop 1
    v_mfma_f32_16x16x32_bf16 v[0:3], v[72:75], v[88:91], v[0:3]
    buffer_load_ushort v64, v204, s[12:15], s45 offen offset:8
    buffer_load_ushort v65, v204, s[12:15], s45 offen offset:264
    buffer_load_ushort v66, v204, s[12:15], s45 offen offset:520
    buffer_load_ushort v67, v204, s[12:15], s45 offen offset:776
    buffer_load_ushort v68, v204, s[12:15], s47 offen offset:8
    buffer_load_ushort v69, v204, s[12:15], s47 offen offset:264
    buffer_load_ushort v70, v204, s[12:15], s47 offen offset:520
    buffer_load_ushort v71, v204, s[12:15], s47 offen offset:776
    s_waitcnt vmcnt(0)
    v_lshl_or_b32 v72, v65, 16, v64
    v_lshl_or_b32 v73, v67, 16, v66
    v_lshl_or_b32 v74, v69, 16, v68
    v_lshl_or_b32 v75, v71, 16, v70
    s_nop 1
    v_mfma_f32_16x16x32_bf16 v[4:7], v[72:75], v[88:91], v[4:7]
    buffer_load_ushort v64, v204, s[12:15], s45 offen offset:64
    buffer_load_ushort v65, v204, s[12:15], s45 offen offset:320
    buffer_load_ushort v66, v204, s[12:15], s45 offen offset:576
    buffer_load_ushort v67, v204, s[12:15], s45 offen offset:832
    buffer_load_ushort v68, v204, s[12:15], s47 offen offset:64
    buffer_load_ushort v69, v204, s[12:15], s47 offen offset:320
    buffer_load_ushort v70, v204, s[12:15], s47 offen offset:576
    buffer_load_ushort v71, v204, s[12:15], s47 offen offset:832
    s_waitcnt vmcnt(0)
    v_lshl_or_b32 v72, v65, 16, v64
    v_lshl_or_b32 v73, v67, 16, v66
    v_lshl_or_b32 v74, v69, 16, v68
    v_lshl_or_b32 v75, v71, 16, v70
    s_nop 1
    v_mfma_f32_16x16x32_bf16 v[8:11], v[72:75], v[88:91], v[8:11]
    buffer_load_ushort v64, v204, s[12:15], s45 offen offset:72
    buffer_load_ushort v65, v204, s[12:15], s45 offen offset:328
    buffer_load_ushort v66, v204, s[12:15], s45 offen offset:584
    buffer_load_ushort v67, v204, s[12:15], s45 offen offset:840
    buffer_load_ushort v68, v204, s[12:15], s47 offen offset:72
    buffer_load_ushort v69, v204, s[12:15], s47 offen offset:328
    buffer_load_ushort v70, v204, s[12:15], s47 offen offset:584
    buffer_load_ushort v71, v204, s[12:15], s47 offen offset:840
    s_waitcnt vmcnt(0)
    v_lshl_or_b32 v72, v65, 16, v64
    v_lshl_or_b32 v73, v67, 16, v66
    v_lshl_or_b32 v74, v69, 16, v68
    v_lshl_or_b32 v75, v71, 16, v70
    s_nop 1
    v_mfma_f32_16x16x32_bf16 v[12:15], v[72:75], v[88:91], v[12:15]
    buffer_load_ushort v64, v204, s[12:15], s45 offen offset:128
    buffer_load_ushort v65, v204, s[12:15], s45 offen offset:384
    buffer_load_ushort v66, v204, s[12:15], s45 offen offset:640
    buffer_load_ushort v67, v204, s[12:15], s45 offen offset:896
    buffer_load_ushort v68, v204, s[12:15], s47 offen offset:128
    buffer_load_ushort v69, v204, s[12:15], s47 offen offset:384
    buffer_load_ushort v70, v204, s[12:15], s47 offen offset:640
    buffer_load_ushort v71, v204, s[12:15], s47 offen offset:896
    s_waitcnt vmcnt(0)
    v_lshl_or_b32 v72, v65, 16, v64
    v_lshl_or_b32 v73, v67, 16, v66
    v_lshl_or_b32 v74, v69, 16, v68
    v_lshl_or_b32 v75, v71, 16, v70
    s_nop 1
    v_mfma_f32_16x16x32_bf16 v[16:19], v[72:75], v[88:91], v[16:19]
    buffer_load_ushort v64, v204, s[12:15], s45 offen offset:136
    buffer_load_ushort v65, v204, s[12:15], s45 offen offset:392
    buffer_load_ushort v66, v204, s[12:15], s45 offen offset:648
    buffer_load_ushort v67, v204, s[12:15], s45 offen offset:904
    buffer_load_ushort v68, v204, s[12:15], s47 offen offset:136
    buffer_load_ushort v69, v204, s[12:15], s47 offen offset:392
    buffer_load_ushort v70, v204, s[12:15], s47 offen offset:648
    buffer_load_ushort v71, v204, s[12:15], s47 offen offset:904
    s_waitcnt vmcnt(0)
    v_lshl_or_b32 v72, v65, 16, v64
    v_lshl_or_b32 v73, v67, 16, v66
    v_lshl_or_b32 v74, v69, 16, v68
    v_lshl_or_b32 v75, v71, 16, v70
    s_nop 1
    v_mfma_f32_16x16x32_bf16 v[20:23], v[72:75], v[88:91], v[20:23]
    buffer_load_ushort v64, v204, s[12:15], s45 offen offset:192
    buffer_load_ushort v65, v204, s[12:15], s45 offen offset:448
    buffer_load_ushort v66, v204, s[12:15], s45 offen offset:704
    buffer_load_ushort v67, v204, s[12:15], s45 offen offset:960
    buffer_load_ushort v68, v204, s[12:15], s47 offen offset:192
    buffer_load_ushort v69, v204, s[12:15], s47 offen offset:448
    buffer_load_ushort v70, v204, s[12:15], s47 offen offset:704
    buffer_load_ushort v71, v204, s[12:15], s47 offen offset:960
    s_waitcnt vmcnt(0)
    v_lshl_or_b32 v72, v65, 16, v64
    v_lshl_or_b32 v73, v67, 16, v66
    v_lshl_or_b32 v74, v69, 16, v68
    v_lshl_or_b32 v75, v71, 16, v70
    s_nop 1
    v_mfma_f32_16x16x32_bf16 v[24:27], v[72:75], v[88:91], v[24:27]
    buffer_load_ushort v64, v204, s[12:15], s45 offen offset:200
    buffer_load_ushort v65, v204, s[12:15], s45 offen offset:456
    buffer_load_ushort v66, v204, s[12:15], s45 offen offset:712
    buffer_load_ushort v67, v204, s[12:15], s45 offen offset:968
    buffer_load_ushort v68, v204, s[12:15], s47 offen offset:200
    buffer_load_ushort v69, v204, s[12:15], s47 offen offset:456
    buffer_load_ushort v70, v204, s[12:15], s47 offen offset:712
    buffer_load_ushort v71, v204, s[12:15], s47 offen offset:968
    s_waitcnt vmcnt(0)
    v_lshl_or_b32 v72, v65, 16, v64
    v_lshl_or_b32 v73, v67, 16, v66
    v_lshl_or_b32 v74, v69, 16, v68
    v_lshl_or_b32 v75, v71, 16, v70
    s_nop 1
    v_mfma_f32_16x16x32_bf16 v[28:31], v[72:75], v[88:91], v[28:31]
    s_add_u32 s45, s45, 8192
    s_sub_u32 s46, s46, 1
    s_cmp_lg_u32 s46, 0
    s_cbranch_scc1 L_sl_acc
    s_nop 9
    v_rcp_f32_e32 v36, v32
    s_nop 1
    v_mul_f32_e32 v0, v36, v0
    v_mul_f32_e32 v1, v36, v1
    v_mul_f32_e32 v2, v36, v2
    v_mul_f32_e32 v3, v36, v3
    v_mul_f32_e32 v4, v36, v4
    v_mul_f32_e32 v5, v36, v5
    v_mul_f32_e32 v6, v36, v6
    v_mul_f32_e32 v7, v36, v7
    v_mul_f32_e32 v8, v36, v8
    v_mul_f32_e32 v9, v36, v9
    v_mul_f32_e32 v10, v36, v10
    v_mul_f32_e32 v11, v36, v11
    v_mul_f32_e32 v12, v36, v12
    v_mul_f32_e32 v13, v36, v13
    v_mul_f32_e32 v14, v36, v14
    v_mul_f32_e32 v15, v36, v15
    v_mul_f32_e32 v16, v36, v16
    v_mul_f32_e32 v17, v36, v17
    v_mul_f32_e32 v18, v36, v18
    v_mul_f32_e32 v19, v36, v19
    v_mul_f32_e32 v20, v36, v20
    v_mul_f32_e32 v21, v36, v21
    v_mul_f32_e32 v22, v36, v22
    v_mul_f32_e32 v23, v36, v23
    v_mul_f32_e32 v24, v36, v24
    v_mul_f32_e32 v25, v36, v25
    v_mul_f32_e32 v26, v36, v26
    v_mul_f32_e32 v27, v36, v27
    v_mul_f32_e32 v28, v36, v28
    v_mul_f32_e32 v29, v36, v29
    v_mul_f32_e32 v30, v36, v30
    v_mul_f32_e32 v31, v36, v31
    v_cvt_pk_bf16_f32 v40, v0, v1
    v_cvt_pk_bf16_f32 v41, v2, v3
    v_cvt_pk_bf16_f32 v42, v4, v5
    v_cvt_pk_bf16_f32 v43, v6, v7
    buffer_store_dwordx4 v[40:43], v255, s[16:19], s43 offen offset:0
    v_cvt_pk_bf16_f32 v44, v8, v9
    v_cvt_pk_bf16_f32 v45, v10, v11
    v_cvt_pk_bf16_f32 v46, v12, v13
    v_cvt_pk_bf16_f32 v47, v14, v15
    buffer_store_dwordx4 v[44:47], v255, s[16:19], s43 offen offset:64
    v_cvt_pk_bf16_f32 v48, v16, v17
    v_cvt_pk_bf16_f32 v49, v18, v19
    v_cvt_pk_bf16_f32 v50, v20, v21
    v_cvt_pk_bf16_f32 v51, v22, v23
    buffer_store_dwordx4 v[48:51], v255, s[16:19], s43 offen offset:128
    v_cvt_pk_bf16_f32 v52, v24, v25
    v_cvt_pk_bf16_f32 v53, v26, v27
    v_cvt_pk_bf16_f32 v54, v28, v29
    v_cvt_pk_bf16_f32 v55, v30, v31
    buffer_store_dwordx4 v[52:55], v255, s[16:19], s43 offen offset:192
    s_waitcnt vmcnt(0)
    s_add_u32 s40, s40, 1
    s_cmp_lt_u32 s40, 16
    s_cbranch_scc1 L_sl_item
    s_endpgm
.section .rodata,"a"
.p2align 6
.amdhsa_kernel standalone__mha_softmax__near_ridge_kernel
  .amdhsa_next_free_vgpr 512
  .amdhsa_next_free_sgpr 100
  .amdhsa_accum_offset 256
  .amdhsa_group_segment_fixed_size 0
  .amdhsa_kernarg_size 48
  .amdhsa_user_sgpr_count 2
  .amdhsa_user_sgpr_kernarg_segment_ptr 1
  .amdhsa_system_sgpr_workgroup_id_x 1
  .amdhsa_float_denorm_mode_32 3
.end_amdhsa_kernel
```
